```python
import torch

def _softmax(x, axis=-1):
    return torch.softmax(x, dim=axis)

def _gelu(x):
    return torch.nn.functional.gelu(x, approximate='tanh')

def _silu(x):
    return torch.nn.functional.silu(x)

def _sigmoid(x):
    return torch.sigmoid(x)

def _layernorm(x, axis=-1, eps=1e-05):
    m = x.mean(dim=axis, keepdim=True)
    v = x.var(dim=axis, keepdim=True, unbiased=False)
    return (x - m) / torch.sqrt(v + eps)

def _scatter_add(tgt, idx, src, axis=0):
    return tgt.clone().index_add_(axis, idx, src)

def _segment_sum(src, seg, n):
    out = torch.zeros((n,) + src.shape[1:], dtype=src.dtype)
    return out.index_add_(0, seg, src)

def _pad(x, pw):
    flat = tuple((v for pair in reversed(pw) for v in pair))
    return torch.nn.functional.pad(x, flat)
kernel_name = 'standalone__autoregressive_conv_wavernn__speech'

def setup_inputs():

    _w = lambda a: (lambda t: t.to(torch.bfloat16) if t.is_floating_point() else t)(torch.as_tensor(a))
    B, T, D, K = (2, 16000, 256, 15)
    return {'x': _w((lambda *s: torch.randn(*s, dtype=torch.bfloat16) * 0.1)(B, T, D)), 'w': _w((lambda *s: torch.randn(*s, dtype=torch.bfloat16) * 0.1)(K, D, 2 * D))}

def reference(x, w):
    B, T, D = x.shape
    K = w.shape[0]
    dil = 2
    pad = (K - 1) * dil
    xp = _pad(x, ((0, 0), (pad, 0), (0, 0)))
    h = torch.einsum('btd,de->bte', xp[:, 0:T, :], w[0])
    for i in range(1, K):
        h = h + torch.einsum('btd,de->bte', xp[:, i * dil:i * dil + T, :], w[i])
    f, g = (h[..., :D].clone(), h[..., D:].clone())
    return torch.tanh(f) * _sigmoid(g)
```

```asm
; @launch kernel=prep_kernel grid=(1016,1,1) block=(256,1,1) lds=24576
; @launch kernel=standalone__autoregressive_conv_wavernn__speech_kernel grid=(232,1,1) block=(256,1,1) lds=161280
.amdgcn_target "amdgcn-amd-amdhsa--gfx950"
.text
.globl prep_kernel
.p2align 8
.type prep_kernel,@function
prep_kernel:
s_cmp_ge_u32 s2, 1016
s_cbranch_scc1 LP_end2
s_cmp_lt_u32 s2, 16
s_cbranch_scc1 LP_cw
s_sub_u32 s2, s2, 16
s_load_dwordx4 s[16:19], s[0:1], 0
s_load_dwordx2 s[6:7], s[0:1], 32
s_mov_b32 s33, 0xffff0000
v_lshrrev_b32 v4, 6, v0
v_and_b32 v5, 63, v0
s_mov_b32 s11, 0x20000
s_mov_b32 s15, 0x20000
v_readfirstlane_b32 s26, v4
s_cmp_ge_u32 s2, 192
s_cbranch_scc0 LP_W
LP_T:
s_sub_u32 s20, s2, 192
s_bfe_u32 s21, s20, 0x10002
s_and_b32 s22, s20, 3
s_mul_i32 s22, s22, 404
s_lshr_b32 s20, s20, 3
s_lshl_b32 s20, s20, 2
s_add_u32 s22, s22, s20
s_add_u32 s22, s22, s26
s_mul_i32 s22, s22, 1
s_sub_u32 s23, s22, s26
s_cmp_ge_u32 s23, 1602
s_cbranch_scc1 LP_end2
s_mul_i32 s20, s21, 1602
s_add_u32 s20, s20, s22
s_mul_i32 s23, s23, 5120
s_lshl_b32 s25, s26, 10
s_add_u32 s23, s23, s25
s_sub_u32 s23, s23, 14336
v_lshlrev_b32 v6, 4, v5
v_add_u32 v1, s23, v6
s_mul_i32 s24, s21, 8192000
s_mov_b32 s10, 8192000
s_mov_b32 m0, s25
s_waitcnt lgkmcnt(0)
s_add_u32 s8, s16, s24
s_addc_u32 s9, s17, 0
buffer_load_dwordx4 v1, s[8:11], 0 offen lds
s_add_u32 m0, m0, 4096
v_add_u32 v2, 4096, v1
buffer_load_dwordx4 v2, s[8:11], 0 offen nt lds
s_add_u32 m0, m0, 4096
v_add_u32 v1, 4096, v2
buffer_load_dwordx4 v1, s[8:11], 0 offen nt lds
s_add_u32 m0, m0, 4096
v_add_u32 v2, 4096, v1
buffer_load_dwordx4 v2, s[8:11], 0 offen nt lds
s_add_u32 m0, m0, 4096
v_add_u32 v1, 4096, v2
buffer_load_dwordx4 v1, s[8:11], 0 offen nt lds
s_add_u32 m0, m0, 4096
v_add_u32 v2, 4096, v1
buffer_load_dwordx4 v2, s[8:11], 0 offen lds
s_mul_i32 s25, s26, 5120
v_add_u32 v6, s25, v6
s_add_u32 s12, s6, 16777216
s_addc_u32 s13, s7, 0
s_mov_b32 s14, 32808960
s_mul_i32 s28, s20, 1024
v_lshrrev_b32 v3, 5, v5
v_xor_b32 v3, v3, v5
v_lshlrev_b32 v3, 4, v3
s_mov_b32 s40, 0x40033333
s_mov_b32 s41, s40
s_mov_b32 s42, 0xc01b48c2
s_mov_b32 s43, s42
s_mov_b32 s44, 0x3f4ccccd
s_mov_b32 s45, s44
s_mov_b32 s46, 0x3fa00000
s_mov_b32 s47, s46
s_mov_b32 s48, 0xbf06bca2
s_mov_b32 s49, s48
s_mov_b32 s50, 0xbff33333
s_mov_b32 s51, s50
s_mov_b32 s52, 0xbec0ac77
s_mov_b32 s53, s52
s_mov_b32 s54, 0xbffcaa4f
s_mov_b32 s55, s54
s_mov_b32 s56, 0xbf40ac77
s_mov_b32 s57, s56
s_mov_b32 s58, 0x3fb8aa3b
s_mov_b32 s59, s58
s_waitcnt vmcnt(0)
s_barrier
s_cmp_ge_u32 s22, 1602
s_cbranch_scc1 LP_end
ds_read_b128 v[92:95], v6 offset:0
ds_read_b128 v[96:99], v6 offset:1024
ds_read_b128 v[100:103], v6 offset:2048
ds_read_b128 v[104:107], v6 offset:3072
ds_read_b128 v[108:111], v6 offset:4096
ds_read_b128 v[112:115], v6 offset:5120
ds_read_b128 v[116:119], v6 offset:6144
ds_read_b128 v[120:123], v6 offset:7168
ds_read_b128 v[124:127], v6 offset:8192
s_waitcnt lgkmcnt(8)
v_lshlrev_b32 v8, 16, v92
v_and_b32 v9, s33, v92
s_waitcnt lgkmcnt(7)
v_lshlrev_b32 v10, 16, v96
v_and_b32 v11, s33, v96
s_waitcnt lgkmcnt(6)
v_lshlrev_b32 v12, 16, v100
v_and_b32 v13, s33, v100
s_waitcnt lgkmcnt(5)
v_lshlrev_b32 v14, 16, v104
v_and_b32 v15, s33, v104
s_waitcnt lgkmcnt(4)
v_lshlrev_b32 v16, 16, v108
v_and_b32 v17, s33, v108
s_waitcnt lgkmcnt(3)
v_lshlrev_b32 v18, 16, v112
v_and_b32 v19, s33, v112
s_waitcnt lgkmcnt(2)
v_lshlrev_b32 v20, 16, v116
v_and_b32 v21, s33, v116
s_waitcnt lgkmcnt(1)
v_lshlrev_b32 v22, 16, v120
v_and_b32 v23, s33, v120
s_waitcnt lgkmcnt(0)
v_lshlrev_b32 v24, 16, v124
v_and_b32 v25, s33, v124
v_pk_add_f32 v[46:47], v[10:11], v[22:23]
v_pk_add_f32 v[48:49], v[12:13], v[20:21]
v_pk_add_f32 v[50:51], v[14:15], v[18:19]
v_pk_fma_f32 v[46:47], v[16:17], s[56:57], v[46:47]
v_pk_fma_f32 v[46:47], v[48:49], s[52:53], v[46:47]
v_pk_fma_f32 v[46:47], v[50:51], s[54:55], v[46:47]
v_pk_add_f32 v[8:9], v[10:11], v[8:9] neg_lo:[0,1] neg_hi:[0,1]
v_pk_add_f32 v[10:11], v[12:13], v[10:11] neg_lo:[0,1] neg_hi:[0,1]
v_pk_add_f32 v[12:13], v[14:15], v[12:13] neg_lo:[0,1] neg_hi:[0,1]
v_pk_add_f32 v[14:15], v[16:17], v[14:15] neg_lo:[0,1] neg_hi:[0,1]
v_pk_add_f32 v[16:17], v[18:19], v[16:17] neg_lo:[0,1] neg_hi:[0,1]
v_pk_add_f32 v[18:19], v[20:21], v[18:19] neg_lo:[0,1] neg_hi:[0,1]
v_pk_add_f32 v[20:21], v[22:23], v[20:21] neg_lo:[0,1] neg_hi:[0,1]
v_pk_add_f32 v[22:23], v[24:25], v[22:23] neg_lo:[0,1] neg_hi:[0,1]
v_cvt_pk_bf16_f32 v64, v46, v47
v_pk_add_f32 v[26:27], v[8:9], v[12:13]
v_pk_add_f32 v[28:29], v[10:11], v[14:15]
v_pk_add_f32 v[30:31], v[12:13], v[16:17]
v_pk_add_f32 v[32:33], v[14:15], v[18:19]
v_pk_add_f32 v[34:35], v[16:17], v[20:21]
v_pk_add_f32 v[36:37], v[18:19], v[22:23]
v_pk_add_f32 v[46:47], v[28:29], v[32:33]
v_pk_add_f32 v[48:49], v[30:31], v[34:35]
v_pk_fma_f32 v[46:47], v[30:31], s[42:43], v[46:47]
v_pk_fma_f32 v[48:49], v[32:33], s[42:43], v[48:49]
v_pk_fma_f32 v[26:27], v[10:11], s[40:41], v[26:27]
v_pk_fma_f32 v[28:29], v[12:13], s[40:41], v[28:29]
v_pk_fma_f32 v[30:31], v[14:15], s[40:41], v[30:31]
v_pk_fma_f32 v[32:33], v[16:17], s[40:41], v[32:33]
v_pk_fma_f32 v[34:35], v[18:19], s[40:41], v[34:35]
v_pk_fma_f32 v[36:37], v[20:21], s[40:41], v[36:37]
v_pk_fma_f32 v[50:51], v[46:47], s[44:45], v[48:49]
v_pk_fma_f32 v[48:49], v[46:47], s[46:47], v[48:49]
v_pk_add_f32 v[38:39], v[26:27], v[30:31]
v_pk_add_f32 v[40:41], v[28:29], v[32:33]
v_pk_add_f32 v[42:43], v[30:31], v[34:35]
v_pk_add_f32 v[44:45], v[32:33], v[36:37]
v_cvt_pk_bf16_f32 v52, v50, v51
v_cvt_pk_bf16_f32 v56, v48, v49
v_pk_fma_f32 v[46:47], v[40:41], s[48:49], v[42:43]
v_pk_fma_f32 v[8:9], v[40:41], s[50:51], v[42:43]
v_pk_fma_f32 v[38:39], v[28:29], s[42:43], v[38:39]
v_pk_fma_f32 v[40:41], v[30:31], s[42:43], v[40:41]
v_pk_fma_f32 v[42:43], v[32:33], s[42:43], v[42:43]
v_pk_fma_f32 v[44:45], v[34:35], s[42:43], v[44:45]
v_cvt_pk_bf16_f32 v68, v46, v47
v_cvt_pk_bf16_f32 v72, v8, v9
v_pk_add_f32 v[48:49], v[40:41], v[42:43]
v_pk_add_f32 v[38:39], v[38:39], v[42:43]
v_pk_add_f32 v[44:45], v[44:45], v[40:41]
v_cvt_pk_bf16_f32 v76, v40, v41
v_cvt_pk_bf16_f32 v80, v42, v43
v_pk_mul_f32 v[38:39], v[38:39], s[58:59]
v_pk_mul_f32 v[44:45], v[44:45], s[58:59]
v_cvt_pk_bf16_f32 v60, v48, v49
v_cvt_pk_bf16_f32 v84, v38, v39
v_cvt_pk_bf16_f32 v88, v44, v45
v_lshlrev_b32 v8, 16, v93
v_and_b32 v9, s33, v93
v_lshlrev_b32 v10, 16, v97
v_and_b32 v11, s33, v97
v_lshlrev_b32 v12, 16, v101
v_and_b32 v13, s33, v101
v_lshlrev_b32 v14, 16, v105
v_and_b32 v15, s33, v105
v_lshlrev_b32 v16, 16, v109
v_and_b32 v17, s33, v109
v_lshlrev_b32 v18, 16, v113
v_and_b32 v19, s33, v113
v_lshlrev_b32 v20, 16, v117
v_and_b32 v21, s33, v117
v_lshlrev_b32 v22, 16, v121
v_and_b32 v23, s33, v121
v_lshlrev_b32 v24, 16, v125
v_and_b32 v25, s33, v125
v_pk_add_f32 v[46:47], v[10:11], v[22:23]
v_pk_add_f32 v[48:49], v[12:13], v[20:21]
v_pk_add_f32 v[50:51], v[14:15], v[18:19]
v_pk_fma_f32 v[46:47], v[16:17], s[56:57], v[46:47]
v_pk_fma_f32 v[46:47], v[48:49], s[52:53], v[46:47]
v_pk_fma_f32 v[46:47], v[50:51], s[54:55], v[46:47]
v_pk_add_f32 v[8:9], v[10:11], v[8:9] neg_lo:[0,1] neg_hi:[0,1]
v_pk_add_f32 v[10:11], v[12:13], v[10:11] neg_lo:[0,1] neg_hi:[0,1]
v_pk_add_f32 v[12:13], v[14:15], v[12:13] neg_lo:[0,1] neg_hi:[0,1]
v_pk_add_f32 v[14:15], v[16:17], v[14:15] neg_lo:[0,1] neg_hi:[0,1]
v_pk_add_f32 v[16:17], v[18:19], v[16:17] neg_lo:[0,1] neg_hi:[0,1]
v_pk_add_f32 v[18:19], v[20:21], v[18:19] neg_lo:[0,1] neg_hi:[0,1]
v_pk_add_f32 v[20:21], v[22:23], v[20:21] neg_lo:[0,1] neg_hi:[0,1]
v_pk_add_f32 v[22:23], v[24:25], v[22:23] neg_lo:[0,1] neg_hi:[0,1]
v_cvt_pk_bf16_f32 v65, v46, v47
v_pk_add_f32 v[26:27], v[8:9], v[12:13]
v_pk_add_f32 v[28:29], v[10:11], v[14:15]
v_pk_add_f32 v[30:31], v[12:13], v[16:17]
v_pk_add_f32 v[32:33], v[14:15], v[18:19]
v_pk_add_f32 v[34:35], v[16:17], v[20:21]
v_pk_add_f32 v[36:37], v[18:19], v[22:23]
v_pk_add_f32 v[46:47], v[28:29], v[32:33]
v_pk_add_f32 v[48:49], v[30:31], v[34:35]
v_pk_fma_f32 v[46:47], v[30:31], s[42:43], v[46:47]
v_pk_fma_f32 v[48:49], v[32:33], s[42:43], v[48:49]
v_pk_fma_f32 v[26:27], v[10:11], s[40:41], v[26:27]
v_pk_fma_f32 v[28:29], v[12:13], s[40:41], v[28:29]
v_pk_fma_f32 v[30:31], v[14:15], s[40:41], v[30:31]
v_pk_fma_f32 v[32:33], v[16:17], s[40:41], v[32:33]
v_pk_fma_f32 v[34:35], v[18:19], s[40:41], v[34:35]
v_pk_fma_f32 v[36:37], v[20:21], s[40:41], v[36:37]
v_pk_fma_f32 v[50:51], v[46:47], s[44:45], v[48:49]
v_pk_fma_f32 v[48:49], v[46:47], s[46:47], v[48:49]
v_pk_add_f32 v[38:39], v[26:27], v[30:31]
v_pk_add_f32 v[40:41], v[28:29], v[32:33]
v_pk_add_f32 v[42:43], v[30:31], v[34:35]
v_pk_add_f32 v[44:45], v[32:33], v[36:37]
v_cvt_pk_bf16_f32 v53, v50, v51
v_cvt_pk_bf16_f32 v57, v48, v49
v_pk_fma_f32 v[46:47], v[40:41], s[48:49], v[42:43]
v_pk_fma_f32 v[8:9], v[40:41], s[50:51], v[42:43]
v_pk_fma_f32 v[38:39], v[28:29], s[42:43], v[38:39]
v_pk_fma_f32 v[40:41], v[30:31], s[42:43], v[40:41]
v_pk_fma_f32 v[42:43], v[32:33], s[42:43], v[42:43]
v_pk_fma_f32 v[44:45], v[34:35], s[42:43], v[44:45]
v_cvt_pk_bf16_f32 v69, v46, v47
v_cvt_pk_bf16_f32 v73, v8, v9
v_pk_add_f32 v[48:49], v[40:41], v[42:43]
v_pk_add_f32 v[38:39], v[38:39], v[42:43]
v_pk_add_f32 v[44:45], v[44:45], v[40:41]
v_cvt_pk_bf16_f32 v77, v40, v41
v_cvt_pk_bf16_f32 v81, v42, v43
v_pk_mul_f32 v[38:39], v[38:39], s[58:59]
v_pk_mul_f32 v[44:45], v[44:45], s[58:59]
v_cvt_pk_bf16_f32 v61, v48, v49
v_cvt_pk_bf16_f32 v85, v38, v39
v_cvt_pk_bf16_f32 v89, v44, v45
v_lshlrev_b32 v8, 16, v94
v_and_b32 v9, s33, v94
v_lshlrev_b32 v10, 16, v98
v_and_b32 v11, s33, v98
v_lshlrev_b32 v12, 16, v102
v_and_b32 v13, s33, v102
v_lshlrev_b32 v14, 16, v106
v_and_b32 v15, s33, v106
v_lshlrev_b32 v16, 16, v110
v_and_b32 v17, s33, v110
v_lshlrev_b32 v18, 16, v114
v_and_b32 v19, s33, v114
v_lshlrev_b32 v20, 16, v118
v_and_b32 v21, s33, v118
v_lshlrev_b32 v22, 16, v122
v_and_b32 v23, s33, v122
v_lshlrev_b32 v24, 16, v126
v_and_b32 v25, s33, v126
v_pk_add_f32 v[46:47], v[10:11], v[22:23]
v_pk_add_f32 v[48:49], v[12:13], v[20:21]
v_pk_add_f32 v[50:51], v[14:15], v[18:19]
v_pk_fma_f32 v[46:47], v[16:17], s[56:57], v[46:47]
v_pk_fma_f32 v[46:47], v[48:49], s[52:53], v[46:47]
v_pk_fma_f32 v[46:47], v[50:51], s[54:55], v[46:47]
v_pk_add_f32 v[8:9], v[10:11], v[8:9] neg_lo:[0,1] neg_hi:[0,1]
v_pk_add_f32 v[10:11], v[12:13], v[10:11] neg_lo:[0,1] neg_hi:[0,1]
v_pk_add_f32 v[12:13], v[14:15], v[12:13] neg_lo:[0,1] neg_hi:[0,1]
v_pk_add_f32 v[14:15], v[16:17], v[14:15] neg_lo:[0,1] neg_hi:[0,1]
v_pk_add_f32 v[16:17], v[18:19], v[16:17] neg_lo:[0,1] neg_hi:[0,1]
v_pk_add_f32 v[18:19], v[20:21], v[18:19] neg_lo:[0,1] neg_hi:[0,1]
v_pk_add_f32 v[20:21], v[22:23], v[20:21] neg_lo:[0,1] neg_hi:[0,1]
v_pk_add_f32 v[22:23], v[24:25], v[22:23] neg_lo:[0,1] neg_hi:[0,1]
v_cvt_pk_bf16_f32 v66, v46, v47
v_pk_add_f32 v[26:27], v[8:9], v[12:13]
v_pk_add_f32 v[28:29], v[10:11], v[14:15]
v_pk_add_f32 v[30:31], v[12:13], v[16:17]
v_pk_add_f32 v[32:33], v[14:15], v[18:19]
v_pk_add_f32 v[34:35], v[16:17], v[20:21]
v_pk_add_f32 v[36:37], v[18:19], v[22:23]
v_pk_add_f32 v[46:47], v[28:29], v[32:33]
v_pk_add_f32 v[48:49], v[30:31], v[34:35]
v_pk_fma_f32 v[46:47], v[30:31], s[42:43], v[46:47]
v_pk_fma_f32 v[48:49], v[32:33], s[42:43], v[48:49]
v_pk_fma_f32 v[26:27], v[10:11], s[40:41], v[26:27]
v_pk_fma_f32 v[28:29], v[12:13], s[40:41], v[28:29]
v_pk_fma_f32 v[30:31], v[14:15], s[40:41], v[30:31]
v_pk_fma_f32 v[32:33], v[16:17], s[40:41], v[32:33]
v_pk_fma_f32 v[34:35], v[18:19], s[40:41], v[34:35]
v_pk_fma_f32 v[36:37], v[20:21], s[40:41], v[36:37]
v_pk_fma_f32 v[50:51], v[46:47], s[44:45], v[48:49]
v_pk_fma_f32 v[48:49], v[46:47], s[46:47], v[48:49]
v_pk_add_f32 v[38:39], v[26:27], v[30:31]
v_pk_add_f32 v[40:41], v[28:29], v[32:33]
v_pk_add_f32 v[42:43], v[30:31], v[34:35]
v_pk_add_f32 v[44:45], v[32:33], v[36:37]
v_cvt_pk_bf16_f32 v54, v50, v51
v_cvt_pk_bf16_f32 v58, v48, v49
v_pk_fma_f32 v[46:47], v[40:41], s[48:49], v[42:43]
v_pk_fma_f32 v[8:9], v[40:41], s[50:51], v[42:43]
v_pk_fma_f32 v[38:39], v[28:29], s[42:43], v[38:39]
v_pk_fma_f32 v[40:41], v[30:31], s[42:43], v[40:41]
v_pk_fma_f32 v[42:43], v[32:33], s[42:43], v[42:43]
v_pk_fma_f32 v[44:45], v[34:35], s[42:43], v[44:45]
v_cvt_pk_bf16_f32 v70, v46, v47
v_cvt_pk_bf16_f32 v74, v8, v9
v_pk_add_f32 v[48:49], v[40:41], v[42:43]
v_pk_add_f32 v[38:39], v[38:39], v[42:43]
v_pk_add_f32 v[44:45], v[44:45], v[40:41]
v_cvt_pk_bf16_f32 v78, v40, v41
v_cvt_pk_bf16_f32 v82, v42, v43
v_pk_mul_f32 v[38:39], v[38:39], s[58:59]
v_pk_mul_f32 v[44:45], v[44:45], s[58:59]
v_cvt_pk_bf16_f32 v62, v48, v49
v_cvt_pk_bf16_f32 v86, v38, v39
v_cvt_pk_bf16_f32 v90, v44, v45
v_lshlrev_b32 v8, 16, v95
v_and_b32 v9, s33, v95
v_lshlrev_b32 v10, 16, v99
v_and_b32 v11, s33, v99
v_lshlrev_b32 v12, 16, v103
v_and_b32 v13, s33, v103
v_lshlrev_b32 v14, 16, v107
v_and_b32 v15, s33, v107
v_lshlrev_b32 v16, 16, v111
v_and_b32 v17, s33, v111
v_lshlrev_b32 v18, 16, v115
v_and_b32 v19, s33, v115
v_lshlrev_b32 v20, 16, v119
v_and_b32 v21, s33, v119
v_lshlrev_b32 v22, 16, v123
v_and_b32 v23, s33, v123
v_lshlrev_b32 v24, 16, v127
v_and_b32 v25, s33, v127
v_pk_add_f32 v[46:47], v[10:11], v[22:23]
v_pk_add_f32 v[48:49], v[12:13], v[20:21]
v_pk_add_f32 v[50:51], v[14:15], v[18:19]
v_pk_fma_f32 v[46:47], v[16:17], s[56:57], v[46:47]
v_pk_fma_f32 v[46:47], v[48:49], s[52:53], v[46:47]
v_pk_fma_f32 v[46:47], v[50:51], s[54:55], v[46:47]
v_pk_add_f32 v[8:9], v[10:11], v[8:9] neg_lo:[0,1] neg_hi:[0,1]
v_pk_add_f32 v[10:11], v[12:13], v[10:11] neg_lo:[0,1] neg_hi:[0,1]
v_pk_add_f32 v[12:13], v[14:15], v[12:13] neg_lo:[0,1] neg_hi:[0,1]
v_pk_add_f32 v[14:15], v[16:17], v[14:15] neg_lo:[0,1] neg_hi:[0,1]
v_pk_add_f32 v[16:17], v[18:19], v[16:17] neg_lo:[0,1] neg_hi:[0,1]
v_pk_add_f32 v[18:19], v[20:21], v[18:19] neg_lo:[0,1] neg_hi:[0,1]
v_pk_add_f32 v[20:21], v[22:23], v[20:21] neg_lo:[0,1] neg_hi:[0,1]
v_pk_add_f32 v[22:23], v[24:25], v[22:23] neg_lo:[0,1] neg_hi:[0,1]
v_cvt_pk_bf16_f32 v67, v46, v47
s_add_u32 s29, s28, 9842688
buffer_store_dwordx4 v[64:67], v3, s[12:15], s29 offen sc1
v_pk_add_f32 v[26:27], v[8:9], v[12:13]
v_pk_add_f32 v[28:29], v[10:11], v[14:15]
v_pk_add_f32 v[30:31], v[12:13], v[16:17]
v_pk_add_f32 v[32:33], v[14:15], v[18:19]
v_pk_add_f32 v[34:35], v[16:17], v[20:21]
v_pk_add_f32 v[36:37], v[18:19], v[22:23]
v_pk_add_f32 v[46:47], v[28:29], v[32:33]
v_pk_add_f32 v[48:49], v[30:31], v[34:35]
v_pk_fma_f32 v[46:47], v[30:31], s[42:43], v[46:47]
v_pk_fma_f32 v[48:49], v[32:33], s[42:43], v[48:49]
v_pk_fma_f32 v[26:27], v[10:11], s[40:41], v[26:27]
v_pk_fma_f32 v[28:29], v[12:13], s[40:41], v[28:29]
v_pk_fma_f32 v[30:31], v[14:15], s[40:41], v[30:31]
v_pk_fma_f32 v[32:33], v[16:17], s[40:41], v[32:33]
v_pk_fma_f32 v[34:35], v[18:19], s[40:41], v[34:35]
v_pk_fma_f32 v[36:37], v[20:21], s[40:41], v[36:37]
v_pk_fma_f32 v[50:51], v[46:47], s[44:45], v[48:49]
v_pk_fma_f32 v[48:49], v[46:47], s[46:47], v[48:49]
v_pk_add_f32 v[38:39], v[26:27], v[30:31]
v_pk_add_f32 v[40:41], v[28:29], v[32:33]
v_pk_add_f32 v[42:43], v[30:31], v[34:35]
v_pk_add_f32 v[44:45], v[32:33], v[36:37]
v_cvt_pk_bf16_f32 v55, v50, v51
s_add_u32 s29, s28, 0
buffer_store_dwordx4 v[52:55], v3, s[12:15], s29 offen sc1
v_cvt_pk_bf16_f32 v59, v48, v49
s_add_u32 s29, s28, 3280896
buffer_store_dwordx4 v[56:59], v3, s[12:15], s29 offen sc1
v_pk_fma_f32 v[46:47], v[40:41], s[48:49], v[42:43]
v_pk_fma_f32 v[8:9], v[40:41], s[50:51], v[42:43]
v_pk_fma_f32 v[38:39], v[28:29], s[42:43], v[38:39]
v_pk_fma_f32 v[40:41], v[30:31], s[42:43], v[40:41]
v_pk_fma_f32 v[42:43], v[32:33], s[42:43], v[42:43]
v_pk_fma_f32 v[44:45], v[34:35], s[42:43], v[44:45]
v_cvt_pk_bf16_f32 v71, v46, v47
s_add_u32 s29, s28, 13123584
buffer_store_dwordx4 v[68:71], v3, s[12:15], s29 offen sc1
v_cvt_pk_bf16_f32 v75, v8, v9
s_add_u32 s29, s28, 16404480
buffer_store_dwordx4 v[72:75], v3, s[12:15], s29 offen sc1
v_pk_add_f32 v[48:49], v[40:41], v[42:43]
v_pk_add_f32 v[38:39], v[38:39], v[42:43]
v_pk_add_f32 v[44:45], v[44:45], v[40:41]
v_cvt_pk_bf16_f32 v79, v40, v41
s_add_u32 s29, s28, 19685376
buffer_store_dwordx4 v[76:79], v3, s[12:15], s29 offen sc1
v_cvt_pk_bf16_f32 v83, v42, v43
s_add_u32 s29, s28, 22966272
buffer_store_dwordx4 v[80:83], v3, s[12:15], s29 offen sc1
v_pk_mul_f32 v[38:39], v[38:39], s[58:59]
v_pk_mul_f32 v[44:45], v[44:45], s[58:59]
v_cvt_pk_bf16_f32 v63, v48, v49
s_add_u32 s29, s28, 6561792
buffer_store_dwordx4 v[60:63], v3, s[12:15], s29 offen sc1
v_cvt_pk_bf16_f32 v87, v38, v39
s_add_u32 s29, s28, 26247168
buffer_store_dwordx4 v[84:87], v3, s[12:15], s29 offen sc1
v_cvt_pk_bf16_f32 v91, v44, v45
s_add_u32 s29, s28, 29528064
buffer_store_dwordx4 v[88:91], v3, s[12:15], s29 offen sc1
LP_end:
LP_end2:
s_endpgm
LP_W:
s_and_b32 s20, s2, 1
s_bfe_u32 s21, s2, 0x50001
s_lshr_b32 s22, s2, 6
v_lshlrev_b32 v1, 11, v4
v_bfe_u32 v2, v0, 5, 1
v_lshl_add_u32 v1, v2, 10, v1
v_and_b32 v3, 31, v0
v_lshl_add_u32 v1, v3, 4, v1
s_lshl_b32 s23, s20, 9
s_lshl_b32 s24, s21, 13
s_add_u32 s23, s23, s24
s_mul_i32 s25, s22, 1310720
s_add_u32 s23, s23, s25
s_mul_i32 s26, s26, 1088
s_mov_b32 s10, 3932160
s_mov_b32 m0, s26
s_waitcnt lgkmcnt(0)
s_mov_b32 s8, s18
s_mov_b32 s9, s19
buffer_load_dwordx4 v1, s[8:11], s23 offen nt lds
s_add_u32 m0, m0, 4352
s_add_u32 s23, s23, 262144
buffer_load_dwordx4 v1, s[8:11], s23 offen nt lds
s_add_u32 m0, m0, 4352
s_add_u32 s23, s23, 262144
buffer_load_dwordx4 v1, s[8:11], s23 offen nt lds
s_add_u32 m0, m0, 4352
s_add_u32 s23, s23, 262144
buffer_load_dwordx4 v1, s[8:11], s23 offen nt lds
s_add_u32 m0, m0, 4352
s_add_u32 s23, s23, 262144
buffer_load_dwordx4 v1, s[8:11], s23 offen nt lds
s_mov_b32 s12, s6
s_mov_b32 s13, s7
s_mov_b32 s14, 7864320
v_lshrrev_b32 v3, 4, v0
v_mul_u32_u24 v3, 491520, v3
v_and_b32 v4, 15, v0
v_lshl_add_u32 v3, v4, 4, v3
s_bfe_u32 s28, s21, 0x30001
s_and_b32 s29, s21, 1
s_lshl_b32 s29, s29, 1
s_lshr_b32 s30, s21, 4
s_add_u32 s29, s29, s30
s_lshl_b32 s29, s29, 8
s_mul_i32 s28, s28, 6
s_mul_i32 s30, s20, 3
s_add_u32 s28, s28, s30
s_add_u32 s28, s28, s22
s_lshl_b32 s28, s28, 10
s_add_u32 s28, s28, s29
v_bfe_u32 v1, v0, 3, 1
v_mul_u32_u24 v1, 1088, v1
v_bfe_u32 v2, v0, 2, 1
v_lshlrev_b32 v2, 9, v2
v_lshrrev_b32 v4, 4, v0
v_lshlrev_b32 v4, 5, v4
v_add3_u32 v1, v1, v2, v4
v_and_b32 v2, 3, v0
v_lshl_add_u32 v1, v2, 3, v1
s_cmp_eq_u32 s20, 0
s_cselect_b32 s38, 2.0, -1.0
s_waitcnt vmcnt(0)
s_barrier
ds_read_b64_tr_b16 v[48:49], v1 offset:0
ds_read_b64_tr_b16 v[50:51], v1 offset:2176
ds_read_b64_tr_b16 v[52:53], v1 offset:4352
ds_read_b64_tr_b16 v[54:55], v1 offset:6528
ds_read_b64_tr_b16 v[56:57], v1 offset:8704
ds_read_b64_tr_b16 v[58:59], v1 offset:10880
ds_read_b64_tr_b16 v[60:61], v1 offset:13056
ds_read_b64_tr_b16 v[62:63], v1 offset:15232
ds_read_b64_tr_b16 v[64:65], v1 offset:17408
ds_read_b64_tr_b16 v[66:67], v1 offset:19584
s_waitcnt lgkmcnt(8)
v_lshlrev_b32 v8, 16, v48
v_and_b32 v9, s33, v48
v_lshlrev_b32 v10, 16, v49
v_and_b32 v11, s33, v49
v_lshlrev_b32 v12, 16, v50
v_and_b32 v13, s33, v50
v_lshlrev_b32 v14, 16, v51
v_and_b32 v15, s33, v51
v_mul_f32 v8, s38, v8
v_mul_f32 v9, s38, v9
v_mul_f32 v10, s38, v10
v_mul_f32 v11, s38, v11
v_mul_f32 v12, s38, v12
v_mul_f32 v13, s38, v13
v_mul_f32 v14, s38, v14
v_mul_f32 v15, s38, v15
s_waitcnt lgkmcnt(6)
v_lshlrev_b32 v16, 16, v52
v_and_b32 v17, s33, v52
v_lshlrev_b32 v18, 16, v53
v_and_b32 v19, s33, v53
v_lshlrev_b32 v20, 16, v54
v_and_b32 v21, s33, v54
v_lshlrev_b32 v22, 16, v55
v_and_b32 v23, s33, v55
v_mul_f32 v16, s38, v16
v_mul_f32 v17, s38, v17
v_mul_f32 v18, s38, v18
v_mul_f32 v19, s38, v19
v_mul_f32 v20, s38, v20
v_mul_f32 v21, s38, v21
v_mul_f32 v22, s38, v22
v_mul_f32 v23, s38, v23
s_waitcnt lgkmcnt(4)
v_lshlrev_b32 v24, 16, v56
v_and_b32 v25, s33, v56
v_lshlrev_b32 v26, 16, v57
v_and_b32 v27, s33, v57
v_lshlrev_b32 v28, 16, v58
v_and_b32 v29, s33, v58
v_lshlrev_b32 v30, 16, v59
v_and_b32 v31, s33, v59
v_mul_f32 v24, s38, v24
v_mul_f32 v25, s38, v25
v_mul_f32 v26, s38, v26
v_mul_f32 v27, s38, v27
v_mul_f32 v28, s38, v28
v_mul_f32 v29, s38, v29
v_mul_f32 v30, s38, v30
v_mul_f32 v31, s38, v31
s_waitcnt lgkmcnt(2)
v_lshlrev_b32 v32, 16, v60
v_and_b32 v33, s33, v60
v_lshlrev_b32 v34, 16, v61
v_and_b32 v35, s33, v61
v_lshlrev_b32 v36, 16, v62
v_and_b32 v37, s33, v62
v_lshlrev_b32 v38, 16, v63
v_and_b32 v39, s33, v63
v_mul_f32 v32, s38, v32
v_mul_f32 v33, s38, v33
v_mul_f32 v34, s38, v34
v_mul_f32 v35, s38, v35
v_mul_f32 v36, s38, v36
v_mul_f32 v37, s38, v37
v_mul_f32 v38, s38, v38
v_mul_f32 v39, s38, v39
s_waitcnt lgkmcnt(0)
v_lshlrev_b32 v40, 16, v64
v_and_b32 v41, s33, v64
v_lshlrev_b32 v42, 16, v65
v_and_b32 v43, s33, v65
v_lshlrev_b32 v44, 16, v66
v_and_b32 v45, s33, v66
v_lshlrev_b32 v46, 16, v67
v_and_b32 v47, s33, v67
v_mul_f32 v40, s38, v40
v_mul_f32 v41, s38, v41
v_mul_f32 v42, s38, v42
v_mul_f32 v43, s38, v43
v_mul_f32 v44, s38, v44
v_mul_f32 v45, s38, v45
v_mul_f32 v46, s38, v46
v_mul_f32 v47, s38, v47
v_mul_f32 v68, 0x402b2077, v8
v_mul_f32 v69, 0x402b2077, v9
v_mul_f32 v70, 0x402b2077, v10
v_mul_f32 v71, 0x402b2077, v11
v_mul_f32 v72, 0x402b2077, v12
v_mul_f32 v73, 0x402b2077, v13
v_mul_f32 v74, 0x402b2077, v14
v_mul_f32 v75, 0x402b2077, v15
v_fmac_f32 v68, 0xc055e894, v16
v_fmac_f32 v69, 0xc055e894, v17
v_fmac_f32 v70, 0xc055e894, v18
v_fmac_f32 v71, 0xc055e894, v19
v_fmac_f32 v72, 0xc055e894, v20
v_fmac_f32 v73, 0xc055e894, v21
v_fmac_f32 v74, 0xc055e894, v22
v_fmac_f32 v75, 0xc055e894, v23
v_fmac_f32 v68, 0x4085b15d, v24
v_fmac_f32 v69, 0x4085b15d, v25
v_fmac_f32 v70, 0x4085b15d, v26
v_fmac_f32 v71, 0x4085b15d, v27
v_fmac_f32 v72, 0x4085b15d, v28
v_fmac_f32 v73, 0x4085b15d, v29
v_fmac_f32 v74, 0x4085b15d, v30
v_fmac_f32 v75, 0x4085b15d, v31
v_fmac_f32 v68, 0xc0a71db4, v32
v_fmac_f32 v69, 0xc0a71db4, v33
v_fmac_f32 v70, 0xc0a71db4, v34
v_fmac_f32 v71, 0xc0a71db4, v35
v_fmac_f32 v72, 0xc0a71db4, v36
v_fmac_f32 v73, 0xc0a71db4, v37
v_fmac_f32 v74, 0xc0a71db4, v38
v_fmac_f32 v75, 0xc0a71db4, v39
v_fmac_f32 v68, 0x40d0e521, v40
v_fmac_f32 v69, 0x40d0e521, v41
v_fmac_f32 v70, 0x40d0e521, v42
v_fmac_f32 v71, 0x40d0e521, v43
v_fmac_f32 v72, 0x40d0e521, v44
v_fmac_f32 v73, 0x40d0e521, v45
v_fmac_f32 v74, 0x40d0e521, v46
v_fmac_f32 v75, 0x40d0e521, v47
v_cvt_pk_bf16_f32 v84, v68, v69
v_cvt_pk_bf16_f32 v85, v70, v71
v_cvt_pk_bf16_f32 v86, v72, v73
v_cvt_pk_bf16_f32 v87, v74, v75
buffer_store_dwordx4 v[84:87], v3, s[12:15], s28 offen sc1
s_add_u32 s28, s28, 49152
v_mul_f32 v76, 0xc0a71db4, v8
v_mul_f32 v77, 0xc0a71db4, v9
v_mul_f32 v78, 0xc0a71db4, v10
v_mul_f32 v79, 0xc0a71db4, v11
v_mul_f32 v80, 0xc0a71db4, v12
v_mul_f32 v81, 0xc0a71db4, v13
v_mul_f32 v82, 0xc0a71db4, v14
v_mul_f32 v83, 0xc0a71db4, v15
v_fmac_f32 v76, 0x4085b15d, v16
v_fmac_f32 v77, 0x4085b15d, v17
v_fmac_f32 v78, 0x4085b15d, v18
v_fmac_f32 v79, 0x4085b15d, v19
v_fmac_f32 v80, 0x4085b15d, v20
v_fmac_f32 v81, 0x4085b15d, v21
v_fmac_f32 v82, 0x4085b15d, v22
v_fmac_f32 v83, 0x4085b15d, v23
v_fmac_f32 v76, 0xc055e894, v24
v_fmac_f32 v77, 0xc055e894, v25
v_fmac_f32 v78, 0xc055e894, v26
v_fmac_f32 v79, 0xc055e894, v27
v_fmac_f32 v80, 0xc055e894, v28
v_fmac_f32 v81, 0xc055e894, v29
v_fmac_f32 v82, 0xc055e894, v30
v_fmac_f32 v83, 0xc055e894, v31
v_fmac_f32 v76, 0x402b2077, v32
v_fmac_f32 v77, 0x402b2077, v33
v_fmac_f32 v78, 0x402b2077, v34
v_fmac_f32 v79, 0x402b2077, v35
v_fmac_f32 v80, 0x402b2077, v36
v_fmac_f32 v81, 0x402b2077, v37
v_fmac_f32 v82, 0x402b2077, v38
v_fmac_f32 v83, 0x402b2077, v39
v_fmac_f32 v76, 0xc008e6c5, v40
v_fmac_f32 v77, 0xc008e6c5, v41
v_fmac_f32 v78, 0xc008e6c5, v42
v_fmac_f32 v79, 0xc008e6c5, v43
v_fmac_f32 v80, 0xc008e6c5, v44
v_fmac_f32 v81, 0xc008e6c5, v45
v_fmac_f32 v82, 0xc008e6c5, v46
v_fmac_f32 v83, 0xc008e6c5, v47
v_cvt_pk_bf16_f32 v88, v76, v77
v_cvt_pk_bf16_f32 v89, v78, v79
v_cvt_pk_bf16_f32 v90, v80, v81
v_cvt_pk_bf16_f32 v91, v82, v83
buffer_store_dwordx4 v[88:91], v3, s[12:15], s28 offen sc1
s_add_u32 s28, s28, 49152
v_mul_f32 v68, 0xbe14817a, v8
v_mul_f32 v69, 0xbe14817a, v9
v_mul_f32 v70, 0xbe14817a, v10
v_mul_f32 v71, 0xbe14817a, v11
v_mul_f32 v72, 0xbe14817a, v12
v_mul_f32 v73, 0xbe14817a, v13
v_mul_f32 v74, 0xbe14817a, v14
v_mul_f32 v75, 0xbe14817a, v15
v_fmac_f32 v68, 0xbe14817a, v16
v_fmac_f32 v69, 0xbe14817a, v17
v_fmac_f32 v70, 0xbe14817a, v18
v_fmac_f32 v71, 0xbe14817a, v19
v_fmac_f32 v72, 0xbe14817a, v20
v_fmac_f32 v73, 0xbe14817a, v21
v_fmac_f32 v74, 0xbe14817a, v22
v_fmac_f32 v75, 0xbe14817a, v23
v_fmac_f32 v68, 0x3e14817a, v24
v_fmac_f32 v69, 0x3e14817a, v25
v_fmac_f32 v70, 0x3e14817a, v26
v_fmac_f32 v71, 0x3e14817a, v27
v_fmac_f32 v72, 0x3e14817a, v28
v_fmac_f32 v73, 0x3e14817a, v29
v_fmac_f32 v74, 0x3e14817a, v30
v_fmac_f32 v75, 0x3e14817a, v31
v_fmac_f32 v68, 0x3e14817a, v32
v_fmac_f32 v69, 0x3e14817a, v33
v_fmac_f32 v70, 0x3e14817a, v34
v_fmac_f32 v71, 0x3e14817a, v35
v_fmac_f32 v72, 0x3e14817a, v36
v_fmac_f32 v73, 0x3e14817a, v37
v_fmac_f32 v74, 0x3e14817a, v38
v_fmac_f32 v75, 0x3e14817a, v39
v_fmac_f32 v68, 0xbe14817a, v40
v_fmac_f32 v69, 0xbe14817a, v41
v_fmac_f32 v70, 0xbe14817a, v42
v_fmac_f32 v71, 0xbe14817a, v43
v_fmac_f32 v72, 0xbe14817a, v44
v_fmac_f32 v73, 0xbe14817a, v45
v_fmac_f32 v74, 0xbe14817a, v46
v_fmac_f32 v75, 0xbe14817a, v47
v_cvt_pk_bf16_f32 v92, v68, v69
v_cvt_pk_bf16_f32 v93, v70, v71
v_cvt_pk_bf16_f32 v94, v72, v73
v_cvt_pk_bf16_f32 v95, v74, v75
buffer_store_dwordx4 v[92:95], v3, s[12:15], s28 offen sc1
s_add_u32 s28, s28, 49152
v_mul_f32 v76, 0xbf55e894, v8
v_mul_f32 v77, 0xbf55e894, v9
v_mul_f32 v78, 0xbf55e894, v10
v_mul_f32 v79, 0xbf55e894, v11
v_mul_f32 v80, 0xbf55e894, v12
v_mul_f32 v81, 0xbf55e894, v13
v_mul_f32 v82, 0xbf55e894, v14
v_mul_f32 v83, 0xbf55e894, v15
v_fmac_f32 v76, 0xbf55e894, v16
v_fmac_f32 v77, 0xbf55e894, v17
v_fmac_f32 v78, 0xbf55e894, v18
v_fmac_f32 v79, 0xbf55e894, v19
v_fmac_f32 v80, 0xbf55e894, v20
v_fmac_f32 v81, 0xbf55e894, v21
v_fmac_f32 v82, 0xbf55e894, v22
v_fmac_f32 v83, 0xbf55e894, v23
v_fmac_f32 v76, 0xbf55e894, v24
v_fmac_f32 v77, 0xbf55e894, v25
v_fmac_f32 v78, 0xbf55e894, v26
v_fmac_f32 v79, 0xbf55e894, v27
v_fmac_f32 v80, 0xbf55e894, v28
v_fmac_f32 v81, 0xbf55e894, v29
v_fmac_f32 v82, 0xbf55e894, v30
v_fmac_f32 v83, 0xbf55e894, v31
v_fmac_f32 v76, 0xbf55e894, v32
v_fmac_f32 v77, 0xbf55e894, v33
v_fmac_f32 v78, 0xbf55e894, v34
v_fmac_f32 v79, 0xbf55e894, v35
v_fmac_f32 v80, 0xbf55e894, v36
v_fmac_f32 v81, 0xbf55e894, v37
v_fmac_f32 v82, 0xbf55e894, v38
v_fmac_f32 v83, 0xbf55e894, v39
v_fmac_f32 v76, 0xbf55e894, v40
v_fmac_f32 v77, 0xbf55e894, v41
v_fmac_f32 v78, 0xbf55e894, v42
v_fmac_f32 v79, 0xbf55e894, v43
v_fmac_f32 v80, 0xbf55e894, v44
v_fmac_f32 v81, 0xbf55e894, v45
v_fmac_f32 v82, 0xbf55e894, v46
v_fmac_f32 v83, 0xbf55e894, v47
v_cvt_pk_bf16_f32 v96, v76, v77
v_cvt_pk_bf16_f32 v97, v78, v79
v_cvt_pk_bf16_f32 v98, v80, v81
v_cvt_pk_bf16_f32 v99, v82, v83
buffer_store_dwordx4 v[96:99], v3, s[12:15], s28 offen sc1
s_add_u32 s28, s28, 49152
v_mul_f32 v68, 0xbe961c7a, v8
v_mul_f32 v69, 0xbe961c7a, v9
v_mul_f32 v70, 0xbe961c7a, v10
v_mul_f32 v71, 0xbe961c7a, v11
v_mul_f32 v72, 0xbe961c7a, v12
v_mul_f32 v73, 0xbe961c7a, v13
v_mul_f32 v74, 0xbe961c7a, v14
v_mul_f32 v75, 0xbe961c7a, v15
v_fmac_f32 v68, 0xbf0e9b0d, v16
v_fmac_f32 v69, 0xbf0e9b0d, v17
v_fmac_f32 v70, 0xbf0e9b0d, v18
v_fmac_f32 v71, 0xbf0e9b0d, v19
v_fmac_f32 v72, 0xbf0e9b0d, v20
v_fmac_f32 v73, 0xbf0e9b0d, v21
v_fmac_f32 v74, 0xbf0e9b0d, v22
v_fmac_f32 v75, 0xbf0e9b0d, v23
v_fmac_f32 v68, 0xbf8779b3, v24
v_fmac_f32 v69, 0xbf8779b3, v25
v_fmac_f32 v70, 0xbf8779b3, v26
v_fmac_f32 v71, 0xbf8779b3, v27
v_fmac_f32 v72, 0xbf8779b3, v28
v_fmac_f32 v73, 0xbf8779b3, v29
v_fmac_f32 v74, 0xbf8779b3, v30
v_fmac_f32 v75, 0xbf8779b3, v31
v_fmac_f32 v68, 0xc000b39d, v32
v_fmac_f32 v69, 0xc000b39d, v33
v_fmac_f32 v70, 0xc000b39d, v34
v_fmac_f32 v71, 0xc000b39d, v35
v_fmac_f32 v72, 0xc000b39d, v36
v_fmac_f32 v73, 0xc000b39d, v37
v_fmac_f32 v74, 0xc000b39d, v38
v_fmac_f32 v75, 0xc000b39d, v39
v_fmac_f32 v68, 0xc0748878, v40
v_fmac_f32 v69, 0xc0748878, v41
v_fmac_f32 v70, 0xc0748878, v42
v_fmac_f32 v71, 0xc0748878, v43
v_fmac_f32 v72, 0xc0748878, v44
v_fmac_f32 v73, 0xc0748878, v45
v_fmac_f32 v74, 0xc0748878, v46
v_fmac_f32 v75, 0xc0748878, v47
v_cvt_pk_bf16_f32 v100, v68, v69
v_cvt_pk_bf16_f32 v101, v70, v71
v_cvt_pk_bf16_f32 v102, v72, v73
v_cvt_pk_bf16_f32 v103, v74, v75
buffer_store_dwordx4 v[100:103], v3, s[12:15], s28 offen sc1
s_add_u32 s28, s28, 49152
v_mul_f32 v76, 0xc179a303, v8
v_mul_f32 v77, 0xc179a303, v9
v_mul_f32 v78, 0xc179a303, v10
v_mul_f32 v79, 0xc179a303, v11
v_mul_f32 v80, 0xc179a303, v12
v_mul_f32 v81, 0xc179a303, v13
v_mul_f32 v82, 0xc179a303, v14
v_mul_f32 v83, 0xc179a303, v15
v_fmac_f32 v76, 0xc1036345, v16
v_fmac_f32 v77, 0xc1036345, v17
v_fmac_f32 v78, 0xc1036345, v18
v_fmac_f32 v79, 0xc1036345, v19
v_fmac_f32 v80, 0xc1036345, v20
v_fmac_f32 v81, 0xc1036345, v21
v_fmac_f32 v82, 0xc1036345, v22
v_fmac_f32 v83, 0xc1036345, v23
v_fmac_f32 v76, 0xc08a4d8c, v24
v_fmac_f32 v77, 0xc08a4d8c, v25
v_fmac_f32 v78, 0xc08a4d8c, v26
v_fmac_f32 v79, 0xc08a4d8c, v27
v_fmac_f32 v80, 0xc08a4d8c, v28
v_fmac_f32 v81, 0xc08a4d8c, v29
v_fmac_f32 v82, 0xc08a4d8c, v30
v_fmac_f32 v83, 0xc08a4d8c, v31
v_fmac_f32 v76, 0xc01194ff, v32
v_fmac_f32 v77, 0xc01194ff, v33
v_fmac_f32 v78, 0xc01194ff, v34
v_fmac_f32 v79, 0xc01194ff, v35
v_fmac_f32 v80, 0xc01194ff, v36
v_fmac_f32 v81, 0xc01194ff, v37
v_fmac_f32 v82, 0xc01194ff, v38
v_fmac_f32 v83, 0xc01194ff, v39
v_fmac_f32 v76, 0xbf993e86, v40
v_fmac_f32 v77, 0xbf993e86, v41
v_fmac_f32 v78, 0xbf993e86, v42
v_fmac_f32 v79, 0xbf993e86, v43
v_fmac_f32 v80, 0xbf993e86, v44
v_fmac_f32 v81, 0xbf993e86, v45
v_fmac_f32 v82, 0xbf993e86, v46
v_fmac_f32 v83, 0xbf993e86, v47
v_cvt_pk_bf16_f32 v104, v76, v77
v_cvt_pk_bf16_f32 v105, v78, v79
v_cvt_pk_bf16_f32 v106, v80, v81
v_cvt_pk_bf16_f32 v107, v82, v83
buffer_store_dwordx4 v[104:107], v3, s[12:15], s28 offen sc1
s_add_u32 s28, s28, 49152
v_mul_f32 v68, 0x3e94817a, v16
v_mul_f32 v69, 0x3e94817a, v17
v_mul_f32 v70, 0x3e94817a, v18
v_mul_f32 v71, 0x3e94817a, v19
v_mul_f32 v72, 0x3e94817a, v20
v_mul_f32 v73, 0x3e94817a, v21
v_mul_f32 v74, 0x3e94817a, v22
v_mul_f32 v75, 0x3e94817a, v23
v_fmac_f32 v68, 0xbe94817a, v32
v_fmac_f32 v69, 0xbe94817a, v33
v_fmac_f32 v70, 0xbe94817a, v34
v_fmac_f32 v71, 0xbe94817a, v35
v_fmac_f32 v72, 0xbe94817a, v36
v_fmac_f32 v73, 0xbe94817a, v37
v_fmac_f32 v74, 0xbe94817a, v38
v_fmac_f32 v75, 0xbe94817a, v39
v_cvt_pk_bf16_f32 v108, v68, v69
v_cvt_pk_bf16_f32 v109, v70, v71
v_cvt_pk_bf16_f32 v110, v72, v73
v_cvt_pk_bf16_f32 v111, v74, v75
buffer_store_dwordx4 v[108:111], v3, s[12:15], s28 offen sc1
s_add_u32 s28, s28, 49152
v_mul_f32 v76, 0xbe94817a, v8
v_mul_f32 v77, 0xbe94817a, v9
v_mul_f32 v78, 0xbe94817a, v10
v_mul_f32 v79, 0xbe94817a, v11
v_mul_f32 v80, 0xbe94817a, v12
v_mul_f32 v81, 0xbe94817a, v13
v_mul_f32 v82, 0xbe94817a, v14
v_mul_f32 v83, 0xbe94817a, v15
v_fmac_f32 v76, 0x3e94817a, v24
v_fmac_f32 v77, 0x3e94817a, v25
v_fmac_f32 v78, 0x3e94817a, v26
v_fmac_f32 v79, 0x3e94817a, v27
v_fmac_f32 v80, 0x3e94817a, v28
v_fmac_f32 v81, 0x3e94817a, v29
v_fmac_f32 v82, 0x3e94817a, v30
v_fmac_f32 v83, 0x3e94817a, v31
v_fmac_f32 v76, 0xbe94817a, v40
v_fmac_f32 v77, 0xbe94817a, v41
v_fmac_f32 v78, 0xbe94817a, v42
v_fmac_f32 v79, 0xbe94817a, v43
v_fmac_f32 v80, 0xbe94817a, v44
v_fmac_f32 v81, 0xbe94817a, v45
v_fmac_f32 v82, 0xbe94817a, v46
v_fmac_f32 v83, 0xbe94817a, v47
v_cvt_pk_bf16_f32 v112, v76, v77
v_cvt_pk_bf16_f32 v113, v78, v79
v_cvt_pk_bf16_f32 v114, v80, v81
v_cvt_pk_bf16_f32 v115, v82, v83
buffer_store_dwordx4 v[112:115], v3, s[12:15], s28 offen sc1
s_add_u32 s28, s28, 49152
v_mul_f32 v68, 0xbf800000, v8
v_mul_f32 v69, 0xbf800000, v9
v_mul_f32 v70, 0xbf800000, v10
v_mul_f32 v71, 0xbf800000, v11
v_mul_f32 v72, 0xbf800000, v12
v_mul_f32 v73, 0xbf800000, v13
v_mul_f32 v74, 0xbf800000, v14
v_mul_f32 v75, 0xbf800000, v15
v_cvt_pk_bf16_f32 v84, v68, v69
v_cvt_pk_bf16_f32 v85, v70, v71
v_cvt_pk_bf16_f32 v86, v72, v73
v_cvt_pk_bf16_f32 v87, v74, v75
buffer_store_dwordx4 v[84:87], v3, s[12:15], s28 offen sc1
s_add_u32 s28, s28, 49152
v_mul_f32 v76, 0x3f800000, v40
v_mul_f32 v77, 0x3f800000, v41
v_mul_f32 v78, 0x3f800000, v42
v_mul_f32 v79, 0x3f800000, v43
v_mul_f32 v80, 0x3f800000, v44
v_mul_f32 v81, 0x3f800000, v45
v_mul_f32 v82, 0x3f800000, v46
v_mul_f32 v83, 0x3f800000, v47
v_cvt_pk_bf16_f32 v88, v76, v77
v_cvt_pk_bf16_f32 v89, v78, v79
v_cvt_pk_bf16_f32 v90, v80, v81
v_cvt_pk_bf16_f32 v91, v82, v83
buffer_store_dwordx4 v[88:91], v3, s[12:15], s28 offen sc1
s_add_u32 s28, s28, 49152
s_endpgm
LP_cw:
s_getpc_b64 s[44:45]
LP_pc:
s_add_u32 s44, s44, standalone__autoregressive_conv_wavernn__speech_kernel-LP_pc
s_addc_u32 s45, s45, 0
s_mov_b32 s46, L_end-standalone__autoregressive_conv_wavernn__speech_kernel
s_mov_b32 s47, 0x20000
s_lshr_b32 s48, s2, 3
s_lshl_b32 s48, s48, 15
v_lshlrev_b32 v6, 7, v0
v_add_u32 v6, s48, v6
buffer_load_dword v7, v6, s[44:47], 0 offen
s_endpgm
.globl standalone__autoregressive_conv_wavernn__speech_kernel
.p2align 8
.type standalone__autoregressive_conv_wavernn__speech_kernel,@function
standalone__autoregressive_conv_wavernn__speech_kernel:
s_cmp_ge_u32 s2, 232
s_cbranch_scc1 L_end
s_load_dwordx2 s[6:7], s[0:1], 16
s_load_dwordx2 s[26:27], s[0:1], 32
s_and_b32 s31, s2, 3
s_bfe_u32 s33, s2, 0x10002
s_lshr_b32 s30, s2, 3
s_and_b32 s32, s30, 3
s_mul_i32 s34, s31, 7
s_lshr_b32 s35, s30, 2
s_add_u32 s34, s34, s35
s_cmp_eq_u32 s30, 28
s_cselect_b32 s34, 28, s34
s_cselect_b32 s32, s31, s32
v_and_b32 v20, 63, v0
v_lshrrev_b32 v21, 6, v0
v_mul_u32_u24 v22, 15360, v21
v_lshl_add_u32 v22, v20, 4, v22
v_readfirstlane_b32 s23, v21
s_mul_i32 s35, s34, 57344
v_add_u32 v4, s35, v22
s_add_u32 s10, s35, 59392
s_min_u32 s10, s10, 1640448
s_movk_i32 s12, 4096
s_movk_i32 s13, 8192
s_movk_i32 s14, 12288
s_mul_i32 s23, s23, 15840
s_lshl_b32 s36, s32, 2
v_add_u32 v22, s36, v21
v_mul_u32_u24 v22, 491520, v22
v_lshl_add_u32 v3, v20, 4, v22
v_lshl_add_u32 v8, v20, 2, v21
v_lshlrev_b32 v8, 7, v8
s_mul_i32 s35, s33, 1640448
s_add_u32 s35, s35, 16777216
s_mov_b32 s11, 0x20000
s_getpc_b64 s[28:29]
L_pc:
s_mov_b32 s30, L_h2-L_pc+128
s_mov_b32 s31, 0x20000
s_mov_b32 s37, 1
s_cmp_eq_u32 s23, 0
s_cbranch_scc1 L_stub0
s_cmp_eq_u32 s23, 15840
s_cbranch_scc1 L_stub1
s_cmp_eq_u32 s23, 31680
s_cbranch_scc1 L_stub2
s_branch L_stub3
L_wret0:
s_waitcnt lgkmcnt(0)
s_add_u32 s8, s26, s35
s_addc_u32 s9, s27, 0
s_add_u32 s20, s26, 4096
s_addc_u32 s21, s27, 0
global_load_dwordx4 a[56:59], v3, s[20:21] offset:-4096
global_load_dwordx4 a[60:63], v3, s[20:21] offset:-3072
global_load_dwordx4 a[64:67], v3, s[20:21] offset:-2048
global_load_dwordx4 a[68:71], v3, s[20:21] offset:-1024
global_load_dwordx4 a[72:75], v3, s[20:21] offset:0
global_load_dwordx4 a[76:79], v3, s[20:21] offset:1024
s_add_u32 m0, s23, 0
s_nop 0
buffer_load_dwordx4 v4, s[8:11], 0 offen offset:0 lds
s_add_u32 m0, s23, 32
s_nop 0
buffer_load_dwordx4 v4, s[8:11], 0 offen offset:1024 lds
s_add_u32 m0, s23, 64
s_nop 0
buffer_load_dwordx4 v4, s[8:11], 0 offen offset:2048 lds
s_add_u32 m0, s23, 96
s_nop 0
buffer_load_dwordx4 v4, s[8:11], 0 offen offset:3072 lds
s_add_u32 m0, s23, 4224
s_nop 0
buffer_load_dwordx4 v4, s[8:11], s12 offen offset:0 lds
s_add_u32 m0, s23, 4256
s_nop 0
buffer_load_dwordx4 v4, s[8:11], s12 offen offset:1024 lds
s_add_u32 m0, s23, 4288
s_nop 0
buffer_load_dwordx4 v4, s[8:11], s12 offen offset:2048 lds
s_add_u32 m0, s23, 4320
s_nop 0
buffer_load_dwordx4 v4, s[8:11], s12 offen offset:3072 lds
s_add_u32 m0, s23, 8448
s_nop 0
buffer_load_dwordx4 v4, s[8:11], s13 offen offset:0 lds
s_add_u32 m0, s23, 8480
s_nop 0
buffer_load_dwordx4 v4, s[8:11], s13 offen offset:1024 lds
s_add_u32 m0, s23, 8512
s_nop 0
buffer_load_dwordx4 v4, s[8:11], s13 offen offset:2048 lds
s_add_u32 m0, s23, 8544
s_nop 0
buffer_load_dwordx4 v4, s[8:11], s13 offen offset:3072 lds
s_add_u32 m0, s23, 12672
s_nop 0
buffer_load_dwordx4 v4, s[8:11], s14 offen offset:0 lds
s_add_u32 m0, s23, 12704
s_nop 0
buffer_load_dwordx4 v4, s[8:11], s14 offen offset:1024 lds
s_add_u32 m0, s23, 12736
s_nop 0
buffer_load_dwordx4 v4, s[8:11], s14 offen offset:2048 lds
global_load_dwordx4 a[80:83], v3, s[20:21] offset:2048
global_load_dwordx4 a[84:87], v3, s[20:21] offset:3072
s_add_u32 s20, s20, 8192
s_addc_u32 s21, s21, 0
global_load_dwordx4 a[88:91], v3, s[20:21] offset:-4096
global_load_dwordx4 a[92:95], v3, s[20:21] offset:-3072
global_load_dwordx4 a[96:99], v3, s[20:21] offset:-2048
global_load_dwordx4 a[100:103], v3, s[20:21] offset:-1024
v_bfe_u32 v22, v0, 1, 3
v_and_b32 v23, 1, v0
v_mul_u32_u24 v24, 7392, v22
v_lshl_add_u32 v24, v23, 9, v24
v_bfe_u32 v25, v0, 4, 1
v_lshl_add_u32 v24, v25, 8, v24
v_bfe_u32 v25, v0, 5, 1
v_xor_b32 v25, v25, v23
v_lshl_add_u32 v1, v25, 4, v24
v_add_u32 v2, 63360, v1
v_mul_u32_u24 v24, 35840, v22
v_lshl_add_u32 v24, v23, 9, v24
v_lshl_add_u32 v24, v21, 5, v24
v_lshrrev_b32 v25, 4, v20
v_lshl_add_u32 v24, v25, 3, v24
s_mul_i32 s35, s34, 286720
s_lshl_b32 s36, s32, 7
s_add_u32 s35, s35, s36
v_add_u32 v0, s35, v24
v_accvgpr_write_b32 a253, v0
v_and_b32 v24, 15, v20
v_mul_u32_u24 v24, 144, v24
v_lshl_add_u32 v24, v21, 5, v24
v_lshl_add_u32 v24, v25, 3, v24
v_add_u32 v5, 126720, v24
v_lshrrev_b32 v24, 3, v20
v_lshl_add_u32 v26, v21, 3, v24
v_mul_u32_u24 v27, 144, v26
v_and_b32 v28, 7, v20
v_lshl_add_u32 v27, v28, 4, v27
v_add_u32 v6, 126720, v27
v_bfe_u32 v24, v26, 1, 3
v_mul_u32_u24 v24, 35840, v24
v_and_b32 v27, 1, v26
v_lshl_add_u32 v24, v27, 9, v24
v_lshrrev_b32 v27, 1, v21
v_mul_u32_u24 v29, 5120, v27
v_lshl_add_u32 v24, v28, 4, v24
v_add3_u32 v7, v24, v29, s35
v_lshlrev_b32 v27, 30, v27
v_add_u32 v9, v27, v7
s_mul_i32 s35, s33, 8192000
s_add_u32 s16, s6, s35
s_addc_u32 s17, s7, 0
s_mov_b32 s18, 8192000
s_mov_b32 s19, 0x20000
s_mov_b32 s22, 0x42000000
s_cmp_eq_u32 s23, 0
s_cbranch_scc1 L_stub12
s_cmp_eq_u32 s23, 15840
s_cbranch_scc1 L_wret
s_cmp_eq_u32 s23, 31680
s_cbranch_scc1 L_wret
s_branch L_wret
.p2align 12
L_wret:
s_mov_b32 s37, 0
s_waitcnt vmcnt(6)
s_nop 0
s_waitcnt lgkmcnt(0)
s_barrier
ds_read_b128 a[176:179], v1 offset:0
ds_read_b128 a[180:183], v1 offset:1056
ds_read_b128 a[184:187], v1 offset:2112
ds_read_b128 a[188:191], v1 offset:3168
ds_read_b128 a[192:195], v1 offset:4224
ds_read_b128 a[196:199], v1 offset:5280
s_waitcnt lgkmcnt(5)
L_h0:
v_mfma_f32_16x16x32_bf16 v[32:35], a[56:59], a[176:179], 0
s_waitcnt lgkmcnt(4)
v_mfma_f32_16x16x32_bf16 v[32:35], a[60:63], a[180:183], v[32:35]
s_waitcnt lgkmcnt(3)
global_load_dwordx4 a[104:107], v3, s[20:21] offset:0
v_mfma_f32_16x16x32_bf16 v[32:35], a[64:67], a[184:187], v[32:35]
ds_read_b128 a[200:203], v1 offset:6336
v_mfma_f32_16x16x32_bf16 v[36:39], a[76:79], a[184:187], 0
v_mfma_f32_16x16x32_bf16 v[36:39], a[72:75], a[180:183], v[36:39]
v_mfma_f32_16x16x32_bf16 v[36:39], a[68:71], a[176:179], v[36:39]
global_load_dwordx4 a[108:111], v3, s[20:21] offset:1024
v_mfma_f32_16x16x32_bf16 v[44:47], a[68:71], a[180:183], 0
v_mfma_f32_16x16x32_bf16 v[44:47], a[72:75], a[184:187], v[44:47]
s_waitcnt lgkmcnt(3)
ds_read_b128 a[204:207], v1 offset:7392
v_mfma_f32_16x16x32_bf16 v[44:47], a[76:79], a[188:191], v[44:47]
v_mfma_f32_16x16x32_bf16 v[40:43], a[64:67], a[188:191], 0
global_load_dwordx4 a[112:115], v3, s[20:21] offset:2048
v_mfma_f32_16x16x32_bf16 v[40:43], a[60:63], a[184:187], v[40:43]
ds_read_b128 a[176:179], v1 offset:32
v_mfma_f32_16x16x32_bf16 v[40:43], a[56:59], a[180:183], v[40:43]
v_mfma_f32_16x16x32_bf16 v[48:51], a[56:59], a[184:187], 0
v_mfma_f32_16x16x32_bf16 v[48:51], a[60:63], a[188:191], v[48:51]
s_waitcnt lgkmcnt(2)
global_load_dwordx4 a[116:119], v3, s[20:21] offset:3072
v_mfma_f32_16x16x32_bf16 v[48:51], a[64:67], a[192:195], v[48:51]
ds_read_b128 a[208:211], v1 offset:8448
v_mfma_f32_16x16x32_bf16 v[52:55], a[76:79], a[192:195], 0
ds_read_b128 a[180:183], v1 offset:1088
v_mfma_f32_16x16x32_bf16 v[52:55], a[72:75], a[188:191], v[52:55]
v_mfma_f32_16x16x32_bf16 v[52:55], a[68:71], a[184:187], v[52:55]
s_add_u32 s20, s20, 8192
s_addc_u32 s21, s21, 0
v_mfma_f32_16x16x32_bf16 v[60:63], a[68:71], a[188:191], 0
global_load_dwordx4 a[120:123], v3, s[20:21] offset:-4096
v_mfma_f32_16x16x32_bf16 v[60:63], a[72:75], a[192:195], v[60:63]
v_mfma_f32_16x16x32_bf16 v[60:63], a[76:79], a[196:199], v[60:63]
v_mfma_f32_16x16x32_bf16 v[56:59], a[64:67], a[196:199], 0
global_load_dwordx4 a[124:127], v3, s[20:21] offset:-3072
v_mfma_f32_16x16x32_bf16 v[56:59], a[60:63], a[192:195], v[56:59]
ds_read_b128 a[184:187], v1 offset:2144
v_mfma_f32_16x16x32_bf16 v[56:59], a[56:59], a[188:191], v[56:59]
v_mfma_f32_16x16x32_bf16 v[64:67], a[56:59], a[192:195], 0
v_mfma_f32_16x16x32_bf16 v[64:67], a[60:63], a[196:199], v[64:67]
global_load_dwordx4 a[128:131], v3, s[20:21] offset:-2048
v_mfma_f32_16x16x32_bf16 v[64:67], a[64:67], a[200:203], v[64:67]
v_mfma_f32_16x16x32_bf16 v[68:71], a[76:79], a[200:203], 0
ds_read_b128 a[188:191], v1 offset:3200
v_mfma_f32_16x16x32_bf16 v[68:71], a[72:75], a[196:199], v[68:71]
v_mfma_f32_16x16x32_bf16 v[68:71], a[68:71], a[192:195], v[68:71]
global_load_dwordx4 a[132:135], v3, s[20:21] offset:-1024
v_mfma_f32_16x16x32_bf16 v[76:79], a[68:71], a[196:199], 0
s_add_u32 s8, s8, 3280896
s_addc_u32 s9, s9, 0
v_mfma_f32_16x16x32_bf16 v[76:79], a[72:75], a[200:203], v[76:79]
s_waitcnt lgkmcnt(2)
s_add_u32 m0, s23, 63360
v_mfma_f32_16x16x32_bf16 v[76:79], a[76:79], a[204:207], v[76:79]
buffer_load_dwordx4 v4, s[8:11], 0 offen offset:0 lds
v_mfma_f32_16x16x32_bf16 v[72:75], a[64:67], a[204:207], 0
ds_read_b128 a[192:195], v1 offset:4256
v_mfma_f32_16x16x32_bf16 v[72:75], a[60:63], a[200:203], v[72:75]
v_mfma_f32_16x16x32_bf16 v[72:75], a[56:59], a[196:199], v[72:75]
global_load_dwordx4 a[136:139], v3, s[20:21] offset:0
v_mfma_f32_16x16x32_bf16 v[80:83], a[56:59], a[200:203], 0
v_mfma_f32_16x16x32_bf16 v[80:83], a[60:63], a[204:207], v[80:83]
v_mfma_f32_16x16x32_bf16 v[80:83], a[64:67], a[208:211], v[80:83]
global_load_dwordx4 a[140:143], v3, s[20:21] offset:1024
v_mfma_f32_16x16x32_bf16 v[84:87], a[76:79], a[208:211], 0
ds_read_b128 a[196:199], v1 offset:5312
v_mfma_f32_16x16x32_bf16 v[84:87], a[72:75], a[204:207], v[84:87]
v_mfma_f32_16x16x32_bf16 v[84:87], a[68:71], a[200:203], v[84:87]
s_waitcnt vmcnt(16)
global_load_dwordx4 a[144:147], v3, s[20:21] offset:2048
v_mfma_f32_16x16x32_bf16 v[32:35], a[80:83], a[176:179], v[32:35]
s_waitcnt vmcnt(16)
v_mfma_f32_16x16x32_bf16 v[32:35], a[84:87], a[180:183], v[32:35]
s_waitcnt vmcnt(15) lgkmcnt(1)
ds_read_b128 a[200:203], v1 offset:6368
v_mfma_f32_16x16x32_bf16 v[32:35], a[88:91], a[184:187], v[32:35]
s_waitcnt vmcnt(12)
v_mfma_f32_16x16x32_bf16 v[36:39], a[100:103], a[184:187], v[36:39]
global_load_dwordx4 a[148:151], v3, s[20:21] offset:3072
v_mfma_f32_16x16x32_bf16 v[36:39], a[96:99], a[180:183], v[36:39]
s_add_u32 m0, s23, 63392
v_mfma_f32_16x16x32_bf16 v[36:39], a[92:95], a[176:179], v[36:39]
v_mfma_f32_16x16x32_bf16 v[44:47], a[92:95], a[180:183], v[44:47]
buffer_load_dwordx4 v4, s[8:11], 0 offen offset:1024 lds
v_mfma_f32_16x16x32_bf16 v[44:47], a[96:99], a[184:187], v[44:47]
s_add_u32 s20, s20, 8192
s_addc_u32 s21, s21, 0
v_mfma_f32_16x16x32_bf16 v[44:47], a[100:103], a[188:191], v[44:47]
ds_read_b128 a[204:207], v1 offset:7424
v_mfma_f32_16x16x32_bf16 v[40:43], a[88:91], a[188:191], v[40:43]
global_load_dwordx4 a[56:59], v3, s[20:21] offset:-4096
v_mfma_f32_16x16x32_bf16 v[40:43], a[84:87], a[184:187], v[40:43]
ds_read_b128 a[176:179], v1 offset:64
v_mfma_f32_16x16x32_bf16 v[40:43], a[80:83], a[180:183], v[40:43]
v_mfma_f32_16x16x32_bf16 v[48:51], a[80:83], a[184:187], v[48:51]
global_load_dwordx4 a[60:63], v3, s[20:21] offset:-3072
v_mfma_f32_16x16x32_bf16 v[48:51], a[84:87], a[188:191], v[48:51]
ds_read_b128 a[208:211], v1 offset:8480
v_mfma_f32_16x16x32_bf16 v[48:51], a[88:91], a[192:195], v[48:51]
v_mfma_f32_16x16x32_bf16 v[52:55], a[100:103], a[192:195], v[52:55]
global_load_dwordx4 a[64:67], v3, s[20:21] offset:-2048
v_mfma_f32_16x16x32_bf16 v[52:55], a[96:99], a[188:191], v[52:55]
ds_read_b128 a[180:183], v1 offset:1120
v_mfma_f32_16x16x32_bf16 v[52:55], a[92:95], a[184:187], v[52:55]
v_mfma_f32_16x16x32_bf16 v[60:63], a[92:95], a[188:191], v[60:63]
v_mfma_f32_16x16x32_bf16 v[60:63], a[96:99], a[192:195], v[60:63]
s_waitcnt lgkmcnt(3)
global_load_dwordx4 a[68:71], v3, s[20:21] offset:-1024
v_mfma_f32_16x16x32_bf16 v[60:63], a[100:103], a[196:199], v[60:63]
s_add_u32 m0, s23, 63424
v_mfma_f32_16x16x32_bf16 v[56:59], a[88:91], a[196:199], v[56:59]
ds_read_b128 a[184:187], v1 offset:2176
v_mfma_f32_16x16x32_bf16 v[56:59], a[84:87], a[192:195], v[56:59]
buffer_load_dwordx4 v4, s[8:11], 0 offen offset:2048 lds
v_mfma_f32_16x16x32_bf16 v[56:59], a[80:83], a[188:191], v[56:59]
v_mfma_f32_16x16x32_bf16 v[64:67], a[80:83], a[192:195], v[64:67]
v_mfma_f32_16x16x32_bf16 v[64:67], a[84:87], a[196:199], v[64:67]
global_load_dwordx4 a[72:75], v3, s[20:21] offset:0
v_mfma_f32_16x16x32_bf16 v[64:67], a[88:91], a[200:203], v[64:67]
v_mfma_f32_16x16x32_bf16 v[68:71], a[100:103], a[200:203], v[68:71]
ds_read_b128 a[188:191], v1 offset:3232
v_mfma_f32_16x16x32_bf16 v[68:71], a[96:99], a[196:199], v[68:71]
global_load_dwordx4 a[76:79], v3, s[20:21] offset:1024
v_mfma_f32_16x16x32_bf16 v[68:71], a[92:95], a[192:195], v[68:71]
v_mfma_f32_16x16x32_bf16 v[76:79], a[92:95], a[196:199], v[76:79]
v_mfma_f32_16x16x32_bf16 v[76:79], a[96:99], a[200:203], v[76:79]
v_mfma_f32_16x16x32_bf16 v[76:79], a[100:103], a[204:207], v[76:79]
v_mfma_f32_16x16x32_bf16 v[72:75], a[88:91], a[204:207], v[72:75]
ds_read_b128 a[192:195], v1 offset:4288
v_mfma_f32_16x16x32_bf16 v[72:75], a[84:87], a[200:203], v[72:75]
v_mfma_f32_16x16x32_bf16 v[72:75], a[80:83], a[196:199], v[72:75]
v_mfma_f32_16x16x32_bf16 v[80:83], a[80:83], a[200:203], v[80:83]
s_add_u32 m0, s23, 63456
v_mfma_f32_16x16x32_bf16 v[80:83], a[84:87], a[204:207], v[80:83]
s_waitcnt lgkmcnt(1)
buffer_load_dwordx4 v4, s[8:11], 0 offen offset:3072 lds
v_mfma_f32_16x16x32_bf16 v[80:83], a[88:91], a[208:211], v[80:83]
v_mfma_f32_16x16x32_bf16 v[84:87], a[100:103], a[208:211], v[84:87]
ds_read_b128 a[196:199], v1 offset:5344
v_mfma_f32_16x16x32_bf16 v[84:87], a[96:99], a[204:207], v[84:87]
v_mfma_f32_16x16x32_bf16 v[84:87], a[92:95], a[200:203], v[84:87]
s_waitcnt vmcnt(21)
v_mfma_f32_16x16x32_bf16 v[32:35], a[104:107], a[176:179], v[32:35]
s_waitcnt vmcnt(20)
v_mfma_f32_16x16x32_bf16 v[32:35], a[108:111], a[180:183], v[32:35]
s_waitcnt vmcnt(19)
global_load_dwordx4 a[80:83], v3, s[20:21] offset:2048
v_mfma_f32_16x16x32_bf16 v[32:35], a[112:115], a[184:187], v[32:35]
s_waitcnt vmcnt(17)
ds_read_b128 a[200:203], v1 offset:6400
v_mfma_f32_16x16x32_bf16 v[36:39], a[124:127], a[184:187], v[36:39]
v_mfma_f32_16x16x32_bf16 v[36:39], a[120:123], a[180:183], v[36:39]
v_mfma_f32_16x16x32_bf16 v[36:39], a[116:119], a[176:179], v[36:39]
global_load_dwordx4 a[84:87], v3, s[20:21] offset:3072
v_mfma_f32_16x16x32_bf16 v[44:47], a[116:119], a[180:183], v[44:47]
v_mfma_f32_16x16x32_bf16 v[44:47], a[120:123], a[184:187], v[44:47]
ds_read_b128 a[204:207], v1 offset:7456
v_mfma_f32_16x16x32_bf16 v[44:47], a[124:127], a[188:191], v[44:47]
v_mfma_f32_16x16x32_bf16 v[40:43], a[112:115], a[188:191], v[40:43]
s_add_u32 s20, s20, 8192
s_addc_u32 s21, s21, 0
v_mfma_f32_16x16x32_bf16 v[40:43], a[108:111], a[184:187], v[40:43]
s_add_u32 m0, s23, 67584
global_load_dwordx4 a[88:91], v3, s[20:21] offset:-4096
v_mfma_f32_16x16x32_bf16 v[40:43], a[104:107], a[180:183], v[40:43]
ds_read_b128 a[176:179], v1 offset:96
v_mfma_f32_16x16x32_bf16 v[48:51], a[104:107], a[184:187], v[48:51]
v_mfma_f32_16x16x32_bf16 v[48:51], a[108:111], a[188:191], v[48:51]
s_waitcnt lgkmcnt(2)
buffer_load_dwordx4 v4, s[8:11], s12 offen offset:0 lds
v_mfma_f32_16x16x32_bf16 v[48:51], a[112:115], a[192:195], v[48:51]
ds_read_b128 a[208:211], v1 offset:8512
v_mfma_f32_16x16x32_bf16 v[52:55], a[124:127], a[192:195], v[52:55]
ds_read_b128 a[180:183], v1 offset:1152
v_mfma_f32_16x16x32_bf16 v[52:55], a[120:123], a[188:191], v[52:55]
global_load_dwordx4 a[92:95], v3, s[20:21] offset:-3072
v_mfma_f32_16x16x32_bf16 v[52:55], a[116:119], a[184:187], v[52:55]
v_mfma_f32_16x16x32_bf16 v[60:63], a[116:119], a[188:191], v[60:63]
v_mfma_f32_16x16x32_bf16 v[60:63], a[120:123], a[192:195], v[60:63]
global_load_dwordx4 a[96:99], v3, s[20:21] offset:-2048
v_mfma_f32_16x16x32_bf16 v[60:63], a[124:127], a[196:199], v[60:63]
v_mfma_f32_16x16x32_bf16 v[56:59], a[112:115], a[196:199], v[56:59]
ds_read_b128 a[184:187], v1 offset:2208
v_mfma_f32_16x16x32_bf16 v[56:59], a[108:111], a[192:195], v[56:59]
global_load_dwordx4 a[100:103], v3, s[20:21] offset:-1024
v_mfma_f32_16x16x32_bf16 v[56:59], a[104:107], a[188:191], v[56:59]
v_mfma_f32_16x16x32_bf16 v[64:67], a[104:107], a[192:195], v[64:67]
v_mfma_f32_16x16x32_bf16 v[64:67], a[108:111], a[196:199], v[64:67]
v_mfma_f32_16x16x32_bf16 v[64:67], a[112:115], a[200:203], v[64:67]
s_add_u32 m0, s23, 67616
v_mfma_f32_16x16x32_bf16 v[68:71], a[124:127], a[200:203], v[68:71]
buffer_load_dwordx4 v4, s[8:11], s12 offen offset:1024 lds
v_mfma_f32_16x16x32_bf16 v[68:71], a[120:123], a[196:199], v[68:71]
ds_read_b128 a[188:191], v1 offset:3264
v_mfma_f32_16x16x32_bf16 v[68:71], a[116:119], a[192:195], v[68:71]
v_mfma_f32_16x16x32_bf16 v[76:79], a[116:119], a[196:199], v[76:79]
v_mfma_f32_16x16x32_bf16 v[76:79], a[120:123], a[200:203], v[76:79]
s_waitcnt lgkmcnt(1)
v_mfma_f32_16x16x32_bf16 v[76:79], a[124:127], a[204:207], v[76:79]
v_mfma_f32_16x16x32_bf16 v[72:75], a[112:115], a[204:207], v[72:75]
ds_read_b128 a[192:195], v1 offset:4320
v_mfma_f32_16x16x32_bf16 v[72:75], a[108:111], a[200:203], v[72:75]
v_mfma_f32_16x16x32_bf16 v[72:75], a[104:107], a[196:199], v[72:75]
v_mfma_f32_16x16x32_bf16 v[80:83], a[104:107], a[200:203], v[80:83]
v_mfma_f32_16x16x32_bf16 v[80:83], a[108:111], a[204:207], v[80:83]
v_mfma_f32_16x16x32_bf16 v[80:83], a[112:115], a[208:211], v[80:83]
v_mfma_f32_16x16x32_bf16 v[84:87], a[124:127], a[208:211], v[84:87]
ds_read_b128 a[196:199], v1 offset:5376
v_mfma_f32_16x16x32_bf16 v[84:87], a[120:123], a[204:207], v[84:87]
v_mfma_f32_16x16x32_bf16 v[84:87], a[116:119], a[200:203], v[84:87]
s_waitcnt vmcnt(23)
v_mfma_f32_16x16x32_bf16 v[32:35], a[128:131], a[176:179], v[32:35]
s_waitcnt vmcnt(22)
s_add_u32 m0, s23, 67648
v_mfma_f32_16x16x32_bf16 v[32:35], a[132:135], a[180:183], v[32:35]
s_waitcnt vmcnt(20)
buffer_load_dwordx4 v4, s[8:11], s12 offen offset:2048 lds
v_mfma_f32_16x16x32_bf16 v[32:35], a[136:139], a[184:187], v[32:35]
s_waitcnt vmcnt(18)
ds_read_b128 a[200:203], v1 offset:6432
v_mfma_f32_16x16x32_bf16 v[36:39], a[148:151], a[184:187], v[36:39]
v_mfma_f32_16x16x32_bf16 v[36:39], a[144:147], a[180:183], v[36:39]
global_load_dwordx4 a[104:107], v3, s[20:21] offset:0
v_mfma_f32_16x16x32_bf16 v[36:39], a[140:143], a[176:179], v[36:39]
v_mfma_f32_16x16x32_bf16 v[44:47], a[140:143], a[180:183], v[44:47]
v_mfma_f32_16x16x32_bf16 v[44:47], a[144:147], a[184:187], v[44:47]
s_waitcnt lgkmcnt(1)
global_load_dwordx4 a[108:111], v3, s[20:21] offset:1024
v_mfma_f32_16x16x32_bf16 v[44:47], a[148:151], a[188:191], v[44:47]
ds_read_b128 a[204:207], v1 offset:7488
v_mfma_f32_16x16x32_bf16 v[40:43], a[136:139], a[188:191], v[40:43]
ds_read_b128 a[176:179], v1 offset:128
v_mfma_f32_16x16x32_bf16 v[40:43], a[132:135], a[184:187], v[40:43]
v_mfma_f32_16x16x32_bf16 v[40:43], a[128:131], a[180:183], v[40:43]
v_mfma_f32_16x16x32_bf16 v[48:51], a[128:131], a[184:187], v[48:51]
v_mfma_f32_16x16x32_bf16 v[48:51], a[132:135], a[188:191], v[48:51]
ds_read_b128 a[208:211], v1 offset:8544
v_mfma_f32_16x16x32_bf16 v[48:51], a[136:139], a[192:195], v[48:51]
global_load_dwordx4 a[112:115], v3, s[20:21] offset:2048
v_mfma_f32_16x16x32_bf16 v[52:55], a[148:151], a[192:195], v[52:55]
ds_read_b128 a[180:183], v1 offset:1184
v_mfma_f32_16x16x32_bf16 v[52:55], a[144:147], a[188:191], v[52:55]
s_add_u32 m0, s23, 67680
v_mfma_f32_16x16x32_bf16 v[52:55], a[140:143], a[184:187], v[52:55]
buffer_load_dwordx4 v4, s[8:11], s12 offen offset:3072 lds
v_mfma_f32_16x16x32_bf16 v[60:63], a[140:143], a[188:191], v[60:63]
v_mfma_f32_16x16x32_bf16 v[60:63], a[144:147], a[192:195], v[60:63]
v_mfma_f32_16x16x32_bf16 v[60:63], a[148:151], a[196:199], v[60:63]
global_load_dwordx4 a[116:119], v3, s[20:21] offset:3072
v_mfma_f32_16x16x32_bf16 v[56:59], a[136:139], a[196:199], v[56:59]
ds_read_b128 a[184:187], v1 offset:2240
v_mfma_f32_16x16x32_bf16 v[56:59], a[132:135], a[192:195], v[56:59]
v_mfma_f32_16x16x32_bf16 v[56:59], a[128:131], a[188:191], v[56:59]
v_mfma_f32_16x16x32_bf16 v[64:67], a[128:131], a[192:195], v[64:67]
v_mfma_f32_16x16x32_bf16 v[64:67], a[132:135], a[196:199], v[64:67]
s_waitcnt lgkmcnt(1)
v_mfma_f32_16x16x32_bf16 v[64:67], a[136:139], a[200:203], v[64:67]
s_add_u32 s20, s20, 8192
s_addc_u32 s21, s21, 0
v_mfma_f32_16x16x32_bf16 v[68:71], a[148:151], a[200:203], v[68:71]
global_load_dwordx4 a[120:123], v3, s[20:21] offset:-4096
v_mfma_f32_16x16x32_bf16 v[68:71], a[144:147], a[196:199], v[68:71]
ds_read_b128 a[188:191], v1 offset:3296
v_mfma_f32_16x16x32_bf16 v[68:71], a[140:143], a[192:195], v[68:71]
v_mfma_f32_16x16x32_bf16 v[76:79], a[140:143], a[196:199], v[76:79]
v_mfma_f32_16x16x32_bf16 v[76:79], a[144:147], a[200:203], v[76:79]
v_mfma_f32_16x16x32_bf16 v[76:79], a[148:151], a[204:207], v[76:79]
s_add_u32 m0, s23, 71808
global_load_dwordx4 a[124:127], v3, s[20:21] offset:-3072
v_mfma_f32_16x16x32_bf16 v[72:75], a[136:139], a[204:207], v[72:75]
ds_read_b128 a[192:195], v1 offset:4352
v_mfma_f32_16x16x32_bf16 v[72:75], a[132:135], a[200:203], v[72:75]
v_mfma_f32_16x16x32_bf16 v[72:75], a[128:131], a[196:199], v[72:75]
buffer_load_dwordx4 v4, s[8:11], s13 offen offset:0 lds
v_mfma_f32_16x16x32_bf16 v[80:83], a[128:131], a[200:203], v[80:83]
v_mfma_f32_16x16x32_bf16 v[80:83], a[132:135], a[204:207], v[80:83]
v_mfma_f32_16x16x32_bf16 v[80:83], a[136:139], a[208:211], v[80:83]
v_mfma_f32_16x16x32_bf16 v[84:87], a[148:151], a[208:211], v[84:87]
ds_read_b128 a[196:199], v1 offset:5408
v_mfma_f32_16x16x32_bf16 v[84:87], a[144:147], a[204:207], v[84:87]
v_mfma_f32_16x16x32_bf16 v[84:87], a[140:143], a[200:203], v[84:87]
s_waitcnt vmcnt(22)
v_mfma_f32_16x16x32_bf16 v[32:35], a[56:59], a[176:179], v[32:35]
v_mfma_f32_16x16x32_bf16 v[32:35], a[60:63], a[180:183], v[32:35]
s_waitcnt lgkmcnt(1)
global_load_dwordx4 a[128:131], v3, s[20:21] offset:-2048
v_mfma_f32_16x16x32_bf16 v[32:35], a[64:67], a[184:187], v[32:35]
s_waitcnt vmcnt(19)
ds_read_b128 a[200:203], v1 offset:6464
v_mfma_f32_16x16x32_bf16 v[36:39], a[76:79], a[184:187], v[36:39]
v_mfma_f32_16x16x32_bf16 v[36:39], a[72:75], a[180:183], v[36:39]
v_mfma_f32_16x16x32_bf16 v[36:39], a[68:71], a[176:179], v[36:39]
v_mfma_f32_16x16x32_bf16 v[44:47], a[68:71], a[180:183], v[44:47]
s_add_u32 m0, s23, 71840
v_mfma_f32_16x16x32_bf16 v[44:47], a[72:75], a[184:187], v[44:47]
buffer_load_dwordx4 v4, s[8:11], s13 offen offset:1024 lds
v_mfma_f32_16x16x32_bf16 v[44:47], a[76:79], a[188:191], v[44:47]
ds_read_b128 a[204:207], v1 offset:7520
v_mfma_f32_16x16x32_bf16 v[40:43], a[64:67], a[188:191], v[40:43]
ds_read_b128 a[176:179], v1 offset:160
v_mfma_f32_16x16x32_bf16 v[40:43], a[60:63], a[184:187], v[40:43]
global_load_dwordx4 a[132:135], v3, s[20:21] offset:-1024
v_mfma_f32_16x16x32_bf16 v[40:43], a[56:59], a[180:183], v[40:43]
v_mfma_f32_16x16x32_bf16 v[48:51], a[56:59], a[184:187], v[48:51]
v_mfma_f32_16x16x32_bf16 v[48:51], a[60:63], a[188:191], v[48:51]
ds_read_b128 a[208:211], v1 offset:8576
v_mfma_f32_16x16x32_bf16 v[48:51], a[64:67], a[192:195], v[48:51]
global_load_dwordx4 a[136:139], v3, s[20:21] offset:0
v_mfma_f32_16x16x32_bf16 v[52:55], a[76:79], a[192:195], v[52:55]
ds_read_b128 a[180:183], v1 offset:1216
v_mfma_f32_16x16x32_bf16 v[52:55], a[72:75], a[188:191], v[52:55]
v_mfma_f32_16x16x32_bf16 v[52:55], a[68:71], a[184:187], v[52:55]
v_mfma_f32_16x16x32_bf16 v[60:63], a[68:71], a[188:191], v[60:63]
v_mfma_f32_16x16x32_bf16 v[60:63], a[72:75], a[192:195], v[60:63]
s_waitcnt lgkmcnt(2)
v_mfma_f32_16x16x32_bf16 v[60:63], a[76:79], a[196:199], v[60:63]
global_load_dwordx4 a[140:143], v3, s[20:21] offset:1024
v_mfma_f32_16x16x32_bf16 v[56:59], a[64:67], a[196:199], v[56:59]
ds_read_b128 a[184:187], v1 offset:2272
v_mfma_f32_16x16x32_bf16 v[56:59], a[60:63], a[192:195], v[56:59]
s_add_u32 m0, s23, 71872
v_mfma_f32_16x16x32_bf16 v[56:59], a[56:59], a[188:191], v[56:59]
buffer_load_dwordx4 v4, s[8:11], s13 offen offset:2048 lds
v_mfma_f32_16x16x32_bf16 v[64:67], a[56:59], a[192:195], v[64:67]
v_mfma_f32_16x16x32_bf16 v[64:67], a[60:63], a[196:199], v[64:67]
v_mfma_f32_16x16x32_bf16 v[64:67], a[64:67], a[200:203], v[64:67]
global_load_dwordx4 a[144:147], v3, s[20:21] offset:2048
v_mfma_f32_16x16x32_bf16 v[68:71], a[76:79], a[200:203], v[68:71]
ds_read_b128 a[188:191], v1 offset:3328
v_mfma_f32_16x16x32_bf16 v[68:71], a[72:75], a[196:199], v[68:71]
v_mfma_f32_16x16x32_bf16 v[68:71], a[68:71], a[192:195], v[68:71]
v_mfma_f32_16x16x32_bf16 v[76:79], a[68:71], a[196:199], v[76:79]
v_mfma_f32_16x16x32_bf16 v[76:79], a[72:75], a[200:203], v[76:79]
v_mfma_f32_16x16x32_bf16 v[76:79], a[76:79], a[204:207], v[76:79]
global_load_dwordx4 a[148:151], v3, s[20:21] offset:3072
v_mfma_f32_16x16x32_bf16 v[72:75], a[64:67], a[204:207], v[72:75]
ds_read_b128 a[192:195], v1 offset:4384
v_mfma_f32_16x16x32_bf16 v[72:75], a[60:63], a[200:203], v[72:75]
v_mfma_f32_16x16x32_bf16 v[72:75], a[56:59], a[196:199], v[72:75]
v_mfma_f32_16x16x32_bf16 v[80:83], a[56:59], a[200:203], v[80:83]
v_mfma_f32_16x16x32_bf16 v[80:83], a[60:63], a[204:207], v[80:83]
s_waitcnt lgkmcnt(1)
v_mfma_f32_16x16x32_bf16 v[80:83], a[64:67], a[208:211], v[80:83]
s_add_u32 m0, s23, 71904
v_mfma_f32_16x16x32_bf16 v[84:87], a[76:79], a[208:211], v[84:87]
buffer_load_dwordx4 v4, s[8:11], s13 offen offset:3072 lds
v_mfma_f32_16x16x32_bf16 v[84:87], a[72:75], a[204:207], v[84:87]
ds_read_b128 a[196:199], v1 offset:5440
v_mfma_f32_16x16x32_bf16 v[84:87], a[68:71], a[200:203], v[84:87]
s_waitcnt vmcnt(22)
v_mfma_f32_16x16x32_bf16 v[32:35], a[80:83], a[176:179], v[32:35]
v_mfma_f32_16x16x32_bf16 v[32:35], a[84:87], a[180:183], v[32:35]
s_add_u32 s20, s20, 8192
s_addc_u32 s21, s21, 0
v_mfma_f32_16x16x32_bf16 v[32:35], a[88:91], a[184:187], v[32:35]
s_waitcnt vmcnt(19)
global_load_dwordx4 a[56:59], v3, s[20:21] offset:-4096
v_mfma_f32_16x16x32_bf16 v[36:39], a[100:103], a[184:187], v[36:39]
ds_read_b128 a[200:203], v1 offset:6496
v_mfma_f32_16x16x32_bf16 v[36:39], a[96:99], a[180:183], v[36:39]
v_mfma_f32_16x16x32_bf16 v[36:39], a[92:95], a[176:179], v[36:39]
v_mfma_f32_16x16x32_bf16 v[44:47], a[92:95], a[180:183], v[44:47]
v_mfma_f32_16x16x32_bf16 v[44:47], a[96:99], a[184:187], v[44:47]
global_load_dwordx4 a[60:63], v3, s[20:21] offset:-3072
v_mfma_f32_16x16x32_bf16 v[44:47], a[100:103], a[188:191], v[44:47]
ds_read_b128 a[204:207], v1 offset:7552
v_mfma_f32_16x16x32_bf16 v[40:43], a[88:91], a[188:191], v[40:43]
ds_read_b128 a[176:179], v1 offset:192
v_mfma_f32_16x16x32_bf16 v[40:43], a[84:87], a[184:187], v[40:43]
v_mfma_f32_16x16x32_bf16 v[40:43], a[80:83], a[180:183], v[40:43]
v_mfma_f32_16x16x32_bf16 v[48:51], a[80:83], a[184:187], v[48:51]
s_add_u32 m0, s23, 76032
v_mfma_f32_16x16x32_bf16 v[48:51], a[84:87], a[188:191], v[48:51]
s_waitcnt lgkmcnt(2)
buffer_load_dwordx4 v4, s[8:11], s14 offen offset:0 lds
v_mfma_f32_16x16x32_bf16 v[48:51], a[88:91], a[192:195], v[48:51]
ds_read_b128 a[208:211], v1 offset:8608
v_mfma_f32_16x16x32_bf16 v[52:55], a[100:103], a[192:195], v[52:55]
ds_read_b128 a[180:183], v1 offset:1248
v_mfma_f32_16x16x32_bf16 v[52:55], a[96:99], a[188:191], v[52:55]
global_load_dwordx4 a[64:67], v3, s[20:21] offset:-2048
v_mfma_f32_16x16x32_bf16 v[52:55], a[92:95], a[184:187], v[52:55]
v_mfma_f32_16x16x32_bf16 v[60:63], a[92:95], a[188:191], v[60:63]
v_mfma_f32_16x16x32_bf16 v[60:63], a[96:99], a[192:195], v[60:63]
v_mfma_f32_16x16x32_bf16 v[60:63], a[100:103], a[196:199], v[60:63]
global_load_dwordx4 a[68:71], v3, s[20:21] offset:-1024
v_mfma_f32_16x16x32_bf16 v[56:59], a[88:91], a[196:199], v[56:59]
ds_read_b128 a[184:187], v1 offset:2304
v_mfma_f32_16x16x32_bf16 v[56:59], a[84:87], a[192:195], v[56:59]
v_mfma_f32_16x16x32_bf16 v[56:59], a[80:83], a[188:191], v[56:59]
v_mfma_f32_16x16x32_bf16 v[64:67], a[80:83], a[192:195], v[64:67]
v_mfma_f32_16x16x32_bf16 v[64:67], a[84:87], a[196:199], v[64:67]
v_mfma_f32_16x16x32_bf16 v[64:67], a[88:91], a[200:203], v[64:67]
global_load_dwordx4 a[72:75], v3, s[20:21] offset:0
v_mfma_f32_16x16x32_bf16 v[68:71], a[100:103], a[200:203], v[68:71]
ds_read_b128 a[188:191], v1 offset:3360
v_mfma_f32_16x16x32_bf16 v[68:71], a[96:99], a[196:199], v[68:71]
s_add_u32 m0, s23, 76064
v_mfma_f32_16x16x32_bf16 v[68:71], a[92:95], a[192:195], v[68:71]
buffer_load_dwordx4 v4, s[8:11], s14 offen offset:1024 lds
v_mfma_f32_16x16x32_bf16 v[76:79], a[92:95], a[196:199], v[76:79]
v_mfma_f32_16x16x32_bf16 v[76:79], a[96:99], a[200:203], v[76:79]
s_waitcnt lgkmcnt(1)
v_mfma_f32_16x16x32_bf16 v[76:79], a[100:103], a[204:207], v[76:79]
global_load_dwordx4 a[76:79], v3, s[20:21] offset:1024
v_mfma_f32_16x16x32_bf16 v[72:75], a[88:91], a[204:207], v[72:75]
ds_read_b128 a[192:195], v1 offset:4416
v_mfma_f32_16x16x32_bf16 v[72:75], a[84:87], a[200:203], v[72:75]
v_mfma_f32_16x16x32_bf16 v[72:75], a[80:83], a[196:199], v[72:75]
v_mfma_f32_16x16x32_bf16 v[80:83], a[80:83], a[200:203], v[80:83]
v_mfma_f32_16x16x32_bf16 v[80:83], a[84:87], a[204:207], v[80:83]
v_mfma_f32_16x16x32_bf16 v[80:83], a[88:91], a[208:211], v[80:83]
v_mfma_f32_16x16x32_bf16 v[84:87], a[100:103], a[208:211], v[84:87]
ds_read_b128 a[196:199], v1 offset:5472
v_mfma_f32_16x16x32_bf16 v[84:87], a[96:99], a[204:207], v[84:87]
v_mfma_f32_16x16x32_bf16 v[84:87], a[92:95], a[200:203], v[84:87]
s_waitcnt vmcnt(22)
v_mfma_f32_16x16x32_bf16 v[32:35], a[104:107], a[176:179], v[32:35]
s_waitcnt vmcnt(18)
s_mov_b32 s36, L_h2-L_pc
v_mfma_f32_16x16x32_bf16 v[32:35], a[108:111], a[180:183], v[32:35]
s_mov_b32 s30, L_h3+128-L_pc
global_load_dwordx4 a[80:83], v3, s[20:21] offset:2048
v_mfma_f32_16x16x32_bf16 v[32:35], a[112:115], a[184:187], v[32:35]
s_add_u32 m0, s23, 76096
ds_read_b128 a[200:203], v1 offset:6528
buffer_load_dwordx4 v4, s[8:11], s14 offen offset:2048 lds
v_mfma_f32_16x16x32_bf16 v[36:39], a[124:127], a[184:187], v[36:39]
v_mfma_f32_16x16x32_bf16 v[36:39], a[120:123], a[180:183], v[36:39]
buffer_load_dword a252, v8, s[28:31], s36 offen
v_mfma_f32_16x16x32_bf16 v[36:39], a[116:119], a[176:179], v[36:39]
v_mfma_f32_16x16x32_bf16 v[44:47], a[116:119], a[180:183], v[44:47]
v_mfma_f32_16x16x32_bf16 v[44:47], a[120:123], a[184:187], v[44:47]
s_waitcnt lgkmcnt(1)
global_load_dwordx4 a[84:87], v3, s[20:21] offset:3072
v_mfma_f32_16x16x32_bf16 v[44:47], a[124:127], a[188:191], v[44:47]
ds_read_b128 a[204:207], v1 offset:7584
v_mfma_f32_16x16x32_bf16 v[40:43], a[112:115], a[188:191], v[40:43]
ds_read_b128 a[176:179], v1 offset:224
v_mfma_f32_16x16x32_bf16 v[40:43], a[108:111], a[184:187], v[40:43]
v_mfma_f32_16x16x32_bf16 v[40:43], a[104:107], a[180:183], v[40:43]
v_mfma_f32_16x16x32_bf16 v[48:51], a[104:107], a[184:187], v[48:51]
v_mfma_f32_16x16x32_bf16 v[48:51], a[108:111], a[188:191], v[48:51]
s_add_u32 s20, s20, 8192
s_addc_u32 s21, s21, 0
v_mfma_f32_16x16x32_bf16 v[48:51], a[112:115], a[192:195], v[48:51]
ds_read_b128 a[208:211], v1 offset:8640
v_mfma_f32_16x16x32_bf16 v[52:55], a[124:127], a[192:195], v[52:55]
global_load_dwordx4 a[88:91], v3, s[20:21] offset:-4096
v_mfma_f32_16x16x32_bf16 v[52:55], a[120:123], a[188:191], v[52:55]
ds_read_b128 a[180:183], v1 offset:1280
v_mfma_f32_16x16x32_bf16 v[52:55], a[116:119], a[184:187], v[52:55]
v_mfma_f32_16x16x32_bf16 v[60:63], a[116:119], a[188:191], v[60:63]
v_mfma_f32_16x16x32_bf16 v[60:63], a[120:123], a[192:195], v[60:63]
v_mfma_f32_16x16x32_bf16 v[60:63], a[124:127], a[196:199], v[60:63]
global_load_dwordx4 a[92:95], v3, s[20:21] offset:-3072
v_mfma_f32_16x16x32_bf16 v[56:59], a[112:115], a[196:199], v[56:59]
ds_read_b128 a[184:187], v1 offset:2336
v_mfma_f32_16x16x32_bf16 v[56:59], a[108:111], a[192:195], v[56:59]
v_mfma_f32_16x16x32_bf16 v[56:59], a[104:107], a[188:191], v[56:59]
v_mfma_f32_16x16x32_bf16 v[64:67], a[104:107], a[192:195], v[64:67]
v_mfma_f32_16x16x32_bf16 v[64:67], a[108:111], a[196:199], v[64:67]
s_waitcnt lgkmcnt(2)
v_mfma_f32_16x16x32_bf16 v[64:67], a[112:115], a[200:203], v[64:67]
global_load_dwordx4 a[96:99], v3, s[20:21] offset:-2048
v_mfma_f32_16x16x32_bf16 v[68:71], a[124:127], a[200:203], v[68:71]
ds_read_b128 a[188:191], v1 offset:3392
v_mfma_f32_16x16x32_bf16 v[68:71], a[120:123], a[196:199], v[68:71]
v_mfma_f32_16x16x32_bf16 v[68:71], a[116:119], a[192:195], v[68:71]
v_mfma_f32_16x16x32_bf16 v[76:79], a[116:119], a[196:199], v[76:79]
v_mfma_f32_16x16x32_bf16 v[76:79], a[120:123], a[200:203], v[76:79]
v_mfma_f32_16x16x32_bf16 v[76:79], a[124:127], a[204:207], v[76:79]
global_load_dwordx4 a[100:103], v3, s[20:21] offset:-1024
v_mfma_f32_16x16x32_bf16 v[72:75], a[112:115], a[204:207], v[72:75]
ds_read_b128 a[192:195], v1 offset:4448
v_mfma_f32_16x16x32_bf16 v[72:75], a[108:111], a[200:203], v[72:75]
v_mfma_f32_16x16x32_bf16 v[72:75], a[104:107], a[196:199], v[72:75]
v_mfma_f32_16x16x32_bf16 v[80:83], a[104:107], a[200:203], v[80:83]
v_mfma_f32_16x16x32_bf16 v[80:83], a[108:111], a[204:207], v[80:83]
v_mfma_f32_16x16x32_bf16 v[80:83], a[112:115], a[208:211], v[80:83]
v_mfma_f32_16x16x32_bf16 v[84:87], a[124:127], a[208:211], v[84:87]
ds_read_b128 a[196:199], v1 offset:5504
v_mfma_f32_16x16x32_bf16 v[84:87], a[120:123], a[204:207], v[84:87]
v_mfma_f32_16x16x32_bf16 v[84:87], a[116:119], a[200:203], v[84:87]
s_waitcnt vmcnt(21)
v_mfma_f32_16x16x32_bf16 v[32:35], a[128:131], a[176:179], v[32:35]
s_waitcnt lgkmcnt(2)
ds_read_b128 a[200:203], v1 offset:6560
v_mfma_f32_16x16x32_bf16 v[32:35], a[132:135], a[180:183], v[32:35]
global_load_dwordx4 a[104:107], v3, s[20:21] offset:0
v_mfma_f32_16x16x32_bf16 v[32:35], a[136:139], a[184:187], v[32:35]
s_waitcnt vmcnt(18)
ds_read_b128 a[204:207], v1 offset:7616
v_mfma_f32_16x16x32_bf16 v[36:39], a[148:151], a[184:187], v[36:39]
v_mfma_f32_16x16x32_bf16 v[36:39], a[144:147], a[180:183], v[36:39]
ds_read_b128 a[208:211], v1 offset:8672
v_mfma_f32_16x16x32_bf16 v[36:39], a[140:143], a[176:179], v[36:39]
v_mfma_f32_16x16x32_bf16 v[44:47], a[140:143], a[180:183], v[44:47]
v_mfma_f32_16x16x32_bf16 v[44:47], a[144:147], a[184:187], v[44:47]
global_load_dwordx4 a[108:111], v3, s[20:21] offset:1024
v_mfma_f32_16x16x32_bf16 v[44:47], a[148:151], a[188:191], v[44:47]
v_mfma_f32_16x16x32_bf16 v[40:43], a[136:139], a[188:191], v[40:43]
v_mfma_f32_16x16x32_bf16 v[40:43], a[132:135], a[184:187], v[40:43]
v_mfma_f32_16x16x32_bf16 v[40:43], a[128:131], a[180:183], v[40:43]
v_mfma_f32_16x16x32_bf16 v[48:51], a[128:131], a[184:187], v[48:51]
v_mfma_f32_16x16x32_bf16 v[48:51], a[132:135], a[188:191], v[48:51]
s_waitcnt lgkmcnt(1)
global_load_dwordx4 a[112:115], v3, s[20:21] offset:2048
v_mfma_f32_16x16x32_bf16 v[48:51], a[136:139], a[192:195], v[48:51]
v_mfma_f32_16x16x32_bf16 v[52:55], a[148:151], a[192:195], v[52:55]
s_waitcnt vmcnt(9)
s_nop 0
s_waitcnt lgkmcnt(0)
s_barrier
v_mfma_f32_16x16x32_bf16 v[52:55], a[144:147], a[188:191], v[52:55]
ds_read_b128 a[176:179], v2 offset:0
v_mfma_f32_16x16x32_bf16 v[52:55], a[140:143], a[184:187], v[52:55]
v_mfma_f32_16x16x32_bf16 v[60:63], a[140:143], a[188:191], v[60:63]
s_add_u32 s8, s8, 3280896
s_addc_u32 s9, s9, 0
v_mfma_f32_16x16x32_bf16 v[60:63], a[144:147], a[192:195], v[60:63]
s_add_u32 m0, s23, 0
ds_read_b128 a[180:183], v2 offset:1056
v_mfma_f32_16x16x32_bf16 v[60:63], a[148:151], a[196:199], v[60:63]
buffer_load_dwordx4 v4, s[8:11], 0 offen offset:0 lds
v_mfma_f32_16x16x32_bf16 v[56:59], a[136:139], a[196:199], v[56:59]
L_stub0:
s_cmp_eq_u32 s37, 1
s_cbranch_scc1 L_stub4
ds_read_b128 a[184:187], v2 offset:2112
v_mfma_f32_16x16x32_bf16 v[56:59], a[132:135], a[192:195], v[56:59]
v_mfma_f32_16x16x32_bf16 v[56:59], a[128:131], a[188:191], v[56:59]
global_load_dwordx4 a[116:119], v3, s[20:21] offset:3072
v_mfma_f32_16x16x32_bf16 v[64:67], a[128:131], a[192:195], v[64:67]
v_mfma_f32_16x16x32_bf16 v[64:67], a[132:135], a[196:199], v[64:67]
v_mfma_f32_16x16x32_bf16 v[64:67], a[136:139], a[200:203], v[64:67]
s_add_u32 s20, s20, 8192
s_addc_u32 s21, s21, 0
v_mfma_f32_16x16x32_bf16 v[68:71], a[148:151], a[200:203], v[68:71]
global_load_dwordx4 a[120:123], v3, s[20:21] offset:-4096
v_mfma_f32_16x16x32_bf16 v[68:71], a[144:147], a[196:199], v[68:71]
ds_read_b128 a[188:191], v2 offset:3168
v_mfma_f32_16x16x32_bf16 v[68:71], a[140:143], a[192:195], v[68:71]
v_mfma_f32_16x16x32_bf16 v[76:79], a[140:143], a[196:199], v[76:79]
v_mfma_f32_16x16x32_bf16 v[76:79], a[144:147], a[200:203], v[76:79]
v_mfma_f32_16x16x32_bf16 v[76:79], a[148:151], a[204:207], v[76:79]
global_load_dwordx4 a[124:127], v3, s[20:21] offset:-3072
v_mfma_f32_16x16x32_bf16 v[72:75], a[136:139], a[204:207], v[72:75]
ds_read_b128 a[192:195], v2 offset:4224
v_mfma_f32_16x16x32_bf16 v[72:75], a[132:135], a[200:203], v[72:75]
s_add_u32 m0, s23, 32
v_mfma_f32_16x16x32_bf16 v[72:75], a[128:131], a[196:199], v[72:75]
buffer_load_dwordx4 v4, s[8:11], 0 offen offset:1024 lds
v_mfma_f32_16x16x32_bf16 v[80:83], a[128:131], a[200:203], v[80:83]
v_mfma_f32_16x16x32_bf16 v[80:83], a[132:135], a[204:207], v[80:83]
v_mfma_f32_16x16x32_bf16 v[80:83], a[136:139], a[208:211], v[80:83]
v_mfma_f32_16x16x32_bf16 v[84:87], a[148:151], a[208:211], v[84:87]
ds_read_b128 a[196:199], v2 offset:5280
v_mfma_f32_16x16x32_bf16 v[84:87], a[144:147], a[204:207], v[84:87]
v_mfma_f32_16x16x32_bf16 v[84:87], a[140:143], a[200:203], v[84:87]
s_waitcnt lgkmcnt(2)
L_h1:
v_mfma_f32_16x16x32_bf16 v[88:91], a[56:59], a[176:179], 0
v_mfma_f32_16x16x32_bf16 v[88:91], a[60:63], a[180:183], v[88:91]
global_load_dwordx4 a[128:131], v3, s[20:21] offset:-2048
v_mfma_f32_16x16x32_bf16 v[88:91], a[64:67], a[184:187], v[88:91]
ds_read_b128 a[200:203], v2 offset:6336
v_mfma_f32_16x16x32_bf16 v[92:95], a[76:79], a[184:187], 0
v_mfma_f32_16x16x32_bf16 v[92:95], a[72:75], a[180:183], v[92:95]
v_mfma_f32_16x16x32_bf16 v[92:95], a[68:71], a[176:179], v[92:95]
v_mfma_f32_16x16x32_bf16 v[100:103], a[68:71], a[180:183], 0
v_mfma_f32_16x16x32_bf16 v[100:103], a[72:75], a[184:187], v[100:103]
global_load_dwordx4 a[132:135], v3, s[20:21] offset:-1024
v_mfma_f32_16x16x32_bf16 v[100:103], a[76:79], a[188:191], v[100:103]
s_add_u32 m0, s23, 64
ds_read_b128 a[204:207], v2 offset:7392
v_mfma_f32_16x16x32_bf16 v[96:99], a[64:67], a[188:191], 0
ds_read_b128 a[176:179], v2 offset:32
v_mfma_f32_16x16x32_bf16 v[96:99], a[60:63], a[184:187], v[96:99]
buffer_load_dwordx4 v4, s[8:11], 0 offen offset:2048 lds
v_mfma_f32_16x16x32_bf16 v[96:99], a[56:59], a[180:183], v[96:99]
v_mfma_f32_16x16x32_bf16 v[104:107], a[56:59], a[184:187], 0
v_mfma_f32_16x16x32_bf16 v[104:107], a[60:63], a[188:191], v[104:107]
s_waitcnt lgkmcnt(2)
ds_read_b128 a[208:211], v2 offset:8448
v_mfma_f32_16x16x32_bf16 v[104:107], a[64:67], a[192:195], v[104:107]
global_load_dwordx4 a[136:139], v3, s[20:21] offset:0
v_mfma_f32_16x16x32_bf16 v[108:111], a[76:79], a[192:195], 0
ds_read_b128 a[180:183], v2 offset:1088
v_mfma_f32_16x16x32_bf16 v[108:111], a[72:75], a[188:191], v[108:111]
v_mfma_f32_16x16x32_bf16 v[108:111], a[68:71], a[184:187], v[108:111]
v_mfma_f32_16x16x32_bf16 v[116:119], a[68:71], a[188:191], 0
v_mfma_f32_16x16x32_bf16 v[116:119], a[72:75], a[192:195], v[116:119]
v_mfma_f32_16x16x32_bf16 v[116:119], a[76:79], a[196:199], v[116:119]
global_load_dwordx4 a[140:143], v3, s[20:21] offset:1024
v_mfma_f32_16x16x32_bf16 v[112:115], a[64:67], a[196:199], 0
ds_read_b128 a[184:187], v2 offset:2144
v_mfma_f32_16x16x32_bf16 v[112:115], a[60:63], a[192:195], v[112:115]
v_mfma_f32_16x16x32_bf16 v[112:115], a[56:59], a[188:191], v[112:115]
v_mfma_f32_16x16x32_bf16 v[120:123], a[56:59], a[192:195], 0
s_add_u32 m0, s23, 96
v_mfma_f32_16x16x32_bf16 v[120:123], a[60:63], a[196:199], v[120:123]
buffer_load_dwordx4 v4, s[8:11], 0 offen offset:3072 lds
v_mfma_f32_16x16x32_bf16 v[120:123], a[64:67], a[200:203], v[120:123]
v_mfma_f32_16x16x32_bf16 v[124:127], a[76:79], a[200:203], 0
ds_read_b128 a[188:191], v2 offset:3200
v_mfma_f32_16x16x32_bf16 v[124:127], a[72:75], a[196:199], v[124:127]
global_load_dwordx4 a[144:147], v3, s[20:21] offset:2048
v_mfma_f32_16x16x32_bf16 v[124:127], a[68:71], a[192:195], v[124:127]
v_mfma_f32_16x16x32_bf16 v[132:135], a[68:71], a[196:199], 0
v_mfma_f32_16x16x32_bf16 v[132:135], a[72:75], a[200:203], v[132:135]
s_waitcnt lgkmcnt(1)
v_mfma_f32_16x16x32_bf16 v[132:135], a[76:79], a[204:207], v[132:135]
global_load_dwordx4 a[148:151], v3, s[20:21] offset:3072
v_mfma_f32_16x16x32_bf16 v[128:131], a[64:67], a[204:207], 0
ds_read_b128 a[192:195], v2 offset:4256
v_mfma_f32_16x16x32_bf16 v[128:131], a[60:63], a[200:203], v[128:131]
v_mfma_f32_16x16x32_bf16 v[128:131], a[56:59], a[196:199], v[128:131]
v_mfma_f32_16x16x32_bf16 v[136:139], a[56:59], a[200:203], 0
v_mfma_f32_16x16x32_bf16 v[136:139], a[60:63], a[204:207], v[136:139]
v_mfma_f32_16x16x32_bf16 v[136:139], a[64:67], a[208:211], v[136:139]
v_mfma_f32_16x16x32_bf16 v[140:143], a[76:79], a[208:211], 0
ds_read_b128 a[196:199], v2 offset:5312
v_mfma_f32_16x16x32_bf16 v[140:143], a[72:75], a[204:207], v[140:143]
s_add_u32 m0, s23, 4224
v_mfma_f32_16x16x32_bf16 v[140:143], a[68:71], a[200:203], v[140:143]
buffer_load_dwordx4 v4, s[8:11], s12 offen offset:0 lds
v_mfma_f32_16x16x32_bf16 v[88:91], a[80:83], a[176:179], v[88:91]
s_waitcnt vmcnt(20)
v_mfma_f32_16x16x32_bf16 v[88:91], a[84:87], a[180:183], v[88:91]
s_add_u32 s20, s20, 8192
s_addc_u32 s21, s21, 0
v_mfma_f32_16x16x32_bf16 v[88:91], a[88:91], a[184:187], v[88:91]
s_waitcnt vmcnt(17)
global_load_dwordx4 a[56:59], v3, s[20:21] offset:-4096
v_mfma_f32_16x16x32_bf16 v[92:95], a[100:103], a[184:187], v[92:95]
ds_read_b128 a[200:203], v2 offset:6368
v_mfma_f32_16x16x32_bf16 v[92:95], a[96:99], a[180:183], v[92:95]
v_mfma_f32_16x16x32_bf16 v[92:95], a[92:95], a[176:179], v[92:95]
v_mfma_f32_16x16x32_bf16 v[100:103], a[92:95], a[180:183], v[100:103]
v_mfma_f32_16x16x32_bf16 v[100:103], a[96:99], a[184:187], v[100:103]
s_waitcnt lgkmcnt(1)
global_load_dwordx4 a[60:63], v3, s[20:21] offset:-3072
v_mfma_f32_16x16x32_bf16 v[100:103], a[100:103], a[188:191], v[100:103]
ds_read_b128 a[204:207], v2 offset:7424
v_mfma_f32_16x16x32_bf16 v[96:99], a[88:91], a[188:191], v[96:99]
ds_read_b128 a[176:179], v2 offset:64
v_mfma_f32_16x16x32_bf16 v[96:99], a[84:87], a[184:187], v[96:99]
v_mfma_f32_16x16x32_bf16 v[96:99], a[80:83], a[180:183], v[96:99]
v_mfma_f32_16x16x32_bf16 v[104:107], a[80:83], a[184:187], v[104:107]
v_mfma_f32_16x16x32_bf16 v[104:107], a[84:87], a[188:191], v[104:107]
ds_read_b128 a[208:211], v2 offset:8480
v_mfma_f32_16x16x32_bf16 v[104:107], a[88:91], a[192:195], v[104:107]
s_add_u32 m0, s23, 4256
global_load_dwordx4 a[64:67], v3, s[20:21] offset:-2048
v_mfma_f32_16x16x32_bf16 v[108:111], a[100:103], a[192:195], v[108:111]
ds_read_b128 a[180:183], v2 offset:1120
v_mfma_f32_16x16x32_bf16 v[108:111], a[96:99], a[188:191], v[108:111]
v_mfma_f32_16x16x32_bf16 v[108:111], a[92:95], a[184:187], v[108:111]
buffer_load_dwordx4 v4, s[8:11], s12 offen offset:1024 lds
v_mfma_f32_16x16x32_bf16 v[116:119], a[92:95], a[188:191], v[116:119]
v_mfma_f32_16x16x32_bf16 v[116:119], a[96:99], a[192:195], v[116:119]
v_mfma_f32_16x16x32_bf16 v[116:119], a[100:103], a[196:199], v[116:119]
global_load_dwordx4 a[68:71], v3, s[20:21] offset:-1024
v_mfma_f32_16x16x32_bf16 v[112:115], a[88:91], a[196:199], v[112:115]
ds_read_b128 a[184:187], v2 offset:2176
v_mfma_f32_16x16x32_bf16 v[112:115], a[84:87], a[192:195], v[112:115]
v_mfma_f32_16x16x32_bf16 v[112:115], a[80:83], a[188:191], v[112:115]
v_mfma_f32_16x16x32_bf16 v[120:123], a[80:83], a[192:195], v[120:123]
v_mfma_f32_16x16x32_bf16 v[120:123], a[84:87], a[196:199], v[120:123]
s_waitcnt lgkmcnt(1)
v_mfma_f32_16x16x32_bf16 v[120:123], a[88:91], a[200:203], v[120:123]
global_load_dwordx4 a[72:75], v3, s[20:21] offset:0
v_mfma_f32_16x16x32_bf16 v[124:127], a[100:103], a[200:203], v[124:127]
ds_read_b128 a[188:191], v2 offset:3232
v_mfma_f32_16x16x32_bf16 v[124:127], a[96:99], a[196:199], v[124:127]
v_mfma_f32_16x16x32_bf16 v[124:127], a[92:95], a[192:195], v[124:127]
v_mfma_f32_16x16x32_bf16 v[132:135], a[92:95], a[196:199], v[132:135]
s_add_u32 m0, s23, 4288
v_mfma_f32_16x16x32_bf16 v[132:135], a[96:99], a[200:203], v[132:135]
buffer_load_dwordx4 v4, s[8:11], s12 offen offset:2048 lds
v_mfma_f32_16x16x32_bf16 v[132:135], a[100:103], a[204:207], v[132:135]
v_mfma_f32_16x16x32_bf16 v[128:131], a[88:91], a[204:207], v[128:131]
ds_read_b128 a[192:195], v2 offset:4288
v_mfma_f32_16x16x32_bf16 v[128:131], a[84:87], a[200:203], v[128:131]
global_load_dwordx4 a[76:79], v3, s[20:21] offset:1024
v_mfma_f32_16x16x32_bf16 v[128:131], a[80:83], a[196:199], v[128:131]
v_mfma_f32_16x16x32_bf16 v[136:139], a[80:83], a[200:203], v[136:139]
v_mfma_f32_16x16x32_bf16 v[136:139], a[84:87], a[204:207], v[136:139]
v_mfma_f32_16x16x32_bf16 v[136:139], a[88:91], a[208:211], v[136:139]
v_mfma_f32_16x16x32_bf16 v[140:143], a[100:103], a[208:211], v[140:143]
ds_read_b128 a[196:199], v2 offset:5344
v_mfma_f32_16x16x32_bf16 v[140:143], a[96:99], a[204:207], v[140:143]
v_mfma_f32_16x16x32_bf16 v[140:143], a[92:95], a[200:203], v[140:143]
s_waitcnt vmcnt(22)
v_mfma_f32_16x16x32_bf16 v[88:91], a[104:107], a[176:179], v[88:91]
v_mfma_f32_16x16x32_bf16 v[88:91], a[108:111], a[180:183], v[88:91]
s_waitcnt lgkmcnt(1)
global_load_dwordx4 a[80:83], v3, s[20:21] offset:2048
v_mfma_f32_16x16x32_bf16 v[88:91], a[112:115], a[184:187], v[88:91]
s_waitcnt vmcnt(19)
ds_read_b128 a[200:203], v2 offset:6400
v_mfma_f32_16x16x32_bf16 v[92:95], a[124:127], a[184:187], v[92:95]
v_mfma_f32_16x16x32_bf16 v[92:95], a[120:123], a[180:183], v[92:95]
s_add_u32 m0, s23, 4320
v_mfma_f32_16x16x32_bf16 v[92:95], a[116:119], a[176:179], v[92:95]
buffer_load_dwordx4 v4, s[8:11], s12 offen offset:3072 lds
v_mfma_f32_16x16x32_bf16 v[100:103], a[116:119], a[180:183], v[100:103]
v_mfma_f32_16x16x32_bf16 v[100:103], a[120:123], a[184:187], v[100:103]
ds_read_b128 a[204:207], v2 offset:7456
v_mfma_f32_16x16x32_bf16 v[100:103], a[124:127], a[188:191], v[100:103]
global_load_dwordx4 a[84:87], v3, s[20:21] offset:3072
v_mfma_f32_16x16x32_bf16 v[96:99], a[112:115], a[188:191], v[96:99]
ds_read_b128 a[176:179], v2 offset:96
v_mfma_f32_16x16x32_bf16 v[96:99], a[108:111], a[184:187], v[96:99]
v_mfma_f32_16x16x32_bf16 v[96:99], a[104:107], a[180:183], v[96:99]
v_mfma_f32_16x16x32_bf16 v[104:107], a[104:107], a[184:187], v[104:107]
v_mfma_f32_16x16x32_bf16 v[104:107], a[108:111], a[188:191], v[104:107]
s_add_u32 s20, s20, 8192
s_addc_u32 s21, s21, 0
v_mfma_f32_16x16x32_bf16 v[104:107], a[112:115], a[192:195], v[104:107]
ds_read_b128 a[208:211], v2 offset:8512
v_mfma_f32_16x16x32_bf16 v[108:111], a[124:127], a[192:195], v[108:111]
global_load_dwordx4 a[88:91], v3, s[20:21] offset:-4096
v_mfma_f32_16x16x32_bf16 v[108:111], a[120:123], a[188:191], v[108:111]
ds_read_b128 a[180:183], v2 offset:1152
v_mfma_f32_16x16x32_bf16 v[108:111], a[116:119], a[184:187], v[108:111]
v_mfma_f32_16x16x32_bf16 v[116:119], a[116:119], a[188:191], v[116:119]
v_mfma_f32_16x16x32_bf16 v[116:119], a[120:123], a[192:195], v[116:119]
s_waitcnt lgkmcnt(2)
v_mfma_f32_16x16x32_bf16 v[116:119], a[124:127], a[196:199], v[116:119]
s_add_u32 m0, s23, 8448
global_load_dwordx4 a[92:95], v3, s[20:21] offset:-3072
v_mfma_f32_16x16x32_bf16 v[112:115], a[112:115], a[196:199], v[112:115]
ds_read_b128 a[184:187], v2 offset:2208
v_mfma_f32_16x16x32_bf16 v[112:115], a[108:111], a[192:195], v[112:115]
v_mfma_f32_16x16x32_bf16 v[112:115], a[104:107], a[188:191], v[112:115]
buffer_load_dwordx4 v4, s[8:11], s13 offen offset:0 lds
v_mfma_f32_16x16x32_bf16 v[120:123], a[104:107], a[192:195], v[120:123]
v_mfma_f32_16x16x32_bf16 v[120:123], a[108:111], a[196:199], v[120:123]
v_mfma_f32_16x16x32_bf16 v[120:123], a[112:115], a[200:203], v[120:123]
global_load_dwordx4 a[96:99], v3, s[20:21] offset:-2048
v_mfma_f32_16x16x32_bf16 v[124:127], a[124:127], a[200:203], v[124:127]
ds_read_b128 a[188:191], v2 offset:3264
v_mfma_f32_16x16x32_bf16 v[124:127], a[120:123], a[196:199], v[124:127]
v_mfma_f32_16x16x32_bf16 v[124:127], a[116:119], a[192:195], v[124:127]
v_mfma_f32_16x16x32_bf16 v[132:135], a[116:119], a[196:199], v[132:135]
v_mfma_f32_16x16x32_bf16 v[132:135], a[120:123], a[200:203], v[132:135]
v_mfma_f32_16x16x32_bf16 v[132:135], a[124:127], a[204:207], v[132:135]
global_load_dwordx4 a[100:103], v3, s[20:21] offset:-1024
v_mfma_f32_16x16x32_bf16 v[128:131], a[112:115], a[204:207], v[128:131]
ds_read_b128 a[192:195], v2 offset:4320
v_mfma_f32_16x16x32_bf16 v[128:131], a[108:111], a[200:203], v[128:131]
v_mfma_f32_16x16x32_bf16 v[128:131], a[104:107], a[196:199], v[128:131]
v_mfma_f32_16x16x32_bf16 v[136:139], a[104:107], a[200:203], v[136:139]
s_add_u32 m0, s23, 8480
v_mfma_f32_16x16x32_bf16 v[136:139], a[108:111], a[204:207], v[136:139]
s_waitcnt lgkmcnt(1)
buffer_load_dwordx4 v4, s[8:11], s13 offen offset:1024 lds
v_mfma_f32_16x16x32_bf16 v[136:139], a[112:115], a[208:211], v[136:139]
v_mfma_f32_16x16x32_bf16 v[140:143], a[124:127], a[208:211], v[140:143]
ds_read_b128 a[196:199], v2 offset:5376
v_mfma_f32_16x16x32_bf16 v[140:143], a[120:123], a[204:207], v[140:143]
v_mfma_f32_16x16x32_bf16 v[140:143], a[116:119], a[200:203], v[140:143]
s_waitcnt vmcnt(22)
v_mfma_f32_16x16x32_bf16 v[88:91], a[128:131], a[176:179], v[88:91]
v_mfma_f32_16x16x32_bf16 v[88:91], a[132:135], a[180:183], v[88:91]
global_load_dwordx4 a[104:107], v3, s[20:21] offset:0
v_mfma_f32_16x16x32_bf16 v[88:91], a[136:139], a[184:187], v[88:91]
s_waitcnt vmcnt(19)
ds_read_b128 a[200:203], v2 offset:6432
v_mfma_f32_16x16x32_bf16 v[92:95], a[148:151], a[184:187], v[92:95]
v_mfma_f32_16x16x32_bf16 v[92:95], a[144:147], a[180:183], v[92:95]
v_mfma_f32_16x16x32_bf16 v[92:95], a[140:143], a[176:179], v[92:95]
v_mfma_f32_16x16x32_bf16 v[100:103], a[140:143], a[180:183], v[100:103]
v_mfma_f32_16x16x32_bf16 v[100:103], a[144:147], a[184:187], v[100:103]
global_load_dwordx4 a[108:111], v3, s[20:21] offset:1024
v_mfma_f32_16x16x32_bf16 v[100:103], a[148:151], a[188:191], v[100:103]
ds_read_b128 a[204:207], v2 offset:7488
v_mfma_f32_16x16x32_bf16 v[96:99], a[136:139], a[188:191], v[96:99]
ds_read_b128 a[176:179], v2 offset:128
v_mfma_f32_16x16x32_bf16 v[96:99], a[132:135], a[184:187], v[96:99]
s_add_u32 m0, s23, 8512
v_mfma_f32_16x16x32_bf16 v[96:99], a[128:131], a[180:183], v[96:99]
buffer_load_dwordx4 v4, s[8:11], s13 offen offset:2048 lds
v_mfma_f32_16x16x32_bf16 v[104:107], a[128:131], a[184:187], v[104:107]
v_mfma_f32_16x16x32_bf16 v[104:107], a[132:135], a[188:191], v[104:107]
s_waitcnt lgkmcnt(2)
ds_read_b128 a[208:211], v2 offset:8544
v_mfma_f32_16x16x32_bf16 v[104:107], a[136:139], a[192:195], v[104:107]
global_load_dwordx4 a[112:115], v3, s[20:21] offset:2048
v_mfma_f32_16x16x32_bf16 v[108:111], a[148:151], a[192:195], v[108:111]
ds_read_b128 a[180:183], v2 offset:1184
v_mfma_f32_16x16x32_bf16 v[108:111], a[144:147], a[188:191], v[108:111]
v_mfma_f32_16x16x32_bf16 v[108:111], a[140:143], a[184:187], v[108:111]
v_mfma_f32_16x16x32_bf16 v[116:119], a[140:143], a[188:191], v[116:119]
v_mfma_f32_16x16x32_bf16 v[116:119], a[144:147], a[192:195], v[116:119]
v_mfma_f32_16x16x32_bf16 v[116:119], a[148:151], a[196:199], v[116:119]
global_load_dwordx4 a[116:119], v3, s[20:21] offset:3072
v_mfma_f32_16x16x32_bf16 v[112:115], a[136:139], a[196:199], v[112:115]
ds_read_b128 a[184:187], v2 offset:2240
v_mfma_f32_16x16x32_bf16 v[112:115], a[132:135], a[192:195], v[112:115]
v_mfma_f32_16x16x32_bf16 v[112:115], a[128:131], a[188:191], v[112:115]
v_mfma_f32_16x16x32_bf16 v[120:123], a[128:131], a[192:195], v[120:123]
v_mfma_f32_16x16x32_bf16 v[120:123], a[132:135], a[196:199], v[120:123]
v_mfma_f32_16x16x32_bf16 v[120:123], a[136:139], a[200:203], v[120:123]
s_add_u32 m0, s23, 8544
v_mfma_f32_16x16x32_bf16 v[124:127], a[148:151], a[200:203], v[124:127]
s_add_u32 s20, s20, 8192
s_addc_u32 s21, s21, 0
v_mfma_f32_16x16x32_bf16 v[124:127], a[144:147], a[196:199], v[124:127]
buffer_load_dwordx4 v4, s[8:11], s13 offen offset:3072 lds
v_mfma_f32_16x16x32_bf16 v[124:127], a[140:143], a[192:195], v[124:127]
ds_read_b128 a[188:191], v2 offset:3296
v_mfma_f32_16x16x32_bf16 v[132:135], a[140:143], a[196:199], v[132:135]
v_mfma_f32_16x16x32_bf16 v[132:135], a[144:147], a[200:203], v[132:135]
s_waitcnt lgkmcnt(1)
global_load_dwordx4 a[120:123], v3, s[20:21] offset:-4096
v_mfma_f32_16x16x32_bf16 v[132:135], a[148:151], a[204:207], v[132:135]
v_mfma_f32_16x16x32_bf16 v[128:131], a[136:139], a[204:207], v[128:131]
ds_read_b128 a[192:195], v2 offset:4352
v_mfma_f32_16x16x32_bf16 v[128:131], a[132:135], a[200:203], v[128:131]
global_load_dwordx4 a[124:127], v3, s[20:21] offset:-3072
v_mfma_f32_16x16x32_bf16 v[128:131], a[128:131], a[196:199], v[128:131]
v_mfma_f32_16x16x32_bf16 v[136:139], a[128:131], a[200:203], v[136:139]
v_mfma_f32_16x16x32_bf16 v[136:139], a[132:135], a[204:207], v[136:139]
v_mfma_f32_16x16x32_bf16 v[136:139], a[136:139], a[208:211], v[136:139]
v_mfma_f32_16x16x32_bf16 v[140:143], a[148:151], a[208:211], v[140:143]
ds_read_b128 a[196:199], v2 offset:5408
v_mfma_f32_16x16x32_bf16 v[140:143], a[144:147], a[204:207], v[140:143]
v_mfma_f32_16x16x32_bf16 v[140:143], a[140:143], a[200:203], v[140:143]
s_waitcnt vmcnt(22)
v_mfma_f32_16x16x32_bf16 v[88:91], a[56:59], a[176:179], v[88:91]
s_add_u32 m0, s23, 12672
v_mfma_f32_16x16x32_bf16 v[88:91], a[60:63], a[180:183], v[88:91]
buffer_load_dwordx4 v4, s[8:11], s14 offen offset:0 lds
v_mfma_f32_16x16x32_bf16 v[88:91], a[64:67], a[184:187], v[88:91]
s_waitcnt vmcnt(18)
ds_read_b128 a[200:203], v2 offset:6464
v_mfma_f32_16x16x32_bf16 v[92:95], a[76:79], a[184:187], v[92:95]
v_mfma_f32_16x16x32_bf16 v[92:95], a[72:75], a[180:183], v[92:95]
global_load_dwordx4 a[128:131], v3, s[20:21] offset:-2048
v_mfma_f32_16x16x32_bf16 v[92:95], a[68:71], a[176:179], v[92:95]
v_mfma_f32_16x16x32_bf16 v[100:103], a[68:71], a[180:183], v[100:103]
v_mfma_f32_16x16x32_bf16 v[100:103], a[72:75], a[184:187], v[100:103]
s_waitcnt lgkmcnt(1)
global_load_dwordx4 a[132:135], v3, s[20:21] offset:-1024
v_mfma_f32_16x16x32_bf16 v[100:103], a[76:79], a[188:191], v[100:103]
ds_read_b128 a[204:207], v2 offset:7520
v_mfma_f32_16x16x32_bf16 v[96:99], a[64:67], a[188:191], v[96:99]
ds_read_b128 a[176:179], v2 offset:160
v_mfma_f32_16x16x32_bf16 v[96:99], a[60:63], a[184:187], v[96:99]
v_mfma_f32_16x16x32_bf16 v[96:99], a[56:59], a[180:183], v[96:99]
v_mfma_f32_16x16x32_bf16 v[104:107], a[56:59], a[184:187], v[104:107]
v_mfma_f32_16x16x32_bf16 v[104:107], a[60:63], a[188:191], v[104:107]
ds_read_b128 a[208:211], v2 offset:8576
v_mfma_f32_16x16x32_bf16 v[104:107], a[64:67], a[192:195], v[104:107]
global_load_dwordx4 a[136:139], v3, s[20:21] offset:0
v_mfma_f32_16x16x32_bf16 v[108:111], a[76:79], a[192:195], v[108:111]
ds_read_b128 a[180:183], v2 offset:1216
v_mfma_f32_16x16x32_bf16 v[108:111], a[72:75], a[188:191], v[108:111]
s_add_u32 m0, s23, 12704
v_mfma_f32_16x16x32_bf16 v[108:111], a[68:71], a[184:187], v[108:111]
buffer_load_dwordx4 v4, s[8:11], s14 offen offset:1024 lds
v_mfma_f32_16x16x32_bf16 v[116:119], a[68:71], a[188:191], v[116:119]
v_mfma_f32_16x16x32_bf16 v[116:119], a[72:75], a[192:195], v[116:119]
v_mfma_f32_16x16x32_bf16 v[116:119], a[76:79], a[196:199], v[116:119]
global_load_dwordx4 a[140:143], v3, s[20:21] offset:1024
v_mfma_f32_16x16x32_bf16 v[112:115], a[64:67], a[196:199], v[112:115]
ds_read_b128 a[184:187], v2 offset:2272
v_mfma_f32_16x16x32_bf16 v[112:115], a[60:63], a[192:195], v[112:115]
v_mfma_f32_16x16x32_bf16 v[112:115], a[56:59], a[188:191], v[112:115]
v_mfma_f32_16x16x32_bf16 v[120:123], a[56:59], a[192:195], v[120:123]
v_mfma_f32_16x16x32_bf16 v[120:123], a[60:63], a[196:199], v[120:123]
s_waitcnt lgkmcnt(1)
v_mfma_f32_16x16x32_bf16 v[120:123], a[64:67], a[200:203], v[120:123]
global_load_dwordx4 a[144:147], v3, s[20:21] offset:2048
v_mfma_f32_16x16x32_bf16 v[124:127], a[76:79], a[200:203], v[124:127]
ds_read_b128 a[188:191], v2 offset:3328
v_mfma_f32_16x16x32_bf16 v[124:127], a[72:75], a[196:199], v[124:127]
v_mfma_f32_16x16x32_bf16 v[124:127], a[68:71], a[192:195], v[124:127]
v_mfma_f32_16x16x32_bf16 v[132:135], a[68:71], a[196:199], v[132:135]
v_mfma_f32_16x16x32_bf16 v[132:135], a[72:75], a[200:203], v[132:135]
v_mfma_f32_16x16x32_bf16 v[132:135], a[76:79], a[204:207], v[132:135]
s_add_u32 m0, s23, 12736
global_load_dwordx4 a[148:151], v3, s[20:21] offset:3072
v_mfma_f32_16x16x32_bf16 v[128:131], a[64:67], a[204:207], v[128:131]
ds_read_b128 a[192:195], v2 offset:4384
v_mfma_f32_16x16x32_bf16 v[128:131], a[60:63], a[200:203], v[128:131]
v_mfma_f32_16x16x32_bf16 v[128:131], a[56:59], a[196:199], v[128:131]
buffer_load_dwordx4 v4, s[8:11], s14 offen offset:2048 lds
v_mfma_f32_16x16x32_bf16 v[136:139], a[56:59], a[200:203], v[136:139]
v_mfma_f32_16x16x32_bf16 v[136:139], a[60:63], a[204:207], v[136:139]
v_mfma_f32_16x16x32_bf16 v[136:139], a[64:67], a[208:211], v[136:139]
v_mfma_f32_16x16x32_bf16 v[140:143], a[76:79], a[208:211], v[140:143]
ds_read_b128 a[196:199], v2 offset:5440
v_mfma_f32_16x16x32_bf16 v[140:143], a[72:75], a[204:207], v[140:143]
v_mfma_f32_16x16x32_bf16 v[140:143], a[68:71], a[200:203], v[140:143]
s_waitcnt vmcnt(22)
v_mfma_f32_16x16x32_bf16 v[88:91], a[80:83], a[176:179], v[88:91]
v_mfma_f32_16x16x32_bf16 v[88:91], a[84:87], a[180:183], v[88:91]
s_waitcnt lgkmcnt(1)
s_add_u32 s20, s20, 8192
s_addc_u32 s21, s21, 0
v_mfma_f32_16x16x32_bf16 v[88:91], a[88:91], a[184:187], v[88:91]
s_waitcnt vmcnt(18)
global_load_dwordx4 a[56:59], v3, s[20:21] offset:-4096
v_mfma_f32_16x16x32_bf16 v[92:95], a[100:103], a[184:187], v[92:95]
ds_read_b128 a[200:203], v2 offset:6496
v_mfma_f32_16x16x32_bf16 v[92:95], a[96:99], a[180:183], v[92:95]
v_mfma_f32_16x16x32_bf16 v[92:95], a[92:95], a[176:179], v[92:95]
v_mfma_f32_16x16x32_bf16 v[100:103], a[92:95], a[180:183], v[100:103]
v_mfma_f32_16x16x32_bf16 v[100:103], a[96:99], a[184:187], v[100:103]
global_load_dwordx4 a[60:63], v3, s[20:21] offset:-3072
v_mfma_f32_16x16x32_bf16 v[100:103], a[100:103], a[188:191], v[100:103]
ds_read_b128 a[204:207], v2 offset:7552
v_mfma_f32_16x16x32_bf16 v[96:99], a[88:91], a[188:191], v[96:99]
ds_read_b128 a[176:179], v2 offset:192
v_mfma_f32_16x16x32_bf16 v[96:99], a[84:87], a[184:187], v[96:99]
v_mfma_f32_16x16x32_bf16 v[96:99], a[80:83], a[180:183], v[96:99]
v_mfma_f32_16x16x32_bf16 v[104:107], a[80:83], a[184:187], v[104:107]
v_mfma_f32_16x16x32_bf16 v[104:107], a[84:87], a[188:191], v[104:107]
ds_read_b128 a[208:211], v2 offset:8608
v_mfma_f32_16x16x32_bf16 v[104:107], a[88:91], a[192:195], v[104:107]
global_load_dwordx4 a[64:67], v3, s[20:21] offset:-2048
v_mfma_f32_16x16x32_bf16 v[108:111], a[100:103], a[192:195], v[108:111]
ds_read_b128 a[180:183], v2 offset:1248
v_mfma_f32_16x16x32_bf16 v[108:111], a[96:99], a[188:191], v[108:111]
v_mfma_f32_16x16x32_bf16 v[108:111], a[92:95], a[184:187], v[108:111]
v_mfma_f32_16x16x32_bf16 v[116:119], a[92:95], a[188:191], v[116:119]
v_mfma_f32_16x16x32_bf16 v[116:119], a[96:99], a[192:195], v[116:119]
s_waitcnt lgkmcnt(2)
v_mfma_f32_16x16x32_bf16 v[116:119], a[100:103], a[196:199], v[116:119]
global_load_dwordx4 a[68:71], v3, s[20:21] offset:-1024
v_mfma_f32_16x16x32_bf16 v[112:115], a[88:91], a[196:199], v[112:115]
ds_read_b128 a[184:187], v2 offset:2304
v_mfma_f32_16x16x32_bf16 v[112:115], a[84:87], a[192:195], v[112:115]
v_mfma_f32_16x16x32_bf16 v[112:115], a[80:83], a[188:191], v[112:115]
v_mfma_f32_16x16x32_bf16 v[120:123], a[80:83], a[192:195], v[120:123]
v_mfma_f32_16x16x32_bf16 v[120:123], a[84:87], a[196:199], v[120:123]
v_mfma_f32_16x16x32_bf16 v[120:123], a[88:91], a[200:203], v[120:123]
global_load_dwordx4 a[72:75], v3, s[20:21] offset:0
v_mfma_f32_16x16x32_bf16 v[124:127], a[100:103], a[200:203], v[124:127]
ds_read_b128 a[188:191], v2 offset:3360
v_mfma_f32_16x16x32_bf16 v[124:127], a[96:99], a[196:199], v[124:127]
v_mfma_f32_16x16x32_bf16 v[124:127], a[92:95], a[192:195], v[124:127]
v_mfma_f32_16x16x32_bf16 v[132:135], a[92:95], a[196:199], v[132:135]
v_mfma_f32_16x16x32_bf16 v[132:135], a[96:99], a[200:203], v[132:135]
v_mfma_f32_16x16x32_bf16 v[132:135], a[100:103], a[204:207], v[132:135]
global_load_dwordx4 a[76:79], v3, s[20:21] offset:1024
v_mfma_f32_16x16x32_bf16 v[128:131], a[88:91], a[204:207], v[128:131]
ds_read_b128 a[192:195], v2 offset:4416
v_mfma_f32_16x16x32_bf16 v[128:131], a[84:87], a[200:203], v[128:131]
v_mfma_f32_16x16x32_bf16 v[128:131], a[80:83], a[196:199], v[128:131]
v_mfma_f32_16x16x32_bf16 v[136:139], a[80:83], a[200:203], v[136:139]
v_mfma_f32_16x16x32_bf16 v[136:139], a[84:87], a[204:207], v[136:139]
s_waitcnt lgkmcnt(1)
v_mfma_f32_16x16x32_bf16 v[136:139], a[88:91], a[208:211], v[136:139]
v_mfma_f32_16x16x32_bf16 v[140:143], a[100:103], a[208:211], v[140:143]
ds_read_b128 a[196:199], v2 offset:5472
v_mfma_f32_16x16x32_bf16 v[140:143], a[96:99], a[204:207], v[140:143]
v_mfma_f32_16x16x32_bf16 v[140:143], a[92:95], a[200:203], v[140:143]
s_waitcnt vmcnt(19)
v_mfma_f32_16x16x32_bf16 v[88:91], a[104:107], a[176:179], v[88:91]
s_mov_b32 s36, L_h3-L_pc
v_mfma_f32_16x16x32_bf16 v[88:91], a[108:111], a[180:183], v[88:91]
s_mov_b32 s30, L_h4+128-L_pc
global_load_dwordx4 a[80:83], v3, s[20:21] offset:2048
v_mfma_f32_16x16x32_bf16 v[88:91], a[112:115], a[184:187], v[88:91]
s_waitcnt vmcnt(16)
ds_read_b128 a[200:203], v2 offset:6528
v_mfma_f32_16x16x32_bf16 v[92:95], a[124:127], a[184:187], v[92:95]
v_mfma_f32_16x16x32_bf16 v[92:95], a[120:123], a[180:183], v[92:95]
buffer_load_dword a252, v8, s[28:31], s36 offen
v_mfma_f32_16x16x32_bf16 v[92:95], a[116:119], a[176:179], v[92:95]
v_mfma_f32_16x16x32_bf16 v[100:103], a[116:119], a[180:183], v[100:103]
v_mfma_f32_16x16x32_bf16 v[100:103], a[120:123], a[184:187], v[100:103]
global_load_dwordx4 a[84:87], v3, s[20:21] offset:3072
v_mfma_f32_16x16x32_bf16 v[100:103], a[124:127], a[188:191], v[100:103]
ds_read_b128 a[204:207], v2 offset:7584
v_mfma_f32_16x16x32_bf16 v[96:99], a[112:115], a[188:191], v[96:99]
ds_read_b128 a[176:179], v2 offset:224
v_mfma_f32_16x16x32_bf16 v[96:99], a[108:111], a[184:187], v[96:99]
v_mfma_f32_16x16x32_bf16 v[96:99], a[104:107], a[180:183], v[96:99]
v_mfma_f32_16x16x32_bf16 v[104:107], a[104:107], a[184:187], v[104:107]
v_mfma_f32_16x16x32_bf16 v[104:107], a[108:111], a[188:191], v[104:107]
s_waitcnt lgkmcnt(2)
s_add_u32 s20, s20, 8192
s_addc_u32 s21, s21, 0
v_mfma_f32_16x16x32_bf16 v[104:107], a[112:115], a[192:195], v[104:107]
ds_read_b128 a[208:211], v2 offset:8640
v_mfma_f32_16x16x32_bf16 v[108:111], a[124:127], a[192:195], v[108:111]
global_load_dwordx4 a[88:91], v3, s[20:21] offset:-4096
v_mfma_f32_16x16x32_bf16 v[108:111], a[120:123], a[188:191], v[108:111]
ds_read_b128 a[180:183], v2 offset:1280
v_mfma_f32_16x16x32_bf16 v[108:111], a[116:119], a[184:187], v[108:111]
v_mfma_f32_16x16x32_bf16 v[116:119], a[116:119], a[188:191], v[116:119]
v_mfma_f32_16x16x32_bf16 v[116:119], a[120:123], a[192:195], v[116:119]
v_mfma_f32_16x16x32_bf16 v[116:119], a[124:127], a[196:199], v[116:119]
global_load_dwordx4 a[92:95], v3, s[20:21] offset:-3072
v_mfma_f32_16x16x32_bf16 v[112:115], a[112:115], a[196:199], v[112:115]
ds_read_b128 a[184:187], v2 offset:2336
v_mfma_f32_16x16x32_bf16 v[112:115], a[108:111], a[192:195], v[112:115]
v_mfma_f32_16x16x32_bf16 v[112:115], a[104:107], a[188:191], v[112:115]
v_mfma_f32_16x16x32_bf16 v[120:123], a[104:107], a[192:195], v[120:123]
v_mfma_f32_16x16x32_bf16 v[120:123], a[108:111], a[196:199], v[120:123]
v_mfma_f32_16x16x32_bf16 v[120:123], a[112:115], a[200:203], v[120:123]
global_load_dwordx4 a[96:99], v3, s[20:21] offset:-2048
v_mfma_f32_16x16x32_bf16 v[124:127], a[124:127], a[200:203], v[124:127]
ds_read_b128 a[188:191], v2 offset:3392
v_mfma_f32_16x16x32_bf16 v[124:127], a[120:123], a[196:199], v[124:127]
v_mfma_f32_16x16x32_bf16 v[124:127], a[116:119], a[192:195], v[124:127]
v_mfma_f32_16x16x32_bf16 v[132:135], a[116:119], a[196:199], v[132:135]
v_mfma_f32_16x16x32_bf16 v[132:135], a[120:123], a[200:203], v[132:135]
s_waitcnt lgkmcnt(1)
v_mfma_f32_16x16x32_bf16 v[132:135], a[124:127], a[204:207], v[132:135]
global_load_dwordx4 a[100:103], v3, s[20:21] offset:-1024
v_mfma_f32_16x16x32_bf16 v[128:131], a[112:115], a[204:207], v[128:131]
ds_read_b128 a[192:195], v2 offset:4448
v_mfma_f32_16x16x32_bf16 v[128:131], a[108:111], a[200:203], v[128:131]
v_mfma_f32_16x16x32_bf16 v[128:131], a[104:107], a[196:199], v[128:131]
v_mfma_f32_16x16x32_bf16 v[136:139], a[104:107], a[200:203], v[136:139]
v_mfma_f32_16x16x32_bf16 v[136:139], a[108:111], a[204:207], v[136:139]
v_mfma_f32_16x16x32_bf16 v[136:139], a[112:115], a[208:211], v[136:139]
v_mfma_f32_16x16x32_bf16 v[140:143], a[124:127], a[208:211], v[140:143]
ds_read_b128 a[196:199], v2 offset:5504
v_mfma_f32_16x16x32_bf16 v[140:143], a[120:123], a[204:207], v[140:143]
v_mfma_f32_16x16x32_bf16 v[140:143], a[116:119], a[200:203], v[140:143]
s_waitcnt vmcnt(18)
v_mfma_f32_16x16x32_bf16 v[88:91], a[128:131], a[176:179], v[88:91]
ds_read_b128 a[200:203], v2 offset:6560
v_mfma_f32_16x16x32_bf16 v[88:91], a[132:135], a[180:183], v[88:91]
global_load_dwordx4 a[104:107], v3, s[20:21] offset:0
v_mfma_f32_16x16x32_bf16 v[88:91], a[136:139], a[184:187], v[88:91]
s_waitcnt vmcnt(15)
ds_read_b128 a[204:207], v2 offset:7616
v_mfma_f32_16x16x32_bf16 v[92:95], a[148:151], a[184:187], v[92:95]
v_mfma_f32_16x16x32_bf16 v[92:95], a[144:147], a[180:183], v[92:95]
ds_read_b128 a[208:211], v2 offset:8672
v_mfma_f32_16x16x32_bf16 v[92:95], a[140:143], a[176:179], v[92:95]
v_mfma_f32_16x16x32_bf16 v[100:103], a[140:143], a[180:183], v[100:103]
v_mfma_f32_16x16x32_bf16 v[100:103], a[144:147], a[184:187], v[100:103]
s_waitcnt lgkmcnt(3)
global_load_dwordx4 a[108:111], v3, s[20:21] offset:1024
v_mfma_f32_16x16x32_bf16 v[100:103], a[148:151], a[188:191], v[100:103]
v_mfma_f32_16x16x32_bf16 v[96:99], a[136:139], a[188:191], v[96:99]
v_mfma_f32_16x16x32_bf16 v[96:99], a[132:135], a[184:187], v[96:99]
v_mfma_f32_16x16x32_bf16 v[96:99], a[128:131], a[180:183], v[96:99]
v_mfma_f32_16x16x32_bf16 v[104:107], a[128:131], a[184:187], v[104:107]
v_mfma_f32_16x16x32_bf16 v[104:107], a[132:135], a[188:191], v[104:107]
global_load_dwordx4 a[112:115], v3, s[20:21] offset:2048
v_mfma_f32_16x16x32_bf16 v[104:107], a[136:139], a[192:195], v[104:107]
s_waitcnt vmcnt(16)
v_mfma_f32_16x16x32_bf16 v[108:111], a[148:151], a[192:195], v[108:111]
s_nop 0
s_waitcnt lgkmcnt(0)
s_barrier
v_mfma_f32_16x16x32_bf16 v[108:111], a[144:147], a[188:191], v[108:111]
ds_read_b128 a[176:179], v1 offset:0
v_mfma_f32_16x16x32_bf16 v[108:111], a[140:143], a[184:187], v[108:111]
v_mfma_f32_16x16x32_bf16 v[116:119], a[140:143], a[188:191], v[116:119]
s_add_u32 s8, s8, 3280896
s_addc_u32 s9, s9, 0
v_mfma_f32_16x16x32_bf16 v[116:119], a[144:147], a[192:195], v[116:119]
L_stub1:
s_cmp_eq_u32 s37, 1
s_cbranch_scc1 L_stub5
s_add_u32 m0, s23, 63360
ds_read_b128 a[180:183], v1 offset:1056
v_mfma_f32_16x16x32_bf16 v[116:119], a[148:151], a[196:199], v[116:119]
buffer_load_dwordx4 v4, s[8:11], 0 offen offset:0 lds
v_mfma_f32_16x16x32_bf16 v[112:115], a[136:139], a[196:199], v[112:115]
ds_read_b128 a[184:187], v1 offset:2112
v_mfma_f32_16x16x32_bf16 v[112:115], a[132:135], a[192:195], v[112:115]
v_mfma_f32_16x16x32_bf16 v[112:115], a[128:131], a[188:191], v[112:115]
global_load_dwordx4 a[116:119], v3, s[20:21] offset:3072
v_mfma_f32_16x16x32_bf16 v[120:123], a[128:131], a[192:195], v[120:123]
v_mfma_f32_16x16x32_bf16 v[120:123], a[132:135], a[196:199], v[120:123]
v_mfma_f32_16x16x32_bf16 v[120:123], a[136:139], a[200:203], v[120:123]
s_add_u32 s20, s20, 8192
s_addc_u32 s21, s21, 0
v_mfma_f32_16x16x32_bf16 v[124:127], a[148:151], a[200:203], v[124:127]
global_load_dwordx4 a[120:123], v3, s[20:21] offset:-4096
v_mfma_f32_16x16x32_bf16 v[124:127], a[144:147], a[196:199], v[124:127]
ds_read_b128 a[188:191], v1 offset:3168
v_mfma_f32_16x16x32_bf16 v[124:127], a[140:143], a[192:195], v[124:127]
v_mfma_f32_16x16x32_bf16 v[132:135], a[140:143], a[196:199], v[132:135]
v_mfma_f32_16x16x32_bf16 v[132:135], a[144:147], a[200:203], v[132:135]
v_mfma_f32_16x16x32_bf16 v[132:135], a[148:151], a[204:207], v[132:135]
global_load_dwordx4 a[124:127], v3, s[20:21] offset:-3072
v_mfma_f32_16x16x32_bf16 v[128:131], a[136:139], a[204:207], v[128:131]
ds_read_b128 a[192:195], v1 offset:4224
v_mfma_f32_16x16x32_bf16 v[128:131], a[132:135], a[200:203], v[128:131]
s_add_u32 m0, s23, 63392
v_mfma_f32_16x16x32_bf16 v[128:131], a[128:131], a[196:199], v[128:131]
buffer_load_dwordx4 v4, s[8:11], 0 offen offset:1024 lds
v_mfma_f32_16x16x32_bf16 v[136:139], a[128:131], a[200:203], v[136:139]
v_mfma_f32_16x16x32_bf16 v[136:139], a[132:135], a[204:207], v[136:139]
v_mfma_f32_16x16x32_bf16 v[136:139], a[136:139], a[208:211], v[136:139]
v_mfma_f32_16x16x32_bf16 v[140:143], a[148:151], a[208:211], v[140:143]
ds_read_b128 a[196:199], v1 offset:5280
v_mfma_f32_16x16x32_bf16 v[140:143], a[144:147], a[204:207], v[140:143]
v_mfma_f32_16x16x32_bf16 v[140:143], a[140:143], a[200:203], v[140:143]
s_waitcnt vmcnt(18) lgkmcnt(2)
L_h2:
v_mfma_f32_16x16x32_bf16 v[144:147], a[56:59], a[176:179], 0
v_mfma_f32_16x16x32_bf16 v[144:147], a[60:63], a[180:183], v[144:147]
global_load_dwordx4 a[128:131], v3, s[20:21] offset:-2048
v_mfma_f32_16x16x32_bf16 v[144:147], a[64:67], a[184:187], v[144:147]
s_waitcnt vmcnt(16)
ds_read_b128 a[200:203], v1 offset:6336
v_mfma_f32_16x16x32_bf16 v[148:151], a[76:79], a[184:187], 0
v_mfma_f32_16x16x32_bf16 v[148:151], a[72:75], a[180:183], v[148:151]
v_mfma_f32_16x16x32_bf16 v[148:151], a[68:71], a[176:179], v[148:151]
v_mfma_f32_16x16x32_bf16 v[156:159], a[68:71], a[180:183], 0
v_mfma_f32_16x16x32_bf16 v[156:159], a[72:75], a[184:187], v[156:159]
global_load_dwordx4 a[132:135], v3, s[20:21] offset:-1024
v_mfma_f32_16x16x32_bf16 v[156:159], a[76:79], a[188:191], v[156:159]
s_add_u32 m0, s23, 63424
ds_read_b128 a[204:207], v1 offset:7392
v_mfma_f32_16x16x32_bf16 v[152:155], a[64:67], a[188:191], 0
ds_read_b128 a[176:179], v1 offset:32
v_add_f32 v10, v32, v88
v_mfma_f32_16x16x32_bf16 v[152:155], a[60:63], a[184:187], v[152:155]
buffer_load_dwordx4 v4, s[8:11], 0 offen offset:2048 lds
v_mfma_f32_16x16x32_bf16 v[152:155], a[56:59], a[180:183], v[152:155]
v_add_f32 v11, v33, v89
v_mfma_f32_16x16x32_bf16 v[160:163], a[56:59], a[184:187], 0
v_mfma_f32_16x16x32_bf16 v[160:163], a[60:63], a[188:191], v[160:163]
s_waitcnt lgkmcnt(2)
ds_read_b128 a[208:211], v1 offset:8448
v_mfma_f32_16x16x32_bf16 v[160:163], a[64:67], a[192:195], v[160:163]
global_load_dwordx4 a[136:139], v3, s[20:21] offset:0
v_accvgpr_write_b32 a0, v10
v_mfma_f32_16x16x32_bf16 v[164:167], a[76:79], a[192:195], 0
ds_read_b128 a[180:183], v1 offset:1088
v_mfma_f32_16x16x32_bf16 v[164:167], a[72:75], a[188:191], v[164:167]
v_mfma_f32_16x16x32_bf16 v[164:167], a[68:71], a[184:187], v[164:167]
v_accvgpr_write_b32 a1, v11
v_mfma_f32_16x16x32_bf16 v[172:175], a[68:71], a[188:191], 0
v_mfma_f32_16x16x32_bf16 v[172:175], a[72:75], a[192:195], v[172:175]
v_add_f32 v12, v34, v90
v_mfma_f32_16x16x32_bf16 v[172:175], a[76:79], a[196:199], v[172:175]
global_load_dwordx4 a[140:143], v3, s[20:21] offset:1024
v_mfma_f32_16x16x32_bf16 v[168:171], a[64:67], a[196:199], 0
ds_read_b128 a[184:187], v1 offset:2144
v_mfma_f32_16x16x32_bf16 v[168:171], a[60:63], a[192:195], v[168:171]
v_add_f32 v13, v35, v91
v_mfma_f32_16x16x32_bf16 v[168:171], a[56:59], a[188:191], v[168:171]
v_mfma_f32_16x16x32_bf16 v[176:179], a[56:59], a[192:195], 0
s_add_u32 m0, s23, 63456
v_mfma_f32_16x16x32_bf16 v[176:179], a[60:63], a[196:199], v[176:179]
buffer_load_dwordx4 v4, s[8:11], 0 offen offset:3072 lds
v_accvgpr_write_b32 a2, v12
v_mfma_f32_16x16x32_bf16 v[176:179], a[64:67], a[200:203], v[176:179]
v_mfma_f32_16x16x32_bf16 v[180:183], a[76:79], a[200:203], 0
ds_read_b128 a[188:191], v1 offset:3200
v_mfma_f32_16x16x32_bf16 v[180:183], a[72:75], a[196:199], v[180:183]
global_load_dwordx4 a[144:147], v3, s[20:21] offset:2048
v_accvgpr_write_b32 a3, v13
v_mfma_f32_16x16x32_bf16 v[180:183], a[68:71], a[192:195], v[180:183]
v_mfma_f32_16x16x32_bf16 v[188:191], a[68:71], a[196:199], 0
v_add_f32 v10, v36, v92
v_mfma_f32_16x16x32_bf16 v[188:191], a[72:75], a[200:203], v[188:191]
s_waitcnt lgkmcnt(1)
v_mfma_f32_16x16x32_bf16 v[188:191], a[76:79], a[204:207], v[188:191]
global_load_dwordx4 a[148:151], v3, s[20:21] offset:3072
v_add_f32 v11, v37, v93
v_mfma_f32_16x16x32_bf16 v[184:187], a[64:67], a[204:207], 0
ds_read_b128 a[192:195], v1 offset:4256
v_mfma_f32_16x16x32_bf16 v[184:187], a[60:63], a[200:203], v[184:187]
v_mfma_f32_16x16x32_bf16 v[184:187], a[56:59], a[196:199], v[184:187]
v_accvgpr_write_b32 a4, v10
v_mfma_f32_16x16x32_bf16 v[192:195], a[56:59], a[200:203], 0
v_accvgpr_write_b32 a5, v11
v_mfma_f32_16x16x32_bf16 v[192:195], a[60:63], a[204:207], v[192:195]
v_mfma_f32_16x16x32_bf16 v[192:195], a[64:67], a[208:211], v[192:195]
v_add_f32 v12, v38, v94
v_mfma_f32_16x16x32_bf16 v[196:199], a[76:79], a[208:211], 0
ds_read_b128 a[196:199], v1 offset:5312
v_mfma_f32_16x16x32_bf16 v[196:199], a[72:75], a[204:207], v[196:199]
s_add_u32 m0, s23, 67584
v_mfma_f32_16x16x32_bf16 v[196:199], a[68:71], a[200:203], v[196:199]
s_waitcnt vmcnt(19)
buffer_load_dwordx4 v4, s[8:11], s12 offen offset:0 lds
v_mfma_f32_16x16x32_bf16 v[144:147], a[80:83], a[176:179], v[144:147]
v_add_f32 v13, v39, v95
v_mfma_f32_16x16x32_bf16 v[144:147], a[84:87], a[180:183], v[144:147]
s_add_u32 s20, s20, 8192
s_addc_u32 s21, s21, 0
v_mfma_f32_16x16x32_bf16 v[144:147], a[88:91], a[184:187], v[144:147]
s_waitcnt vmcnt(17)
global_load_dwordx4 a[56:59], v3, s[20:21] offset:-4096
v_mfma_f32_16x16x32_bf16 v[148:151], a[100:103], a[184:187], v[148:151]
ds_read_b128 a[200:203], v1 offset:6368
v_accvgpr_write_b32 a6, v12
v_mfma_f32_16x16x32_bf16 v[148:151], a[96:99], a[180:183], v[148:151]
v_mfma_f32_16x16x32_bf16 v[148:151], a[92:95], a[176:179], v[148:151]
v_accvgpr_write_b32 a7, v13
v_mfma_f32_16x16x32_bf16 v[156:159], a[92:95], a[180:183], v[156:159]
v_mfma_f32_16x16x32_bf16 v[156:159], a[96:99], a[184:187], v[156:159]
s_waitcnt lgkmcnt(1)
global_load_dwordx4 a[60:63], v3, s[20:21] offset:-3072
v_mfma_f32_16x16x32_bf16 v[156:159], a[100:103], a[188:191], v[156:159]
ds_read_b128 a[204:207], v1 offset:7424
v_add_f32 v10, v40, v96
v_mfma_f32_16x16x32_bf16 v[152:155], a[88:91], a[188:191], v[152:155]
ds_read_b128 a[176:179], v1 offset:64
v_mfma_f32_16x16x32_bf16 v[152:155], a[84:87], a[184:187], v[152:155]
v_mfma_f32_16x16x32_bf16 v[152:155], a[80:83], a[180:183], v[152:155]
v_add_f32 v11, v41, v97
v_mfma_f32_16x16x32_bf16 v[160:163], a[80:83], a[184:187], v[160:163]
v_mfma_f32_16x16x32_bf16 v[160:163], a[84:87], a[188:191], v[160:163]
ds_read_b128 a[208:211], v1 offset:8480
v_mfma_f32_16x16x32_bf16 v[160:163], a[88:91], a[192:195], v[160:163]
s_add_u32 m0, s23, 67616
global_load_dwordx4 a[64:67], v3, s[20:21] offset:-2048
v_mfma_f32_16x16x32_bf16 v[164:167], a[100:103], a[192:195], v[164:167]
ds_read_b128 a[180:183], v1 offset:1120
v_accvgpr_write_b32 a8, v10
v_mfma_f32_16x16x32_bf16 v[164:167], a[96:99], a[188:191], v[164:167]
v_mfma_f32_16x16x32_bf16 v[164:167], a[92:95], a[184:187], v[164:167]
buffer_load_dwordx4 v4, s[8:11], s12 offen offset:1024 lds
v_mfma_f32_16x16x32_bf16 v[172:175], a[92:95], a[188:191], v[172:175]
v_accvgpr_write_b32 a9, v11
v_mfma_f32_16x16x32_bf16 v[172:175], a[96:99], a[192:195], v[172:175]
v_mfma_f32_16x16x32_bf16 v[172:175], a[100:103], a[196:199], v[172:175]
global_load_dwordx4 a[68:71], v3, s[20:21] offset:-1024
v_add_f32 v12, v42, v98
v_mfma_f32_16x16x32_bf16 v[168:171], a[88:91], a[196:199], v[168:171]
ds_read_b128 a[184:187], v1 offset:2176
v_mfma_f32_16x16x32_bf16 v[168:171], a[84:87], a[192:195], v[168:171]
v_add_f32 v13, v43, v99
v_mfma_f32_16x16x32_bf16 v[168:171], a[80:83], a[188:191], v[168:171]
v_mfma_f32_16x16x32_bf16 v[176:179], a[80:83], a[192:195], v[176:179]
v_mfma_f32_16x16x32_bf16 v[176:179], a[84:87], a[196:199], v[176:179]
s_waitcnt lgkmcnt(1)
v_accvgpr_write_b32 a10, v12
v_mfma_f32_16x16x32_bf16 v[176:179], a[88:91], a[200:203], v[176:179]
global_load_dwordx4 a[72:75], v3, s[20:21] offset:0
v_accvgpr_write_b32 a11, v13
v_mfma_f32_16x16x32_bf16 v[180:183], a[100:103], a[200:203], v[180:183]
ds_read_b128 a[188:191], v1 offset:3232
v_mfma_f32_16x16x32_bf16 v[180:183], a[96:99], a[196:199], v[180:183]
v_mfma_f32_16x16x32_bf16 v[180:183], a[92:95], a[192:195], v[180:183]
v_mfma_f32_16x16x32_bf16 v[188:191], a[92:95], a[196:199], v[188:191]
s_add_u32 m0, s23, 67648
v_add_f32 v10, v44, v100
v_mfma_f32_16x16x32_bf16 v[188:191], a[96:99], a[200:203], v[188:191]
buffer_load_dwordx4 v4, s[8:11], s12 offen offset:2048 lds
v_mfma_f32_16x16x32_bf16 v[188:191], a[100:103], a[204:207], v[188:191]
v_mfma_f32_16x16x32_bf16 v[184:187], a[88:91], a[204:207], v[184:187]
ds_read_b128 a[192:195], v1 offset:4288
v_mfma_f32_16x16x32_bf16 v[184:187], a[84:87], a[200:203], v[184:187]
global_load_dwordx4 a[76:79], v3, s[20:21] offset:1024
v_add_f32 v11, v45, v101
v_mfma_f32_16x16x32_bf16 v[184:187], a[80:83], a[196:199], v[184:187]
v_accvgpr_write_b32 a12, v10
v_mfma_f32_16x16x32_bf16 v[192:195], a[80:83], a[200:203], v[192:195]
v_mfma_f32_16x16x32_bf16 v[192:195], a[84:87], a[204:207], v[192:195]
v_accvgpr_write_b32 a13, v11
v_mfma_f32_16x16x32_bf16 v[192:195], a[88:91], a[208:211], v[192:195]
v_add_f32 v12, v46, v102
v_mfma_f32_16x16x32_bf16 v[196:199], a[100:103], a[208:211], v[196:199]
ds_read_b128 a[196:199], v1 offset:5344
v_mfma_f32_16x16x32_bf16 v[196:199], a[96:99], a[204:207], v[196:199]
v_mfma_f32_16x16x32_bf16 v[196:199], a[92:95], a[200:203], v[196:199]
s_waitcnt vmcnt(22)
v_add_f32 v13, v47, v103
v_mfma_f32_16x16x32_bf16 v[144:147], a[104:107], a[176:179], v[144:147]
v_mfma_f32_16x16x32_bf16 v[144:147], a[108:111], a[180:183], v[144:147]
s_waitcnt lgkmcnt(1) vmcnt(18)
global_load_dwordx4 a[80:83], v3, s[20:21] offset:2048
v_mfma_f32_16x16x32_bf16 v[144:147], a[112:115], a[184:187], v[144:147]
ds_read_b128 a[200:203], v1 offset:6400
v_accvgpr_write_b32 a14, v12
v_mfma_f32_16x16x32_bf16 v[148:151], a[124:127], a[184:187], v[148:151]
v_mfma_f32_16x16x32_bf16 v[148:151], a[120:123], a[180:183], v[148:151]
s_add_u32 m0, s23, 67680
v_mfma_f32_16x16x32_bf16 v[148:151], a[116:119], a[176:179], v[148:151]
buffer_load_dwordx4 v4, s[8:11], s12 offen offset:3072 lds
v_mfma_f32_16x16x32_bf16 v[156:159], a[116:119], a[180:183], v[156:159]
v_accvgpr_write_b32 a15, v13
v_mfma_f32_16x16x32_bf16 v[156:159], a[120:123], a[184:187], v[156:159]
ds_read_b128 a[204:207], v1 offset:7456
v_mfma_f32_16x16x32_bf16 v[156:159], a[124:127], a[188:191], v[156:159]
global_load_dwordx4 a[84:87], v3, s[20:21] offset:3072
v_add_f32 v10, v48, v104
v_mfma_f32_16x16x32_bf16 v[152:155], a[112:115], a[188:191], v[152:155]
ds_read_b128 a[176:179], v1 offset:96
v_mfma_f32_16x16x32_bf16 v[152:155], a[108:111], a[184:187], v[152:155]
v_mfma_f32_16x16x32_bf16 v[152:155], a[104:107], a[180:183], v[152:155]
v_add_f32 v11, v49, v105
v_mfma_f32_16x16x32_bf16 v[160:163], a[104:107], a[184:187], v[160:163]
v_mfma_f32_16x16x32_bf16 v[160:163], a[108:111], a[188:191], v[160:163]
s_add_u32 s20, s20, 8192
s_addc_u32 s21, s21, 0
v_mfma_f32_16x16x32_bf16 v[160:163], a[112:115], a[192:195], v[160:163]
ds_read_b128 a[208:211], v1 offset:8512
v_accvgpr_write_b32 a16, v10
v_mfma_f32_16x16x32_bf16 v[164:167], a[124:127], a[192:195], v[164:167]
global_load_dwordx4 a[88:91], v3, s[20:21] offset:-4096
v_mfma_f32_16x16x32_bf16 v[164:167], a[120:123], a[188:191], v[164:167]
ds_read_b128 a[180:183], v1 offset:1152
v_mfma_f32_16x16x32_bf16 v[164:167], a[116:119], a[184:187], v[164:167]
v_accvgpr_write_b32 a17, v11
v_mfma_f32_16x16x32_bf16 v[172:175], a[116:119], a[188:191], v[172:175]
v_mfma_f32_16x16x32_bf16 v[172:175], a[120:123], a[192:195], v[172:175]
s_waitcnt lgkmcnt(2)
v_mfma_f32_16x16x32_bf16 v[172:175], a[124:127], a[196:199], v[172:175]
s_add_u32 m0, s23, 71808
global_load_dwordx4 a[92:95], v3, s[20:21] offset:-3072
v_mfma_f32_16x16x32_bf16 v[168:171], a[112:115], a[196:199], v[168:171]
ds_read_b128 a[184:187], v1 offset:2208
v_add_f32 v12, v50, v106
v_mfma_f32_16x16x32_bf16 v[168:171], a[108:111], a[192:195], v[168:171]
v_mfma_f32_16x16x32_bf16 v[168:171], a[104:107], a[188:191], v[168:171]
buffer_load_dwordx4 v4, s[8:11], s13 offen offset:0 lds
v_mfma_f32_16x16x32_bf16 v[176:179], a[104:107], a[192:195], v[176:179]
v_add_f32 v13, v51, v107
v_mfma_f32_16x16x32_bf16 v[176:179], a[108:111], a[196:199], v[176:179]
v_accvgpr_write_b32 a18, v12
v_mfma_f32_16x16x32_bf16 v[176:179], a[112:115], a[200:203], v[176:179]
global_load_dwordx4 a[96:99], v3, s[20:21] offset:-2048
v_mfma_f32_16x16x32_bf16 v[180:183], a[124:127], a[200:203], v[180:183]
ds_read_b128 a[188:191], v1 offset:3264
v_mfma_f32_16x16x32_bf16 v[180:183], a[120:123], a[196:199], v[180:183]
v_accvgpr_write_b32 a19, v13
v_mfma_f32_16x16x32_bf16 v[180:183], a[116:119], a[192:195], v[180:183]
v_mfma_f32_16x16x32_bf16 v[188:191], a[116:119], a[196:199], v[188:191]
v_add_f32 v10, v52, v108
v_mfma_f32_16x16x32_bf16 v[188:191], a[120:123], a[200:203], v[188:191]
v_mfma_f32_16x16x32_bf16 v[188:191], a[124:127], a[204:207], v[188:191]
global_load_dwordx4 a[100:103], v3, s[20:21] offset:-1024
v_add_f32 v11, v53, v109
v_mfma_f32_16x16x32_bf16 v[184:187], a[112:115], a[204:207], v[184:187]
ds_read_b128 a[192:195], v1 offset:4320
v_mfma_f32_16x16x32_bf16 v[184:187], a[108:111], a[200:203], v[184:187]
v_mfma_f32_16x16x32_bf16 v[184:187], a[104:107], a[196:199], v[184:187]
v_mfma_f32_16x16x32_bf16 v[192:195], a[104:107], a[200:203], v[192:195]
s_add_u32 m0, s23, 71840
v_accvgpr_write_b32 a20, v10
v_mfma_f32_16x16x32_bf16 v[192:195], a[108:111], a[204:207], v[192:195]
s_waitcnt lgkmcnt(1)
buffer_load_dwordx4 v4, s[8:11], s13 offen offset:1024 lds
v_mfma_f32_16x16x32_bf16 v[192:195], a[112:115], a[208:211], v[192:195]
v_accvgpr_write_b32 a21, v11
v_mfma_f32_16x16x32_bf16 v[196:199], a[124:127], a[208:211], v[196:199]
ds_read_b128 a[196:199], v1 offset:5376
v_mfma_f32_16x16x32_bf16 v[196:199], a[120:123], a[204:207], v[196:199]
v_add_f32 v12, v54, v110
v_mfma_f32_16x16x32_bf16 v[196:199], a[116:119], a[200:203], v[196:199]
s_waitcnt vmcnt(22)
v_mfma_f32_16x16x32_bf16 v[144:147], a[128:131], a[176:179], v[144:147]
v_add_f32 v13, v55, v111
v_mfma_f32_16x16x32_bf16 v[144:147], a[132:135], a[180:183], v[144:147]
global_load_dwordx4 a[104:107], v3, s[20:21] offset:0
v_mfma_f32_16x16x32_bf16 v[144:147], a[136:139], a[184:187], v[144:147]
s_waitcnt vmcnt(19)
ds_read_b128 a[200:203], v1 offset:6432
v_mfma_f32_16x16x32_bf16 v[148:151], a[148:151], a[184:187], v[148:151]
v_accvgpr_write_b32 a22, v12
v_mfma_f32_16x16x32_bf16 v[148:151], a[144:147], a[180:183], v[148:151]
v_mfma_f32_16x16x32_bf16 v[148:151], a[140:143], a[176:179], v[148:151]
v_accvgpr_write_b32 a23, v13
v_mfma_f32_16x16x32_bf16 v[156:159], a[140:143], a[180:183], v[156:159]
v_mfma_f32_16x16x32_bf16 v[156:159], a[144:147], a[184:187], v[156:159]
global_load_dwordx4 a[108:111], v3, s[20:21] offset:1024
v_mfma_f32_16x16x32_bf16 v[156:159], a[148:151], a[188:191], v[156:159]
ds_read_b128 a[204:207], v1 offset:7488
v_add_f32 v10, v56, v112
v_mfma_f32_16x16x32_bf16 v[152:155], a[136:139], a[188:191], v[152:155]
ds_read_b128 a[176:179], v1 offset:128
v_mfma_f32_16x16x32_bf16 v[152:155], a[132:135], a[184:187], v[152:155]
s_add_u32 m0, s23, 71872
v_mfma_f32_16x16x32_bf16 v[152:155], a[128:131], a[180:183], v[152:155]
buffer_load_dwordx4 v4, s[8:11], s13 offen offset:2048 lds
v_mfma_f32_16x16x32_bf16 v[160:163], a[128:131], a[184:187], v[160:163]
v_add_f32 v11, v57, v113
v_mfma_f32_16x16x32_bf16 v[160:163], a[132:135], a[188:191], v[160:163]
s_waitcnt lgkmcnt(2)
ds_read_b128 a[208:211], v1 offset:8544
v_mfma_f32_16x16x32_bf16 v[160:163], a[136:139], a[192:195], v[160:163]
global_load_dwordx4 a[112:115], v3, s[20:21] offset:2048
v_mfma_f32_16x16x32_bf16 v[164:167], a[148:151], a[192:195], v[164:167]
ds_read_b128 a[180:183], v1 offset:1184
v_mfma_f32_16x16x32_bf16 v[164:167], a[144:147], a[188:191], v[164:167]
v_accvgpr_write_b32 a24, v10
v_mfma_f32_16x16x32_bf16 v[164:167], a[140:143], a[184:187], v[164:167]
v_mfma_f32_16x16x32_bf16 v[172:175], a[140:143], a[188:191], v[172:175]
v_accvgpr_write_b32 a25, v11
v_mfma_f32_16x16x32_bf16 v[172:175], a[144:147], a[192:195], v[172:175]
v_mfma_f32_16x16x32_bf16 v[172:175], a[148:151], a[196:199], v[172:175]
global_load_dwordx4 a[116:119], v3, s[20:21] offset:3072
v_add_f32 v12, v58, v114
v_mfma_f32_16x16x32_bf16 v[168:171], a[136:139], a[196:199], v[168:171]
ds_read_b128 a[184:187], v1 offset:2240
v_mfma_f32_16x16x32_bf16 v[168:171], a[132:135], a[192:195], v[168:171]
v_add_f32 v13, v59, v115
v_mfma_f32_16x16x32_bf16 v[168:171], a[128:131], a[188:191], v[168:171]
v_mfma_f32_16x16x32_bf16 v[176:179], a[128:131], a[192:195], v[176:179]
v_mfma_f32_16x16x32_bf16 v[176:179], a[132:135], a[196:199], v[176:179]
v_accvgpr_write_b32 a26, v12
v_mfma_f32_16x16x32_bf16 v[176:179], a[136:139], a[200:203], v[176:179]
s_add_u32 m0, s23, 71904
v_mfma_f32_16x16x32_bf16 v[180:183], a[148:151], a[200:203], v[180:183]
s_add_u32 s20, s20, 8192
s_addc_u32 s21, s21, 0
v_mfma_f32_16x16x32_bf16 v[180:183], a[144:147], a[196:199], v[180:183]
buffer_load_dwordx4 v4, s[8:11], s13 offen offset:3072 lds
v_mfma_f32_16x16x32_bf16 v[180:183], a[140:143], a[192:195], v[180:183]
ds_read_b128 a[188:191], v1 offset:3296
v_accvgpr_write_b32 a27, v13
v_mfma_f32_16x16x32_bf16 v[188:191], a[140:143], a[196:199], v[188:191]
s_waitcnt lgkmcnt(2)
v_mfma_f32_16x16x32_bf16 v[188:191], a[144:147], a[200:203], v[188:191]
global_load_dwordx4 a[120:123], v3, s[20:21] offset:-4096
v_add_f32 v10, v60, v116
v_mfma_f32_16x16x32_bf16 v[188:191], a[148:151], a[204:207], v[188:191]
v_mfma_f32_16x16x32_bf16 v[184:187], a[136:139], a[204:207], v[184:187]
ds_read_b128 a[192:195], v1 offset:4352
v_mfma_f32_16x16x32_bf16 v[184:187], a[132:135], a[200:203], v[184:187]
global_load_dwordx4 a[124:127], v3, s[20:21] offset:-3072
v_add_f32 v11, v61, v117
v_mfma_f32_16x16x32_bf16 v[184:187], a[128:131], a[196:199], v[184:187]
v_mfma_f32_16x16x32_bf16 v[192:195], a[128:131], a[200:203], v[192:195]
v_accvgpr_write_b32 a28, v10
v_mfma_f32_16x16x32_bf16 v[192:195], a[132:135], a[204:207], v[192:195]
v_accvgpr_write_b32 a29, v11
v_mfma_f32_16x16x32_bf16 v[192:195], a[136:139], a[208:211], v[192:195]
v_mfma_f32_16x16x32_bf16 v[196:199], a[148:151], a[208:211], v[196:199]
ds_read_b128 a[196:199], v1 offset:5408
v_mfma_f32_16x16x32_bf16 v[196:199], a[144:147], a[204:207], v[196:199]
v_add_f32 v12, v62, v118
v_mfma_f32_16x16x32_bf16 v[196:199], a[140:143], a[200:203], v[196:199]
s_waitcnt vmcnt(22)
v_mfma_f32_16x16x32_bf16 v[144:147], a[56:59], a[176:179], v[144:147]
s_add_u32 m0, s23, 76032
v_add_f32 v13, v63, v119
v_mfma_f32_16x16x32_bf16 v[144:147], a[60:63], a[180:183], v[144:147]
s_waitcnt lgkmcnt(1)
buffer_load_dwordx4 v4, s[8:11], s14 offen offset:0 lds
v_mfma_f32_16x16x32_bf16 v[144:147], a[64:67], a[184:187], v[144:147]
s_waitcnt vmcnt(18)
ds_read_b128 a[200:203], v1 offset:6464
v_mfma_f32_16x16x32_bf16 v[148:151], a[76:79], a[184:187], v[148:151]
v_mfma_f32_16x16x32_bf16 v[148:151], a[72:75], a[180:183], v[148:151]
global_load_dwordx4 a[128:131], v3, s[20:21] offset:-2048
v_accvgpr_write_b32 a30, v12
v_mfma_f32_16x16x32_bf16 v[148:151], a[68:71], a[176:179], v[148:151]
v_mfma_f32_16x16x32_bf16 v[156:159], a[68:71], a[180:183], v[156:159]
v_accvgpr_write_b32 a31, v13
v_mfma_f32_16x16x32_bf16 v[156:159], a[72:75], a[184:187], v[156:159]
global_load_dwordx4 a[132:135], v3, s[20:21] offset:-1024
v_mfma_f32_16x16x32_bf16 v[156:159], a[76:79], a[188:191], v[156:159]
ds_read_b128 a[204:207], v1 offset:7520
v_mfma_f32_16x16x32_bf16 v[152:155], a[64:67], a[188:191], v[152:155]
ds_read_b128 a[176:179], v1 offset:160
v_mfma_f32_16x16x32_bf16 v[152:155], a[60:63], a[184:187], v[152:155]
v_add_f32 v10, v64, v120
v_mfma_f32_16x16x32_bf16 v[152:155], a[56:59], a[180:183], v[152:155]
v_mfma_f32_16x16x32_bf16 v[160:163], a[56:59], a[184:187], v[160:163]
v_add_f32 v11, v65, v121
v_mfma_f32_16x16x32_bf16 v[160:163], a[60:63], a[188:191], v[160:163]
ds_read_b128 a[208:211], v1 offset:8576
v_mfma_f32_16x16x32_bf16 v[160:163], a[64:67], a[192:195], v[160:163]
global_load_dwordx4 a[136:139], v3, s[20:21] offset:0
v_mfma_f32_16x16x32_bf16 v[164:167], a[76:79], a[192:195], v[164:167]
ds_read_b128 a[180:183], v1 offset:1216
v_mfma_f32_16x16x32_bf16 v[164:167], a[72:75], a[188:191], v[164:167]
s_add_u32 m0, s23, 76064
v_accvgpr_write_b32 a32, v10
v_mfma_f32_16x16x32_bf16 v[164:167], a[68:71], a[184:187], v[164:167]
buffer_load_dwordx4 v4, s[8:11], s14 offen offset:1024 lds
v_mfma_f32_16x16x32_bf16 v[172:175], a[68:71], a[188:191], v[172:175]
v_accvgpr_write_b32 a33, v11
v_mfma_f32_16x16x32_bf16 v[172:175], a[72:75], a[192:195], v[172:175]
s_waitcnt lgkmcnt(2)
v_mfma_f32_16x16x32_bf16 v[172:175], a[76:79], a[196:199], v[172:175]
global_load_dwordx4 a[140:143], v3, s[20:21] offset:1024
v_mfma_f32_16x16x32_bf16 v[168:171], a[64:67], a[196:199], v[168:171]
ds_read_b128 a[184:187], v1 offset:2272
v_mfma_f32_16x16x32_bf16 v[168:171], a[60:63], a[192:195], v[168:171]
v_add_f32 v12, v66, v122
v_mfma_f32_16x16x32_bf16 v[168:171], a[56:59], a[188:191], v[168:171]
v_mfma_f32_16x16x32_bf16 v[176:179], a[56:59], a[192:195], v[176:179]
v_add_f32 v13, v67, v123
v_mfma_f32_16x16x32_bf16 v[176:179], a[60:63], a[196:199], v[176:179]
v_mfma_f32_16x16x32_bf16 v[176:179], a[64:67], a[200:203], v[176:179]
global_load_dwordx4 a[144:147], v3, s[20:21] offset:2048
v_accvgpr_write_b32 a34, v12
v_mfma_f32_16x16x32_bf16 v[180:183], a[76:79], a[200:203], v[180:183]
ds_read_b128 a[188:191], v1 offset:3328
v_mfma_f32_16x16x32_bf16 v[180:183], a[72:75], a[196:199], v[180:183]
v_accvgpr_write_b32 a35, v13
v_mfma_f32_16x16x32_bf16 v[180:183], a[68:71], a[192:195], v[180:183]
v_mfma_f32_16x16x32_bf16 v[188:191], a[68:71], a[196:199], v[188:191]
v_mfma_f32_16x16x32_bf16 v[188:191], a[72:75], a[200:203], v[188:191]
v_add_f32 v10, v68, v124
v_mfma_f32_16x16x32_bf16 v[188:191], a[76:79], a[204:207], v[188:191]
s_add_u32 m0, s23, 76096
global_load_dwordx4 a[148:151], v3, s[20:21] offset:3072
v_mfma_f32_16x16x32_bf16 v[184:187], a[64:67], a[204:207], v[184:187]
ds_read_b128 a[192:195], v1 offset:4384
v_mfma_f32_16x16x32_bf16 v[184:187], a[60:63], a[200:203], v[184:187]
v_mfma_f32_16x16x32_bf16 v[184:187], a[56:59], a[196:199], v[184:187]
buffer_load_dwordx4 v4, s[8:11], s14 offen offset:2048 lds
v_mfma_f32_16x16x32_bf16 v[192:195], a[56:59], a[200:203], v[192:195]
v_add_f32 v11, v69, v125
v_mfma_f32_16x16x32_bf16 v[192:195], a[60:63], a[204:207], v[192:195]
s_waitcnt lgkmcnt(1)
v_accvgpr_write_b32 a36, v10
v_mfma_f32_16x16x32_bf16 v[192:195], a[64:67], a[208:211], v[192:195]
v_accvgpr_write_b32 a37, v11
v_mfma_f32_16x16x32_bf16 v[196:199], a[76:79], a[208:211], v[196:199]
ds_read_b128 a[196:199], v1 offset:5440
v_mfma_f32_16x16x32_bf16 v[196:199], a[72:75], a[204:207], v[196:199]
v_mfma_f32_16x16x32_bf16 v[196:199], a[68:71], a[200:203], v[196:199]
s_waitcnt vmcnt(22)
v_add_f32 v12, v70, v126
v_mfma_f32_16x16x32_bf16 v[144:147], a[80:83], a[176:179], v[144:147]
v_mfma_f32_16x16x32_bf16 v[144:147], a[84:87], a[180:183], v[144:147]
s_add_u32 s20, s20, 8192
s_addc_u32 s21, s21, 0
v_add_f32 v13, v71, v127
v_mfma_f32_16x16x32_bf16 v[144:147], a[88:91], a[184:187], v[144:147]
s_waitcnt vmcnt(18)
global_load_dwordx4 a[56:59], v3, s[20:21] offset:-4096
v_mfma_f32_16x16x32_bf16 v[148:151], a[100:103], a[184:187], v[148:151]
ds_read_b128 a[200:203], v1 offset:6496
v_accvgpr_write_b32 a38, v12
v_mfma_f32_16x16x32_bf16 v[148:151], a[96:99], a[180:183], v[148:151]
v_mfma_f32_16x16x32_bf16 v[148:151], a[92:95], a[176:179], v[148:151]
v_accvgpr_write_b32 a39, v13
v_mfma_f32_16x16x32_bf16 v[156:159], a[92:95], a[180:183], v[156:159]
v_mfma_f32_16x16x32_bf16 v[156:159], a[96:99], a[184:187], v[156:159]
global_load_dwordx4 a[60:63], v3, s[20:21] offset:-3072
v_mfma_f32_16x16x32_bf16 v[156:159], a[100:103], a[188:191], v[156:159]
ds_read_b128 a[204:207], v1 offset:7552
v_add_f32 v10, v72, v128
v_mfma_f32_16x16x32_bf16 v[152:155], a[88:91], a[188:191], v[152:155]
ds_read_b128 a[176:179], v1 offset:192
v_mfma_f32_16x16x32_bf16 v[152:155], a[84:87], a[184:187], v[152:155]
v_mfma_f32_16x16x32_bf16 v[152:155], a[80:83], a[180:183], v[152:155]
v_add_f32 v11, v73, v129
v_mfma_f32_16x16x32_bf16 v[160:163], a[80:83], a[184:187], v[160:163]
v_mfma_f32_16x16x32_bf16 v[160:163], a[84:87], a[188:191], v[160:163]
s_waitcnt lgkmcnt(2)
ds_read_b128 a[208:211], v1 offset:8608
v_mfma_f32_16x16x32_bf16 v[160:163], a[88:91], a[192:195], v[160:163]
global_load_dwordx4 a[64:67], v3, s[20:21] offset:-2048
v_accvgpr_write_b32 a40, v10
v_mfma_f32_16x16x32_bf16 v[164:167], a[100:103], a[192:195], v[164:167]
ds_read_b128 a[180:183], v1 offset:1248
v_mfma_f32_16x16x32_bf16 v[164:167], a[96:99], a[188:191], v[164:167]
v_mfma_f32_16x16x32_bf16 v[164:167], a[92:95], a[184:187], v[164:167]
v_accvgpr_write_b32 a41, v11
v_mfma_f32_16x16x32_bf16 v[172:175], a[92:95], a[188:191], v[172:175]
v_mfma_f32_16x16x32_bf16 v[172:175], a[96:99], a[192:195], v[172:175]
v_add_f32 v12, v74, v130
v_mfma_f32_16x16x32_bf16 v[172:175], a[100:103], a[196:199], v[172:175]
global_load_dwordx4 a[68:71], v3, s[20:21] offset:-1024
v_mfma_f32_16x16x32_bf16 v[168:171], a[88:91], a[196:199], v[168:171]
ds_read_b128 a[184:187], v1 offset:2304
v_mfma_f32_16x16x32_bf16 v[168:171], a[84:87], a[192:195], v[168:171]
v_add_f32 v13, v75, v131
v_mfma_f32_16x16x32_bf16 v[168:171], a[80:83], a[188:191], v[168:171]
v_mfma_f32_16x16x32_bf16 v[176:179], a[80:83], a[192:195], v[176:179]
v_accvgpr_write_b32 a42, v12
v_mfma_f32_16x16x32_bf16 v[176:179], a[84:87], a[196:199], v[176:179]
v_mfma_f32_16x16x32_bf16 v[176:179], a[88:91], a[200:203], v[176:179]
global_load_dwordx4 a[72:75], v3, s[20:21] offset:0
v_accvgpr_write_b32 a43, v13
v_mfma_f32_16x16x32_bf16 v[180:183], a[100:103], a[200:203], v[180:183]
ds_read_b128 a[188:191], v1 offset:3360
v_mfma_f32_16x16x32_bf16 v[180:183], a[96:99], a[196:199], v[180:183]
v_mfma_f32_16x16x32_bf16 v[180:183], a[92:95], a[192:195], v[180:183]
v_add_f32 v10, v76, v132
v_mfma_f32_16x16x32_bf16 v[188:191], a[92:95], a[196:199], v[188:191]
v_mfma_f32_16x16x32_bf16 v[188:191], a[96:99], a[200:203], v[188:191]
s_waitcnt lgkmcnt(1)
v_add_f32 v11, v77, v133
v_mfma_f32_16x16x32_bf16 v[188:191], a[100:103], a[204:207], v[188:191]
global_load_dwordx4 a[76:79], v3, s[20:21] offset:1024
v_mfma_f32_16x16x32_bf16 v[184:187], a[88:91], a[204:207], v[184:187]
ds_read_b128 a[192:195], v1 offset:4416
v_accvgpr_write_b32 a44, v10
v_mfma_f32_16x16x32_bf16 v[184:187], a[84:87], a[200:203], v[184:187]
v_mfma_f32_16x16x32_bf16 v[184:187], a[80:83], a[196:199], v[184:187]
v_accvgpr_write_b32 a45, v11
v_mfma_f32_16x16x32_bf16 v[192:195], a[80:83], a[200:203], v[192:195]
v_mfma_f32_16x16x32_bf16 v[192:195], a[84:87], a[204:207], v[192:195]
v_add_f32 v12, v78, v134
v_mfma_f32_16x16x32_bf16 v[192:195], a[88:91], a[208:211], v[192:195]
v_add_f32 v13, v79, v135
v_mfma_f32_16x16x32_bf16 v[196:199], a[100:103], a[208:211], v[196:199]
ds_read_b128 a[196:199], v1 offset:5472
v_mfma_f32_16x16x32_bf16 v[196:199], a[96:99], a[204:207], v[196:199]
v_mfma_f32_16x16x32_bf16 v[196:199], a[92:95], a[200:203], v[196:199]
s_waitcnt vmcnt(19)
v_accvgpr_write_b32 a46, v12
v_mfma_f32_16x16x32_bf16 v[144:147], a[104:107], a[176:179], v[144:147]
s_waitcnt vmcnt(15)
s_mov_b32 s36, L_h4-L_pc
v_mfma_f32_16x16x32_bf16 v[144:147], a[108:111], a[180:183], v[144:147]
s_mov_b32 s30, L_h5+128-L_pc
global_load_dwordx4 a[80:83], v3, s[20:21] offset:2048
v_mfma_f32_16x16x32_bf16 v[144:147], a[112:115], a[184:187], v[144:147]
ds_read_b128 a[200:203], v1 offset:6528
v_accvgpr_write_b32 a47, v13
v_mfma_f32_16x16x32_bf16 v[148:151], a[124:127], a[184:187], v[148:151]
v_mfma_f32_16x16x32_bf16 v[148:151], a[120:123], a[180:183], v[148:151]
buffer_load_dword a252, v8, s[28:31], s36 offen
v_mfma_f32_16x16x32_bf16 v[148:151], a[116:119], a[176:179], v[148:151]
v_add_f32 v10, v80, v136
v_mfma_f32_16x16x32_bf16 v[156:159], a[116:119], a[180:183], v[156:159]
v_add_f32 v11, v81, v137
v_mfma_f32_16x16x32_bf16 v[156:159], a[120:123], a[184:187], v[156:159]
s_waitcnt lgkmcnt(1)
global_load_dwordx4 a[84:87], v3, s[20:21] offset:3072
v_mfma_f32_16x16x32_bf16 v[156:159], a[124:127], a[188:191], v[156:159]
L_stub2:
s_cmp_eq_u32 s37, 1
s_cbranch_scc1 L_stub6
ds_read_b128 a[204:207], v1 offset:7584
v_mfma_f32_16x16x32_bf16 v[152:155], a[112:115], a[188:191], v[152:155]
ds_read_b128 a[176:179], v1 offset:224
v_mfma_f32_16x16x32_bf16 v[152:155], a[108:111], a[184:187], v[152:155]
v_accvgpr_write_b32 a48, v10
v_mfma_f32_16x16x32_bf16 v[152:155], a[104:107], a[180:183], v[152:155]
v_mfma_f32_16x16x32_bf16 v[160:163], a[104:107], a[184:187], v[160:163]
v_accvgpr_write_b32 a49, v11
v_mfma_f32_16x16x32_bf16 v[160:163], a[108:111], a[188:191], v[160:163]
s_add_u32 s20, s20, 8192
s_addc_u32 s21, s21, 0
v_mfma_f32_16x16x32_bf16 v[160:163], a[112:115], a[192:195], v[160:163]
ds_read_b128 a[208:211], v1 offset:8640
v_mfma_f32_16x16x32_bf16 v[164:167], a[124:127], a[192:195], v[164:167]
global_load_dwordx4 a[88:91], v3, s[20:21] offset:-4096
v_mfma_f32_16x16x32_bf16 v[164:167], a[120:123], a[188:191], v[164:167]
ds_read_b128 a[180:183], v1 offset:1280
v_add_f32 v12, v82, v138
v_mfma_f32_16x16x32_bf16 v[164:167], a[116:119], a[184:187], v[164:167]
v_add_f32 v13, v83, v139
v_mfma_f32_16x16x32_bf16 v[172:175], a[116:119], a[188:191], v[172:175]
v_mfma_f32_16x16x32_bf16 v[172:175], a[120:123], a[192:195], v[172:175]
v_accvgpr_write_b32 a50, v12
v_mfma_f32_16x16x32_bf16 v[172:175], a[124:127], a[196:199], v[172:175]
global_load_dwordx4 a[92:95], v3, s[20:21] offset:-3072
v_mfma_f32_16x16x32_bf16 v[168:171], a[112:115], a[196:199], v[168:171]
ds_read_b128 a[184:187], v1 offset:2336
v_mfma_f32_16x16x32_bf16 v[168:171], a[108:111], a[192:195], v[168:171]
v_accvgpr_write_b32 a51, v13
v_mfma_f32_16x16x32_bf16 v[168:171], a[104:107], a[188:191], v[168:171]
v_mfma_f32_16x16x32_bf16 v[176:179], a[104:107], a[192:195], v[176:179]
v_add_f32 v10, v84, v140
v_mfma_f32_16x16x32_bf16 v[176:179], a[108:111], a[196:199], v[176:179]
s_waitcnt lgkmcnt(2)
v_mfma_f32_16x16x32_bf16 v[176:179], a[112:115], a[200:203], v[176:179]
global_load_dwordx4 a[96:99], v3, s[20:21] offset:-2048
v_add_f32 v11, v85, v141
v_mfma_f32_16x16x32_bf16 v[180:183], a[124:127], a[200:203], v[180:183]
ds_read_b128 a[188:191], v1 offset:3392
v_mfma_f32_16x16x32_bf16 v[180:183], a[120:123], a[196:199], v[180:183]
v_mfma_f32_16x16x32_bf16 v[180:183], a[116:119], a[192:195], v[180:183]
v_accvgpr_write_b32 a52, v10
v_mfma_f32_16x16x32_bf16 v[188:191], a[116:119], a[196:199], v[188:191]
v_mfma_f32_16x16x32_bf16 v[188:191], a[120:123], a[200:203], v[188:191]
v_accvgpr_write_b32 a53, v11
v_mfma_f32_16x16x32_bf16 v[188:191], a[124:127], a[204:207], v[188:191]
global_load_dwordx4 a[100:103], v3, s[20:21] offset:-1024
v_mfma_f32_16x16x32_bf16 v[184:187], a[112:115], a[204:207], v[184:187]
ds_read_b128 a[192:195], v1 offset:4448
v_mfma_f32_16x16x32_bf16 v[184:187], a[108:111], a[200:203], v[184:187]
v_add_f32 v12, v86, v142
v_mfma_f32_16x16x32_bf16 v[184:187], a[104:107], a[196:199], v[184:187]
v_mfma_f32_16x16x32_bf16 v[192:195], a[104:107], a[200:203], v[192:195]
v_add_f32 v13, v87, v143
v_mfma_f32_16x16x32_bf16 v[192:195], a[108:111], a[204:207], v[192:195]
v_accvgpr_write_b32 a54, v12
v_mfma_f32_16x16x32_bf16 v[192:195], a[112:115], a[208:211], v[192:195]
v_mfma_f32_16x16x32_bf16 v[196:199], a[124:127], a[208:211], v[196:199]
ds_read_b128 a[196:199], v1 offset:5504
v_mfma_f32_16x16x32_bf16 v[196:199], a[120:123], a[204:207], v[196:199]
v_accvgpr_write_b32 a55, v13
v_mfma_f32_16x16x32_bf16 v[196:199], a[116:119], a[200:203], v[196:199]
s_waitcnt vmcnt(18)
v_mfma_f32_16x16x32_bf16 v[144:147], a[128:131], a[176:179], v[144:147]
s_waitcnt lgkmcnt(2)
ds_read_b128 a[200:203], v1 offset:6560
v_mfma_f32_16x16x32_bf16 v[144:147], a[132:135], a[180:183], v[144:147]
global_load_dwordx4 a[104:107], v3, s[20:21] offset:0
v_mfma_f32_16x16x32_bf16 v[144:147], a[136:139], a[184:187], v[144:147]
s_waitcnt vmcnt(15)
ds_read_b128 a[204:207], v1 offset:7616
v_mfma_f32_16x16x32_bf16 v[148:151], a[148:151], a[184:187], v[148:151]
v_mfma_f32_16x16x32_bf16 v[148:151], a[144:147], a[180:183], v[148:151]
ds_read_b128 a[208:211], v1 offset:8672
v_mfma_f32_16x16x32_bf16 v[148:151], a[140:143], a[176:179], v[148:151]
v_mfma_f32_16x16x32_bf16 v[156:159], a[140:143], a[180:183], v[156:159]
v_mfma_f32_16x16x32_bf16 v[156:159], a[144:147], a[184:187], v[156:159]
global_load_dwordx4 a[108:111], v3, s[20:21] offset:1024
v_mfma_f32_16x16x32_bf16 v[156:159], a[148:151], a[188:191], v[156:159]
v_mfma_f32_16x16x32_bf16 v[152:155], a[136:139], a[188:191], v[152:155]
v_mfma_f32_16x16x32_bf16 v[152:155], a[132:135], a[184:187], v[152:155]
v_mfma_f32_16x16x32_bf16 v[152:155], a[128:131], a[180:183], v[152:155]
v_mfma_f32_16x16x32_bf16 v[160:163], a[128:131], a[184:187], v[160:163]
v_mfma_f32_16x16x32_bf16 v[160:163], a[132:135], a[188:191], v[160:163]
s_waitcnt lgkmcnt(1)
global_load_dwordx4 a[112:115], v3, s[20:21] offset:2048
v_mfma_f32_16x16x32_bf16 v[160:163], a[136:139], a[192:195], v[160:163]
s_waitcnt vmcnt(16)
v_mfma_f32_16x16x32_bf16 v[164:167], a[148:151], a[192:195], v[164:167]
s_nop 0
s_waitcnt lgkmcnt(0)
s_barrier
v_mfma_f32_16x16x32_bf16 v[164:167], a[144:147], a[188:191], v[164:167]
ds_read_b128 a[176:179], v2 offset:0
v_mfma_f32_16x16x32_bf16 v[164:167], a[140:143], a[184:187], v[164:167]
v_mfma_f32_16x16x32_bf16 v[172:175], a[140:143], a[188:191], v[172:175]
s_add_u32 s8, s8, 3280896
s_addc_u32 s9, s9, 0
v_mfma_f32_16x16x32_bf16 v[172:175], a[144:147], a[192:195], v[172:175]
s_add_u32 m0, s23, 0
ds_read_b128 a[180:183], v2 offset:1056
v_mfma_f32_16x16x32_bf16 v[172:175], a[148:151], a[196:199], v[172:175]
buffer_load_dwordx4 v4, s[8:11], 0 offen offset:0 lds
v_mfma_f32_16x16x32_bf16 v[168:171], a[136:139], a[196:199], v[168:171]
ds_read_b128 a[184:187], v2 offset:2112
v_mfma_f32_16x16x32_bf16 v[168:171], a[132:135], a[192:195], v[168:171]
v_mfma_f32_16x16x32_bf16 v[168:171], a[128:131], a[188:191], v[168:171]
global_load_dwordx4 a[116:119], v3, s[20:21] offset:3072
v_mfma_f32_16x16x32_bf16 v[176:179], a[128:131], a[192:195], v[176:179]
v_mfma_f32_16x16x32_bf16 v[176:179], a[132:135], a[196:199], v[176:179]
v_mfma_f32_16x16x32_bf16 v[176:179], a[136:139], a[200:203], v[176:179]
s_add_u32 s20, s20, 8192
s_addc_u32 s21, s21, 0
v_mfma_f32_16x16x32_bf16 v[180:183], a[148:151], a[200:203], v[180:183]
global_load_dwordx4 a[120:123], v3, s[20:21] offset:-4096
v_mfma_f32_16x16x32_bf16 v[180:183], a[144:147], a[196:199], v[180:183]
ds_read_b128 a[188:191], v2 offset:3168
v_mfma_f32_16x16x32_bf16 v[180:183], a[140:143], a[192:195], v[180:183]
v_mfma_f32_16x16x32_bf16 v[188:191], a[140:143], a[196:199], v[188:191]
v_mfma_f32_16x16x32_bf16 v[188:191], a[144:147], a[200:203], v[188:191]
v_mfma_f32_16x16x32_bf16 v[188:191], a[148:151], a[204:207], v[188:191]
global_load_dwordx4 a[124:127], v3, s[20:21] offset:-3072
v_mfma_f32_16x16x32_bf16 v[184:187], a[136:139], a[204:207], v[184:187]
ds_read_b128 a[192:195], v2 offset:4224
v_mfma_f32_16x16x32_bf16 v[184:187], a[132:135], a[200:203], v[184:187]
s_add_u32 m0, s23, 32
v_mfma_f32_16x16x32_bf16 v[184:187], a[128:131], a[196:199], v[184:187]
buffer_load_dwordx4 v4, s[8:11], 0 offen offset:1024 lds
v_mfma_f32_16x16x32_bf16 v[192:195], a[128:131], a[200:203], v[192:195]
v_mfma_f32_16x16x32_bf16 v[192:195], a[132:135], a[204:207], v[192:195]
v_mfma_f32_16x16x32_bf16 v[192:195], a[136:139], a[208:211], v[192:195]
v_mfma_f32_16x16x32_bf16 v[196:199], a[148:151], a[208:211], v[196:199]
ds_read_b128 a[196:199], v2 offset:5280
v_mfma_f32_16x16x32_bf16 v[196:199], a[144:147], a[204:207], v[196:199]
v_mfma_f32_16x16x32_bf16 v[196:199], a[140:143], a[200:203], v[196:199]
s_waitcnt vmcnt(18) lgkmcnt(2)
L_h3:
v_mfma_f32_16x16x32_bf16 a[0:3], a[56:59], a[176:179], a[0:3]
v_mfma_f32_16x16x32_bf16 a[0:3], a[60:63], a[180:183], a[0:3]
global_load_dwordx4 a[128:131], v3, s[20:21] offset:-2048
v_mfma_f32_16x16x32_bf16 a[0:3], a[64:67], a[184:187], a[0:3]
s_waitcnt vmcnt(16)
ds_read_b128 a[200:203], v2 offset:6336
v_mfma_f32_16x16x32_bf16 a[4:7], a[76:79], a[184:187], a[4:7]
v_mfma_f32_16x16x32_bf16 a[4:7], a[72:75], a[180:183], a[4:7]
v_mfma_f32_16x16x32_bf16 a[4:7], a[68:71], a[176:179], a[4:7]
v_mfma_f32_16x16x32_bf16 a[12:15], a[68:71], a[180:183], a[12:15]
v_mfma_f32_16x16x32_bf16 a[12:15], a[72:75], a[184:187], a[12:15]
global_load_dwordx4 a[132:135], v3, s[20:21] offset:-1024
v_mfma_f32_16x16x32_bf16 a[12:15], a[76:79], a[188:191], a[12:15]
s_add_u32 m0, s23, 64
v_mfma_f32_16x16x32_bf16 a[8:11], a[64:67], a[188:191], a[8:11]
s_mov_b32 s60, 0xbc9dfaef
v_fma_f32 v200, s60, v32, v144
v_fma_f32 v201, s60, v33, v145
v_mfma_f32_16x16x32_bf16 a[8:11], a[60:63], a[184:187], a[8:11]
s_mov_b32 s61, 0x3c9dfaef
v_mfma_f32_16x16x32_bf16 a[8:11], a[56:59], a[180:183], a[8:11]
s_mov_b32 s62, 0xbe31ba4d
v_fma_f32 v144, s62, v32, -v144
v_fma_f32 v145, s62, v33, -v145
v_mfma_f32_16x16x32_bf16 a[16:19], a[56:59], a[184:187], a[16:19]
s_mov_b32 s63, 0xbe31ba4d
v_fmac_f32 v200, s61, v88
v_mfma_f32_16x16x32_bf16 a[16:19], a[60:63], a[188:191], a[16:19]
s_waitcnt lgkmcnt(0)
s_mov_b32 s64, 0x3f6eeeef
v_fmac_f32 v201, s61, v89
v_mfma_f32_16x16x32_bf16 a[16:19], a[64:67], a[192:195], a[16:19]
s_mov_b32 s65, 0x40e7b961
v_fmac_f32 v144, s63, v88
v_mfma_f32_16x16x32_bf16 a[20:23], a[76:79], a[192:195], a[20:23]
s_mov_b32 s66, 0xbe458186
v_mfma_f32_16x16x32_bf16 a[20:23], a[72:75], a[188:191], a[20:23]
s_mov_b32 s67, 0xbdcfe6a8
v_fmac_f32 v145, s63, v89
v_fmac_f32 v32, s64, v88
v_mfma_f32_16x16x32_bf16 a[20:23], a[68:71], a[184:187], a[20:23]
ds_read_b128 a[204:207], v2 offset:7392
v_fmac_f32 v33, s64, v89
v_mfma_f32_16x16x32_bf16 a[28:31], a[68:71], a[188:191], a[28:31]
buffer_load_dwordx4 v4, s[8:11], 0 offen offset:2048 lds
v_fmac_f32 v88, s65, v32
v_mfma_f32_16x16x32_bf16 a[28:31], a[72:75], a[192:195], a[28:31]
ds_read_b128 a[176:179], v2 offset:32
v_fmac_f32 v89, s65, v33
v_mfma_f32_16x16x32_bf16 a[28:31], a[76:79], a[196:199], a[28:31]
ds_read_b128 a[208:211], v2 offset:8448
v_fma_f32 v202, s60, v34, v146
v_mfma_f32_16x16x32_bf16 a[24:27], a[64:67], a[196:199], a[24:27]
global_load_dwordx4 a[136:139], v3, s[20:21] offset:0
v_fma_f32 v203, s60, v35, v147
v_mfma_f32_16x16x32_bf16 a[24:27], a[60:63], a[192:195], a[24:27]
ds_read_b128 a[180:183], v2 offset:1088
v_fma_f32 v146, s62, v34, -v146
v_mfma_f32_16x16x32_bf16 a[24:27], a[56:59], a[188:191], a[24:27]
ds_read_b128 a[184:187], v2 offset:2144
v_fma_f32 v147, s62, v35, -v147
v_mfma_f32_16x16x32_bf16 a[32:35], a[56:59], a[192:195], a[32:35]
s_add_u32 m0, s23, 96
global_load_dwordx4 a[140:143], v3, s[20:21] offset:1024
v_mfma_f32_16x16x32_bf16 a[32:35], a[60:63], a[196:199], a[32:35]
v_fmac_f32 v202, s61, v90
v_fmac_f32 v203, s61, v91
v_mfma_f32_16x16x32_bf16 a[32:35], a[64:67], a[200:203], a[32:35]
v_fmac_f32 v146, s63, v90
v_fmac_f32 v147, s63, v91
v_mfma_f32_16x16x32_bf16 a[36:39], a[76:79], a[200:203], a[36:39]
buffer_load_dwordx4 v4, s[8:11], 0 offen offset:3072 lds
v_mfma_f32_16x16x32_bf16 a[36:39], a[72:75], a[196:199], a[36:39]
ds_read_b128 a[188:191], v2 offset:3200
v_fmac_f32 v34, s64, v90
v_mfma_f32_16x16x32_bf16 a[36:39], a[68:71], a[192:195], a[36:39]
v_fmac_f32 v35, s64, v91
v_mfma_f32_16x16x32_bf16 a[44:47], a[68:71], a[196:199], a[44:47]
global_load_dwordx4 a[144:147], v3, s[20:21] offset:2048
v_fmac_f32 v90, s65, v34
v_mfma_f32_16x16x32_bf16 a[44:47], a[72:75], a[200:203], a[44:47]
s_waitcnt lgkmcnt(3)
v_fmac_f32 v91, s65, v35
v_fma_f32 v204, s60, v36, v148
v_mfma_f32_16x16x32_bf16 a[44:47], a[76:79], a[204:207], a[44:47]
v_fma_f32 v205, s60, v37, v149
v_mfma_f32_16x16x32_bf16 a[40:43], a[64:67], a[204:207], a[40:43]
global_load_dwordx4 a[148:151], v3, s[20:21] offset:3072
v_fma_f32 v148, s62, v36, -v148
v_mfma_f32_16x16x32_bf16 a[40:43], a[60:63], a[200:203], a[40:43]
ds_read_b128 a[192:195], v2 offset:4256
v_fma_f32 v149, s62, v37, -v149
v_mfma_f32_16x16x32_bf16 a[40:43], a[56:59], a[196:199], a[40:43]
v_fmac_f32 v204, s61, v92
v_mfma_f32_16x16x32_bf16 a[48:51], a[56:59], a[200:203], a[48:51]
v_fmac_f32 v205, s61, v93
v_fmac_f32 v148, s63, v92
v_mfma_f32_16x16x32_bf16 a[48:51], a[60:63], a[204:207], a[48:51]
v_fmac_f32 v149, s63, v93
v_mfma_f32_16x16x32_bf16 a[48:51], a[64:67], a[208:211], a[48:51]
v_fmac_f32 v36, s64, v92
v_mfma_f32_16x16x32_bf16 a[52:55], a[76:79], a[208:211], a[52:55]
ds_read_b128 a[196:199], v2 offset:5312
v_fmac_f32 v37, s64, v93
v_mfma_f32_16x16x32_bf16 a[52:55], a[72:75], a[204:207], a[52:55]
s_add_u32 m0, s23, 4224
v_fmac_f32 v92, s65, v36
v_mfma_f32_16x16x32_bf16 a[52:55], a[68:71], a[200:203], a[52:55]
s_waitcnt vmcnt(19)
buffer_load_dwordx4 v4, s[8:11], s12 offen offset:0 lds
v_mfma_f32_16x16x32_bf16 a[0:3], a[80:83], a[176:179], a[0:3]
s_waitcnt lgkmcnt(2)
v_fmac_f32 v93, s65, v37
v_fma_f32 v206, s60, v38, v150
v_mfma_f32_16x16x32_bf16 a[0:3], a[84:87], a[180:183], a[0:3]
s_waitcnt vmcnt(17)
s_add_u32 s20, s20, 8192
s_addc_u32 s21, s21, 0
v_mfma_f32_16x16x32_bf16 a[0:3], a[88:91], a[184:187], a[0:3]
global_load_dwordx4 a[56:59], v3, s[20:21] offset:-4096
v_fma_f32 v207, s60, v39, v151
v_mfma_f32_16x16x32_bf16 a[4:7], a[100:103], a[184:187], a[4:7]
ds_read_b128 a[200:203], v2 offset:6368
v_fma_f32 v150, s62, v38, -v150
v_mfma_f32_16x16x32_bf16 a[4:7], a[96:99], a[180:183], a[4:7]
v_fma_f32 v151, s62, v39, -v151
v_fmac_f32 v206, s61, v94
v_mfma_f32_16x16x32_bf16 a[4:7], a[92:95], a[176:179], a[4:7]
v_fmac_f32 v207, s61, v95
v_mfma_f32_16x16x32_bf16 a[12:15], a[92:95], a[180:183], a[12:15]
v_fmac_f32 v150, s63, v94
v_fmac_f32 v151, s63, v95
v_mfma_f32_16x16x32_bf16 a[12:15], a[96:99], a[184:187], a[12:15]
global_load_dwordx4 a[60:63], v3, s[20:21] offset:-3072
v_mfma_f32_16x16x32_bf16 a[12:15], a[100:103], a[188:191], a[12:15]
ds_read_b128 a[204:207], v2 offset:7424
v_fmac_f32 v38, s64, v94
v_mfma_f32_16x16x32_bf16 a[8:11], a[88:91], a[188:191], a[8:11]
ds_read_b128 a[176:179], v2 offset:64
v_fmac_f32 v39, s64, v95
v_mfma_f32_16x16x32_bf16 a[8:11], a[84:87], a[184:187], a[8:11]
v_fmac_f32 v94, s65, v38
v_mfma_f32_16x16x32_bf16 a[8:11], a[80:83], a[180:183], a[8:11]
v_fmac_f32 v95, s65, v39
v_mfma_f32_16x16x32_bf16 a[16:19], a[80:83], a[184:187], a[16:19]
v_fma_f32 v208, s60, v40, v152
v_mfma_f32_16x16x32_bf16 a[16:19], a[84:87], a[188:191], a[16:19]
s_waitcnt lgkmcnt(2)
ds_read_b128 a[208:211], v2 offset:8480
v_mfma_f32_16x16x32_bf16 a[16:19], a[88:91], a[192:195], a[16:19]
s_add_u32 m0, s23, 4256
global_load_dwordx4 a[64:67], v3, s[20:21] offset:-2048
v_mfma_f32_16x16x32_bf16 a[20:23], a[100:103], a[192:195], a[20:23]
ds_read_b128 a[180:183], v2 offset:1120
v_fma_f32 v209, s60, v41, v153
v_mfma_f32_16x16x32_bf16 a[20:23], a[96:99], a[188:191], a[20:23]
v_fma_f32 v152, s62, v40, -v152
v_fma_f32 v153, s62, v41, -v153
v_mfma_f32_16x16x32_bf16 a[20:23], a[92:95], a[184:187], a[20:23]
buffer_load_dwordx4 v4, s[8:11], s12 offen offset:1024 lds
v_mfma_f32_16x16x32_bf16 a[28:31], a[92:95], a[188:191], a[28:31]
v_fmac_f32 v208, s61, v96
v_fmac_f32 v209, s61, v97
v_mfma_f32_16x16x32_bf16 a[28:31], a[96:99], a[192:195], a[28:31]
v_fmac_f32 v152, s63, v96
v_fmac_f32 v153, s63, v97
v_mfma_f32_16x16x32_bf16 a[28:31], a[100:103], a[196:199], a[28:31]
global_load_dwordx4 a[68:71], v3, s[20:21] offset:-1024
v_fmac_f32 v40, s64, v96
v_mfma_f32_16x16x32_bf16 a[24:27], a[88:91], a[196:199], a[24:27]
ds_read_b128 a[184:187], v2 offset:2176
v_mfma_f32_16x16x32_bf16 a[24:27], a[84:87], a[192:195], a[24:27]
v_fmac_f32 v41, s64, v97
v_mfma_f32_16x16x32_bf16 a[24:27], a[80:83], a[188:191], a[24:27]
v_fmac_f32 v96, s65, v40
v_fmac_f32 v97, s65, v41
v_mfma_f32_16x16x32_bf16 a[32:35], a[80:83], a[192:195], a[32:35]
v_fma_f32 v210, s60, v42, v154
v_mfma_f32_16x16x32_bf16 a[32:35], a[84:87], a[196:199], a[32:35]
v_fma_f32 v211, s60, v43, v155
v_mfma_f32_16x16x32_bf16 a[32:35], a[88:91], a[200:203], a[32:35]
global_load_dwordx4 a[72:75], v3, s[20:21] offset:0
v_fma_f32 v154, s62, v42, -v154
v_mfma_f32_16x16x32_bf16 a[36:39], a[100:103], a[200:203], a[36:39]
ds_read_b128 a[188:191], v2 offset:3232
v_fma_f32 v155, s62, v43, -v155
v_mfma_f32_16x16x32_bf16 a[36:39], a[96:99], a[196:199], a[36:39]
v_fmac_f32 v210, s61, v98
v_mfma_f32_16x16x32_bf16 a[36:39], a[92:95], a[192:195], a[36:39]
v_fmac_f32 v211, s61, v99
v_mfma_f32_16x16x32_bf16 a[44:47], a[92:95], a[196:199], a[44:47]
s_add_u32 m0, s23, 4288
v_fmac_f32 v154, s63, v98
v_mfma_f32_16x16x32_bf16 a[44:47], a[96:99], a[200:203], a[44:47]
s_waitcnt lgkmcnt(1)
buffer_load_dwordx4 v4, s[8:11], s12 offen offset:2048 lds
v_mfma_f32_16x16x32_bf16 a[44:47], a[100:103], a[204:207], a[44:47]
v_fmac_f32 v155, s63, v99
v_fmac_f32 v42, s64, v98
v_mfma_f32_16x16x32_bf16 a[40:43], a[88:91], a[204:207], a[40:43]
ds_read_b128 a[192:195], v2 offset:4288
v_fmac_f32 v43, s64, v99
v_mfma_f32_16x16x32_bf16 a[40:43], a[84:87], a[200:203], a[40:43]
global_load_dwordx4 a[76:79], v3, s[20:21] offset:1024
v_fmac_f32 v98, s65, v42
v_mfma_f32_16x16x32_bf16 a[40:43], a[80:83], a[196:199], a[40:43]
v_fmac_f32 v99, s65, v43
v_mfma_f32_16x16x32_bf16 a[48:51], a[80:83], a[200:203], a[48:51]
v_fma_f32 v212, s60, v44, v156
v_fma_f32 v213, s60, v45, v157
v_mfma_f32_16x16x32_bf16 a[48:51], a[84:87], a[204:207], a[48:51]
v_fma_f32 v156, s62, v44, -v156
v_mfma_f32_16x16x32_bf16 a[48:51], a[88:91], a[208:211], a[48:51]
v_fma_f32 v157, s62, v45, -v157
v_fmac_f32 v212, s61, v100
v_mfma_f32_16x16x32_bf16 a[52:55], a[100:103], a[208:211], a[52:55]
ds_read_b128 a[196:199], v2 offset:5344
v_mfma_f32_16x16x32_bf16 a[52:55], a[96:99], a[204:207], a[52:55]
v_fmac_f32 v213, s61, v101
v_mfma_f32_16x16x32_bf16 a[52:55], a[92:95], a[200:203], a[52:55]
s_waitcnt vmcnt(22)
v_fmac_f32 v156, s63, v100
v_fmac_f32 v157, s63, v101
v_mfma_f32_16x16x32_bf16 a[0:3], a[104:107], a[176:179], a[0:3]
v_fmac_f32 v44, s64, v100
v_mfma_f32_16x16x32_bf16 a[0:3], a[108:111], a[180:183], a[0:3]
s_waitcnt vmcnt(18)
global_load_dwordx4 a[80:83], v3, s[20:21] offset:2048
v_mfma_f32_16x16x32_bf16 a[0:3], a[112:115], a[184:187], a[0:3]
ds_read_b128 a[200:203], v2 offset:6400
v_fmac_f32 v45, s64, v101
v_mfma_f32_16x16x32_bf16 a[4:7], a[124:127], a[184:187], a[4:7]
v_fmac_f32 v100, s65, v44
v_fmac_f32 v101, s65, v45
v_mfma_f32_16x16x32_bf16 a[4:7], a[120:123], a[180:183], a[4:7]
s_add_u32 m0, s23, 4320
v_fma_f32 v214, s60, v46, v158
v_mfma_f32_16x16x32_bf16 a[4:7], a[116:119], a[176:179], a[4:7]
buffer_load_dwordx4 v4, s[8:11], s12 offen offset:3072 lds
v_mfma_f32_16x16x32_bf16 a[12:15], a[116:119], a[180:183], a[12:15]
v_fma_f32 v215, s60, v47, v159
v_fma_f32 v158, s62, v46, -v158
v_mfma_f32_16x16x32_bf16 a[12:15], a[120:123], a[184:187], a[12:15]
s_waitcnt lgkmcnt(1)
ds_read_b128 a[204:207], v2 offset:7456
v_mfma_f32_16x16x32_bf16 a[12:15], a[124:127], a[188:191], a[12:15]
global_load_dwordx4 a[84:87], v3, s[20:21] offset:3072
v_fma_f32 v159, s62, v47, -v159
v_mfma_f32_16x16x32_bf16 a[8:11], a[112:115], a[188:191], a[8:11]
ds_read_b128 a[176:179], v2 offset:96
v_fmac_f32 v214, s61, v102
v_mfma_f32_16x16x32_bf16 a[8:11], a[108:111], a[184:187], a[8:11]
v_fmac_f32 v215, s61, v103
v_mfma_f32_16x16x32_bf16 a[8:11], a[104:107], a[180:183], a[8:11]
v_fmac_f32 v158, s63, v102
v_mfma_f32_16x16x32_bf16 a[16:19], a[104:107], a[184:187], a[16:19]
v_fmac_f32 v159, s63, v103
v_mfma_f32_16x16x32_bf16 a[16:19], a[108:111], a[188:191], a[16:19]
s_add_u32 s20, s20, 8192
s_addc_u32 s21, s21, 0
v_fmac_f32 v46, s64, v102
v_mfma_f32_16x16x32_bf16 a[16:19], a[112:115], a[192:195], a[16:19]
ds_read_b128 a[208:211], v2 offset:8512
v_fmac_f32 v47, s64, v103
v_mfma_f32_16x16x32_bf16 a[20:23], a[124:127], a[192:195], a[20:23]
global_load_dwordx4 a[88:91], v3, s[20:21] offset:-4096
v_mfma_f32_16x16x32_bf16 a[20:23], a[120:123], a[188:191], a[20:23]
ds_read_b128 a[180:183], v2 offset:1152
v_fmac_f32 v102, s65, v46
v_mfma_f32_16x16x32_bf16 a[20:23], a[116:119], a[184:187], a[20:23]
v_fmac_f32 v103, s65, v47
v_fma_f32 v216, s60, v48, v160
v_mfma_f32_16x16x32_bf16 a[28:31], a[116:119], a[188:191], a[28:31]
v_fma_f32 v217, s60, v49, v161
v_mfma_f32_16x16x32_bf16 a[28:31], a[120:123], a[192:195], a[28:31]
v_fma_f32 v160, s62, v48, -v160
v_mfma_f32_16x16x32_bf16 a[28:31], a[124:127], a[196:199], a[28:31]
s_add_u32 m0, s23, 8448
global_load_dwordx4 a[92:95], v3, s[20:21] offset:-3072
v_mfma_f32_16x16x32_bf16 a[24:27], a[112:115], a[196:199], a[24:27]
ds_read_b128 a[184:187], v2 offset:2208
v_fma_f32 v161, s62, v49, -v161
v_mfma_f32_16x16x32_bf16 a[24:27], a[108:111], a[192:195], a[24:27]
v_fmac_f32 v216, s61, v104
v_fmac_f32 v217, s61, v105
v_mfma_f32_16x16x32_bf16 a[24:27], a[104:107], a[188:191], a[24:27]
buffer_load_dwordx4 v4, s[8:11], s13 offen offset:0 lds
v_mfma_f32_16x16x32_bf16 a[32:35], a[104:107], a[192:195], a[32:35]
v_fmac_f32 v160, s63, v104
v_fmac_f32 v161, s63, v105
v_mfma_f32_16x16x32_bf16 a[32:35], a[108:111], a[196:199], a[32:35]
s_waitcnt lgkmcnt(2)
v_fmac_f32 v48, s64, v104
v_mfma_f32_16x16x32_bf16 a[32:35], a[112:115], a[200:203], a[32:35]
global_load_dwordx4 a[96:99], v3, s[20:21] offset:-2048
v_fmac_f32 v49, s64, v105
v_mfma_f32_16x16x32_bf16 a[36:39], a[124:127], a[200:203], a[36:39]
ds_read_b128 a[188:191], v2 offset:3264
v_fmac_f32 v104, s65, v48
v_mfma_f32_16x16x32_bf16 a[36:39], a[120:123], a[196:199], a[36:39]
v_fmac_f32 v105, s65, v49
v_mfma_f32_16x16x32_bf16 a[36:39], a[116:119], a[192:195], a[36:39]
v_fma_f32 v218, s60, v50, v162
v_mfma_f32_16x16x32_bf16 a[44:47], a[116:119], a[196:199], a[44:47]
v_fma_f32 v219, s60, v51, v163
v_fma_f32 v162, s62, v50, -v162
v_mfma_f32_16x16x32_bf16 a[44:47], a[120:123], a[200:203], a[44:47]
v_fma_f32 v163, s62, v51, -v163
v_mfma_f32_16x16x32_bf16 a[44:47], a[124:127], a[204:207], a[44:47]
global_load_dwordx4 a[100:103], v3, s[20:21] offset:-1024
v_fmac_f32 v218, s61, v106
v_mfma_f32_16x16x32_bf16 a[40:43], a[112:115], a[204:207], a[40:43]
ds_read_b128 a[192:195], v2 offset:4320
v_fmac_f32 v219, s61, v107
v_mfma_f32_16x16x32_bf16 a[40:43], a[108:111], a[200:203], a[40:43]
v_fmac_f32 v162, s63, v106
v_mfma_f32_16x16x32_bf16 a[40:43], a[104:107], a[196:199], a[40:43]
v_fmac_f32 v163, s63, v107
v_mfma_f32_16x16x32_bf16 a[48:51], a[104:107], a[200:203], a[48:51]
s_add_u32 m0, s23, 8480
v_fmac_f32 v50, s64, v106
v_mfma_f32_16x16x32_bf16 a[48:51], a[108:111], a[204:207], a[48:51]
buffer_load_dwordx4 v4, s[8:11], s13 offen offset:1024 lds
v_mfma_f32_16x16x32_bf16 a[48:51], a[112:115], a[208:211], a[48:51]
v_fmac_f32 v51, s64, v107
v_fmac_f32 v106, s65, v50
v_mfma_f32_16x16x32_bf16 a[52:55], a[124:127], a[208:211], a[52:55]
ds_read_b128 a[196:199], v2 offset:5376
v_fmac_f32 v107, s65, v51
v_mfma_f32_16x16x32_bf16 a[52:55], a[120:123], a[204:207], a[52:55]
v_fma_f32 v220, s60, v52, v164
v_mfma_f32_16x16x32_bf16 a[52:55], a[116:119], a[200:203], a[52:55]
s_waitcnt vmcnt(24)
v_fma_f32 v221, s60, v53, v165
v_fma_f32 v164, s62, v52, -v164
v_mfma_f32_16x16x32_bf16 a[0:3], a[128:131], a[176:179], a[0:3]
s_waitcnt lgkmcnt(2)
v_fma_f32 v165, s62, v53, -v165
v_mfma_f32_16x16x32_bf16 a[0:3], a[132:135], a[180:183], a[0:3]
s_waitcnt vmcnt(18)
global_load_dwordx4 a[104:107], v3, s[20:21] offset:0
v_mfma_f32_16x16x32_bf16 a[0:3], a[136:139], a[184:187], a[0:3]
ds_read_b128 a[200:203], v2 offset:6432
v_fmac_f32 v220, s61, v108
v_mfma_f32_16x16x32_bf16 a[4:7], a[148:151], a[184:187], a[4:7]
v_fmac_f32 v221, s61, v109
v_fmac_f32 v164, s63, v108
v_mfma_f32_16x16x32_bf16 a[4:7], a[144:147], a[180:183], a[4:7]
v_fmac_f32 v165, s63, v109
v_mfma_f32_16x16x32_bf16 a[4:7], a[140:143], a[176:179], a[4:7]
v_fmac_f32 v52, s64, v108
v_mfma_f32_16x16x32_bf16 a[12:15], a[140:143], a[180:183], a[12:15]
v_fmac_f32 v53, s64, v109
v_fmac_f32 v108, s65, v52
v_mfma_f32_16x16x32_bf16 a[12:15], a[144:147], a[184:187], a[12:15]
global_load_dwordx4 a[108:111], v3, s[20:21] offset:1024
v_mfma_f32_16x16x32_bf16 a[12:15], a[148:151], a[188:191], a[12:15]
ds_read_b128 a[204:207], v2 offset:7488
v_fmac_f32 v109, s65, v53
v_mfma_f32_16x16x32_bf16 a[8:11], a[136:139], a[188:191], a[8:11]
ds_read_b128 a[176:179], v2 offset:128
v_mfma_f32_16x16x32_bf16 a[8:11], a[132:135], a[184:187], a[8:11]
s_add_u32 m0, s23, 8512
v_fma_f32 v222, s60, v54, v166
v_mfma_f32_16x16x32_bf16 a[8:11], a[128:131], a[180:183], a[8:11]
buffer_load_dwordx4 v4, s[8:11], s13 offen offset:2048 lds
v_mfma_f32_16x16x32_bf16 a[16:19], a[128:131], a[184:187], a[16:19]
s_waitcnt lgkmcnt(2)
v_fma_f32 v223, s60, v55, v167
v_fma_f32 v166, s62, v54, -v166
v_mfma_f32_16x16x32_bf16 a[16:19], a[132:135], a[188:191], a[16:19]
ds_read_b128 a[208:211], v2 offset:8544
v_fma_f32 v167, s62, v55, -v167
v_mfma_f32_16x16x32_bf16 a[16:19], a[136:139], a[192:195], a[16:19]
global_load_dwordx4 a[112:115], v3, s[20:21] offset:2048
v_fmac_f32 v222, s61, v110
v_mfma_f32_16x16x32_bf16 a[20:23], a[148:151], a[192:195], a[20:23]
ds_read_b128 a[180:183], v2 offset:1184
v_mfma_f32_16x16x32_bf16 a[20:23], a[144:147], a[188:191], a[20:23]
v_fmac_f32 v223, s61, v111
v_fmac_f32 v166, s63, v110
v_mfma_f32_16x16x32_bf16 a[20:23], a[140:143], a[184:187], a[20:23]
v_fmac_f32 v167, s63, v111
v_mfma_f32_16x16x32_bf16 a[28:31], a[140:143], a[188:191], a[28:31]
v_fmac_f32 v54, s64, v110
v_mfma_f32_16x16x32_bf16 a[28:31], a[144:147], a[192:195], a[28:31]
v_fmac_f32 v55, s64, v111
v_fmac_f32 v110, s65, v54
v_mfma_f32_16x16x32_bf16 a[28:31], a[148:151], a[196:199], a[28:31]
global_load_dwordx4 a[116:119], v3, s[20:21] offset:3072
v_fmac_f32 v111, s65, v55
v_mfma_f32_16x16x32_bf16 a[24:27], a[136:139], a[196:199], a[24:27]
ds_read_b128 a[184:187], v2 offset:2240
v_mfma_f32_16x16x32_bf16 a[24:27], a[132:135], a[192:195], a[24:27]
v_fma_f32 v224, s60, v56, v168
v_fma_f32 v225, s60, v57, v169
v_mfma_f32_16x16x32_bf16 a[24:27], a[128:131], a[188:191], a[24:27]
v_fma_f32 v168, s62, v56, -v168
v_mfma_f32_16x16x32_bf16 a[32:35], a[128:131], a[192:195], a[32:35]
v_fma_f32 v169, s62, v57, -v169
v_mfma_f32_16x16x32_bf16 a[32:35], a[132:135], a[196:199], a[32:35]
v_fmac_f32 v224, s61, v112
v_mfma_f32_16x16x32_bf16 a[32:35], a[136:139], a[200:203], a[32:35]
s_add_u32 m0, s23, 8544
v_fmac_f32 v225, s61, v113
v_mfma_f32_16x16x32_bf16 a[36:39], a[148:151], a[200:203], a[36:39]
s_add_u32 s20, s20, 8192
s_addc_u32 s21, s21, 0
v_mfma_f32_16x16x32_bf16 a[36:39], a[144:147], a[196:199], a[36:39]
buffer_load_dwordx4 v4, s[8:11], s13 offen offset:3072 lds
v_mfma_f32_16x16x32_bf16 a[36:39], a[140:143], a[192:195], a[36:39]
ds_read_b128 a[188:191], v2 offset:3296
v_fmac_f32 v168, s63, v112
v_mfma_f32_16x16x32_bf16 a[44:47], a[140:143], a[196:199], a[44:47]
s_waitcnt lgkmcnt(2)
v_fmac_f32 v169, s63, v113
v_fmac_f32 v56, s64, v112
v_mfma_f32_16x16x32_bf16 a[44:47], a[144:147], a[200:203], a[44:47]
global_load_dwordx4 a[120:123], v3, s[20:21] offset:-4096
v_fmac_f32 v57, s64, v113
v_mfma_f32_16x16x32_bf16 a[44:47], a[148:151], a[204:207], a[44:47]
v_fmac_f32 v112, s65, v56
v_fmac_f32 v113, s65, v57
v_mfma_f32_16x16x32_bf16 a[40:43], a[136:139], a[204:207], a[40:43]
ds_read_b128 a[192:195], v2 offset:4352
v_fma_f32 v226, s60, v58, v170
v_mfma_f32_16x16x32_bf16 a[40:43], a[132:135], a[200:203], a[40:43]
global_load_dwordx4 a[124:127], v3, s[20:21] offset:-3072
v_fma_f32 v227, s60, v59, v171
v_mfma_f32_16x16x32_bf16 a[40:43], a[128:131], a[196:199], a[40:43]
v_fma_f32 v170, s62, v58, -v170
v_mfma_f32_16x16x32_bf16 a[48:51], a[128:131], a[200:203], a[48:51]
v_fma_f32 v171, s62, v59, -v171
v_fmac_f32 v226, s61, v114
v_mfma_f32_16x16x32_bf16 a[48:51], a[132:135], a[204:207], a[48:51]
v_fmac_f32 v227, s61, v115
v_mfma_f32_16x16x32_bf16 a[48:51], a[136:139], a[208:211], a[48:51]
v_fmac_f32 v170, s63, v114
v_fmac_f32 v171, s63, v115
v_mfma_f32_16x16x32_bf16 a[52:55], a[148:151], a[208:211], a[52:55]
ds_read_b128 a[196:199], v2 offset:5408
v_mfma_f32_16x16x32_bf16 a[52:55], a[144:147], a[204:207], a[52:55]
v_fmac_f32 v58, s64, v114
v_mfma_f32_16x16x32_bf16 a[52:55], a[140:143], a[200:203], a[52:55]
s_waitcnt vmcnt(22)
v_fmac_f32 v59, s64, v115
v_mfma_f32_16x16x32_bf16 a[0:3], a[56:59], a[176:179], a[0:3]
s_add_u32 m0, s23, 12672
v_fmac_f32 v114, s65, v58
v_fmac_f32 v115, s65, v59
v_mfma_f32_16x16x32_bf16 a[0:3], a[60:63], a[180:183], a[0:3]
L_stub3:
s_cmp_eq_u32 s37, 1
s_cbranch_scc1 L_stub7
s_waitcnt lgkmcnt(1) vmcnt(17)
buffer_load_dwordx4 v4, s[8:11], s14 offen offset:0 lds
v_mfma_f32_16x16x32_bf16 a[0:3], a[64:67], a[184:187], a[0:3]
ds_read_b128 a[200:203], v2 offset:6464
v_fma_f32 v228, s60, v60, v172
v_mfma_f32_16x16x32_bf16 a[4:7], a[76:79], a[184:187], a[4:7]
v_fma_f32 v229, s60, v61, v173
v_mfma_f32_16x16x32_bf16 a[4:7], a[72:75], a[180:183], a[4:7]
global_load_dwordx4 a[128:131], v3, s[20:21] offset:-2048
v_fma_f32 v172, s62, v60, -v172
v_mfma_f32_16x16x32_bf16 a[4:7], a[68:71], a[176:179], a[4:7]
v_fma_f32 v173, s62, v61, -v173
v_fmac_f32 v228, s61, v116
v_mfma_f32_16x16x32_bf16 a[12:15], a[68:71], a[180:183], a[12:15]
v_fmac_f32 v229, s61, v117
v_mfma_f32_16x16x32_bf16 a[12:15], a[72:75], a[184:187], a[12:15]
global_load_dwordx4 a[132:135], v3, s[20:21] offset:-1024
v_mfma_f32_16x16x32_bf16 a[12:15], a[76:79], a[188:191], a[12:15]
ds_read_b128 a[204:207], v2 offset:7520
v_fmac_f32 v172, s63, v116
v_mfma_f32_16x16x32_bf16 a[8:11], a[64:67], a[188:191], a[8:11]
ds_read_b128 a[176:179], v2 offset:160
v_fmac_f32 v173, s63, v117
v_mfma_f32_16x16x32_bf16 a[8:11], a[60:63], a[184:187], a[8:11]
v_fmac_f32 v60, s64, v116
v_mfma_f32_16x16x32_bf16 a[8:11], a[56:59], a[180:183], a[8:11]
v_fmac_f32 v61, s64, v117
v_mfma_f32_16x16x32_bf16 a[16:19], a[56:59], a[184:187], a[16:19]
v_fmac_f32 v116, s65, v60
v_fmac_f32 v117, s65, v61
v_mfma_f32_16x16x32_bf16 a[16:19], a[60:63], a[188:191], a[16:19]
ds_read_b128 a[208:211], v2 offset:8576
v_mfma_f32_16x16x32_bf16 a[16:19], a[64:67], a[192:195], a[16:19]
global_load_dwordx4 a[136:139], v3, s[20:21] offset:0
v_fma_f32 v230, s60, v62, v174
v_mfma_f32_16x16x32_bf16 a[20:23], a[76:79], a[192:195], a[20:23]
ds_read_b128 a[180:183], v2 offset:1216
v_mfma_f32_16x16x32_bf16 a[20:23], a[72:75], a[188:191], a[20:23]
s_add_u32 m0, s23, 12704
v_fma_f32 v231, s60, v63, v175
v_mfma_f32_16x16x32_bf16 a[20:23], a[68:71], a[184:187], a[20:23]
buffer_load_dwordx4 v4, s[8:11], s14 offen offset:1024 lds
v_mfma_f32_16x16x32_bf16 a[28:31], a[68:71], a[188:191], a[28:31]
v_fma_f32 v174, s62, v62, -v174
v_fma_f32 v175, s62, v63, -v175
v_mfma_f32_16x16x32_bf16 a[28:31], a[72:75], a[192:195], a[28:31]
s_waitcnt lgkmcnt(2)
v_fmac_f32 v230, s61, v118
v_fmac_f32 v231, s61, v119
v_mfma_f32_16x16x32_bf16 a[28:31], a[76:79], a[196:199], a[28:31]
global_load_dwordx4 a[140:143], v3, s[20:21] offset:1024
v_fmac_f32 v174, s63, v118
v_mfma_f32_16x16x32_bf16 a[24:27], a[64:67], a[196:199], a[24:27]
ds_read_b128 a[184:187], v2 offset:2272
v_mfma_f32_16x16x32_bf16 a[24:27], a[60:63], a[192:195], a[24:27]
v_fmac_f32 v175, s63, v119
v_fmac_f32 v62, s64, v118
v_mfma_f32_16x16x32_bf16 a[24:27], a[56:59], a[188:191], a[24:27]
v_fmac_f32 v63, s64, v119
v_mfma_f32_16x16x32_bf16 a[32:35], a[56:59], a[192:195], a[32:35]
v_fmac_f32 v118, s65, v62
v_mfma_f32_16x16x32_bf16 a[32:35], a[60:63], a[196:199], a[32:35]
v_fmac_f32 v119, s65, v63
v_mfma_f32_16x16x32_bf16 a[32:35], a[64:67], a[200:203], a[32:35]
global_load_dwordx4 a[144:147], v3, s[20:21] offset:2048
v_fma_f32 v232, s60, v64, v176
v_mfma_f32_16x16x32_bf16 a[36:39], a[76:79], a[200:203], a[36:39]
ds_read_b128 a[188:191], v2 offset:3328
v_fma_f32 v233, s60, v65, v177
v_mfma_f32_16x16x32_bf16 a[36:39], a[72:75], a[196:199], a[36:39]
v_fma_f32 v176, s62, v64, -v176
v_mfma_f32_16x16x32_bf16 a[36:39], a[68:71], a[192:195], a[36:39]
v_fma_f32 v177, s62, v65, -v177
v_mfma_f32_16x16x32_bf16 a[44:47], a[68:71], a[196:199], a[44:47]
v_fmac_f32 v232, s61, v120
v_fmac_f32 v233, s61, v121
v_mfma_f32_16x16x32_bf16 a[44:47], a[72:75], a[200:203], a[44:47]
v_fmac_f32 v176, s63, v120
v_mfma_f32_16x16x32_bf16 a[44:47], a[76:79], a[204:207], a[44:47]
s_add_u32 m0, s23, 12736
global_load_dwordx4 a[148:151], v3, s[20:21] offset:3072
v_mfma_f32_16x16x32_bf16 a[40:43], a[64:67], a[204:207], a[40:43]
ds_read_b128 a[192:195], v2 offset:4384
v_fmac_f32 v177, s63, v121
v_mfma_f32_16x16x32_bf16 a[40:43], a[60:63], a[200:203], a[40:43]
v_fmac_f32 v64, s64, v120
v_mfma_f32_16x16x32_bf16 a[40:43], a[56:59], a[196:199], a[40:43]
buffer_load_dwordx4 v4, s[8:11], s14 offen offset:2048 lds
v_mfma_f32_16x16x32_bf16 a[48:51], a[56:59], a[200:203], a[48:51]
v_fmac_f32 v65, s64, v121
v_fmac_f32 v120, s65, v64
v_mfma_f32_16x16x32_bf16 a[48:51], a[60:63], a[204:207], a[48:51]
s_waitcnt lgkmcnt(1)
v_fmac_f32 v121, s65, v65
v_fma_f32 v234, s60, v66, v178
v_mfma_f32_16x16x32_bf16 a[48:51], a[64:67], a[208:211], a[48:51]
v_fma_f32 v235, s60, v67, v179
v_fma_f32 v178, s62, v66, -v178
v_mfma_f32_16x16x32_bf16 a[52:55], a[76:79], a[208:211], a[52:55]
ds_read_b128 a[196:199], v2 offset:5440
v_mfma_f32_16x16x32_bf16 a[52:55], a[72:75], a[204:207], a[52:55]
v_fma_f32 v179, s62, v67, -v179
v_fmac_f32 v234, s61, v122
v_mfma_f32_16x16x32_bf16 a[52:55], a[68:71], a[200:203], a[52:55]
s_waitcnt vmcnt(22)
v_fmac_f32 v235, s61, v123
v_mfma_f32_16x16x32_bf16 a[0:3], a[80:83], a[176:179], a[0:3]
v_fmac_f32 v178, s63, v122
v_mfma_f32_16x16x32_bf16 a[0:3], a[84:87], a[180:183], a[0:3]
s_waitcnt vmcnt(18)
s_add_u32 s20, s20, 8192
s_addc_u32 s21, s21, 0
v_mfma_f32_16x16x32_bf16 a[0:3], a[88:91], a[184:187], a[0:3]
global_load_dwordx4 a[56:59], v3, s[20:21] offset:-4096
v_fmac_f32 v179, s63, v123
v_mfma_f32_16x16x32_bf16 a[4:7], a[100:103], a[184:187], a[4:7]
ds_read_b128 a[200:203], v2 offset:6496
v_fmac_f32 v66, s64, v122
v_mfma_f32_16x16x32_bf16 a[4:7], a[96:99], a[180:183], a[4:7]
v_fmac_f32 v67, s64, v123
v_fmac_f32 v122, s65, v66
v_mfma_f32_16x16x32_bf16 a[4:7], a[92:95], a[176:179], a[4:7]
v_fmac_f32 v123, s65, v67
v_fma_f32 v236, s60, v68, v180
v_mfma_f32_16x16x32_bf16 a[12:15], a[92:95], a[180:183], a[12:15]
v_fma_f32 v237, s60, v69, v181
v_mfma_f32_16x16x32_bf16 a[12:15], a[96:99], a[184:187], a[12:15]
global_load_dwordx4 a[60:63], v3, s[20:21] offset:-3072
v_mfma_f32_16x16x32_bf16 a[12:15], a[100:103], a[188:191], a[12:15]
ds_read_b128 a[204:207], v2 offset:7552
v_fma_f32 v180, s62, v68, -v180
v_mfma_f32_16x16x32_bf16 a[8:11], a[88:91], a[188:191], a[8:11]
ds_read_b128 a[176:179], v2 offset:192
v_fma_f32 v181, s62, v69, -v181
v_mfma_f32_16x16x32_bf16 a[8:11], a[84:87], a[184:187], a[8:11]
v_fmac_f32 v236, s61, v124
v_mfma_f32_16x16x32_bf16 a[8:11], a[80:83], a[180:183], a[8:11]
v_fmac_f32 v237, s61, v125
v_mfma_f32_16x16x32_bf16 a[16:19], a[80:83], a[184:187], a[16:19]
v_fmac_f32 v180, s63, v124
v_fmac_f32 v181, s63, v125
v_mfma_f32_16x16x32_bf16 a[16:19], a[84:87], a[188:191], a[16:19]
s_waitcnt lgkmcnt(2)
ds_read_b128 a[208:211], v2 offset:8608
v_mfma_f32_16x16x32_bf16 a[16:19], a[88:91], a[192:195], a[16:19]
global_load_dwordx4 a[64:67], v3, s[20:21] offset:-2048
v_fmac_f32 v68, s64, v124
v_mfma_f32_16x16x32_bf16 a[20:23], a[100:103], a[192:195], a[20:23]
ds_read_b128 a[180:183], v2 offset:1248
v_fmac_f32 v69, s64, v125
v_mfma_f32_16x16x32_bf16 a[20:23], a[96:99], a[188:191], a[20:23]
v_fmac_f32 v124, s65, v68
v_mfma_f32_16x16x32_bf16 a[20:23], a[92:95], a[184:187], a[20:23]
v_fmac_f32 v125, s65, v69
v_mfma_f32_16x16x32_bf16 a[28:31], a[92:95], a[188:191], a[28:31]
v_fma_f32 v238, s60, v70, v182
v_mfma_f32_16x16x32_bf16 a[28:31], a[96:99], a[192:195], a[28:31]
v_fma_f32 v239, s60, v71, v183
v_fma_f32 v182, s62, v70, -v182
v_mfma_f32_16x16x32_bf16 a[28:31], a[100:103], a[196:199], a[28:31]
global_load_dwordx4 a[68:71], v3, s[20:21] offset:-1024
v_fma_f32 v183, s62, v71, -v183
v_mfma_f32_16x16x32_bf16 a[24:27], a[88:91], a[196:199], a[24:27]
ds_read_b128 a[184:187], v2 offset:2304
v_mfma_f32_16x16x32_bf16 a[24:27], a[84:87], a[192:195], a[24:27]
v_fmac_f32 v238, s61, v126
v_fmac_f32 v239, s61, v127
v_mfma_f32_16x16x32_bf16 a[24:27], a[80:83], a[188:191], a[24:27]
v_fmac_f32 v182, s63, v126
v_mfma_f32_16x16x32_bf16 a[32:35], a[80:83], a[192:195], a[32:35]
v_fmac_f32 v183, s63, v127
v_mfma_f32_16x16x32_bf16 a[32:35], a[84:87], a[196:199], a[32:35]
v_fmac_f32 v70, s64, v126
v_mfma_f32_16x16x32_bf16 a[32:35], a[88:91], a[200:203], a[32:35]
global_load_dwordx4 a[72:75], v3, s[20:21] offset:0
v_fmac_f32 v71, s64, v127
v_mfma_f32_16x16x32_bf16 a[36:39], a[100:103], a[200:203], a[36:39]
ds_read_b128 a[188:191], v2 offset:3360
v_fmac_f32 v126, s65, v70
v_mfma_f32_16x16x32_bf16 a[36:39], a[96:99], a[196:199], a[36:39]
v_fmac_f32 v127, s65, v71
v_mfma_f32_16x16x32_bf16 a[36:39], a[92:95], a[192:195], a[36:39]
v_fma_f32 v240, s60, v72, v184
v_fma_f32 v241, s60, v73, v185
v_mfma_f32_16x16x32_bf16 a[44:47], a[92:95], a[196:199], a[44:47]
v_fma_f32 v184, s62, v72, -v184
v_mfma_f32_16x16x32_bf16 a[44:47], a[96:99], a[200:203], a[44:47]
s_waitcnt lgkmcnt(1)
v_fma_f32 v185, s62, v73, -v185
v_mfma_f32_16x16x32_bf16 a[44:47], a[100:103], a[204:207], a[44:47]
global_load_dwordx4 a[76:79], v3, s[20:21] offset:1024
v_fmac_f32 v240, s61, v128
v_mfma_f32_16x16x32_bf16 a[40:43], a[88:91], a[204:207], a[40:43]
ds_read_b128 a[192:195], v2 offset:4416
v_fmac_f32 v241, s61, v129
v_mfma_f32_16x16x32_bf16 a[40:43], a[84:87], a[200:203], a[40:43]
v_fmac_f32 v184, s63, v128
v_mfma_f32_16x16x32_bf16 a[40:43], a[80:83], a[196:199], a[40:43]
v_fmac_f32 v185, s63, v129
v_mfma_f32_16x16x32_bf16 a[48:51], a[80:83], a[200:203], a[48:51]
v_fmac_f32 v72, s64, v128
v_fmac_f32 v73, s64, v129
v_mfma_f32_16x16x32_bf16 a[48:51], a[84:87], a[204:207], a[48:51]
v_fmac_f32 v128, s65, v72
v_mfma_f32_16x16x32_bf16 a[48:51], a[88:91], a[208:211], a[48:51]
v_fmac_f32 v129, s65, v73
v_fma_f32 v242, s60, v74, v186
v_mfma_f32_16x16x32_bf16 a[52:55], a[100:103], a[208:211], a[52:55]
ds_read_b128 a[196:199], v2 offset:5472
v_mfma_f32_16x16x32_bf16 a[52:55], a[96:99], a[204:207], a[52:55]
v_fma_f32 v243, s60, v75, v187
v_fma_f32 v186, s62, v74, -v186
v_mfma_f32_16x16x32_bf16 a[52:55], a[92:95], a[200:203], a[52:55]
s_waitcnt vmcnt(19)
v_fma_f32 v187, s62, v75, -v187
v_mfma_f32_16x16x32_bf16 a[0:3], a[104:107], a[176:179], a[0:3]
s_waitcnt vmcnt(15)
s_mov_b32 s36, L_h5-L_pc
v_fmac_f32 v242, s61, v130
v_mfma_f32_16x16x32_bf16 a[0:3], a[108:111], a[180:183], a[0:3]
s_mov_b32 s30, L_h6+128-L_pc
global_load_dwordx4 a[80:83], v3, s[20:21] offset:2048
v_mfma_f32_16x16x32_bf16 a[0:3], a[112:115], a[184:187], a[0:3]
ds_read_b128 a[200:203], v2 offset:6528
v_fmac_f32 v243, s61, v131
v_mfma_f32_16x16x32_bf16 a[4:7], a[124:127], a[184:187], a[4:7]
v_fmac_f32 v186, s63, v130
v_fmac_f32 v187, s63, v131
v_mfma_f32_16x16x32_bf16 a[4:7], a[120:123], a[180:183], a[4:7]
buffer_load_dword a252, v8, s[28:31], s36 offen
v_mfma_f32_16x16x32_bf16 a[4:7], a[116:119], a[176:179], a[4:7]
v_fmac_f32 v74, s64, v130
v_fmac_f32 v75, s64, v131
v_mfma_f32_16x16x32_bf16 a[12:15], a[116:119], a[180:183], a[12:15]
v_fmac_f32 v130, s65, v74
v_fmac_f32 v131, s65, v75
v_mfma_f32_16x16x32_bf16 a[12:15], a[120:123], a[184:187], a[12:15]
s_waitcnt lgkmcnt(1)
global_load_dwordx4 a[84:87], v3, s[20:21] offset:3072
v_mfma_f32_16x16x32_bf16 a[12:15], a[124:127], a[188:191], a[12:15]
ds_read_b128 a[204:207], v2 offset:7584
v_fma_f32 v244, s60, v76, v188
v_mfma_f32_16x16x32_bf16 a[8:11], a[112:115], a[188:191], a[8:11]
ds_read_b128 a[176:179], v2 offset:224
v_fma_f32 v245, s60, v77, v189
v_mfma_f32_16x16x32_bf16 a[8:11], a[108:111], a[184:187], a[8:11]
v_fma_f32 v188, s62, v76, -v188
v_mfma_f32_16x16x32_bf16 a[8:11], a[104:107], a[180:183], a[8:11]
v_fma_f32 v189, s62, v77, -v189
v_mfma_f32_16x16x32_bf16 a[16:19], a[104:107], a[184:187], a[16:19]
v_fmac_f32 v244, s61, v132
v_fmac_f32 v245, s61, v133
v_mfma_f32_16x16x32_bf16 a[16:19], a[108:111], a[188:191], a[16:19]
s_add_u32 s20, s20, 8192
s_addc_u32 s21, s21, 0
v_mfma_f32_16x16x32_bf16 a[16:19], a[112:115], a[192:195], a[16:19]
ds_read_b128 a[208:211], v2 offset:8640
v_fmac_f32 v188, s63, v132
v_mfma_f32_16x16x32_bf16 a[20:23], a[124:127], a[192:195], a[20:23]
global_load_dwordx4 a[88:91], v3, s[20:21] offset:-4096
v_fmac_f32 v189, s63, v133
v_mfma_f32_16x16x32_bf16 a[20:23], a[120:123], a[188:191], a[20:23]
ds_read_b128 a[180:183], v2 offset:1280
v_fmac_f32 v76, s64, v132
v_mfma_f32_16x16x32_bf16 a[20:23], a[116:119], a[184:187], a[20:23]
v_fmac_f32 v77, s64, v133
v_mfma_f32_16x16x32_bf16 a[28:31], a[116:119], a[188:191], a[28:31]
v_fmac_f32 v132, s65, v76
v_fmac_f32 v133, s65, v77
v_mfma_f32_16x16x32_bf16 a[28:31], a[120:123], a[192:195], a[28:31]
v_fma_f32 v246, s60, v78, v190
v_mfma_f32_16x16x32_bf16 a[28:31], a[124:127], a[196:199], a[28:31]
global_load_dwordx4 a[92:95], v3, s[20:21] offset:-3072
v_fma_f32 v247, s60, v79, v191
v_mfma_f32_16x16x32_bf16 a[24:27], a[112:115], a[196:199], a[24:27]
ds_read_b128 a[184:187], v2 offset:2336
v_mfma_f32_16x16x32_bf16 a[24:27], a[108:111], a[192:195], a[24:27]
v_fma_f32 v190, s62, v78, -v190
v_fma_f32 v191, s62, v79, -v191
v_mfma_f32_16x16x32_bf16 a[24:27], a[104:107], a[188:191], a[24:27]
v_fmac_f32 v246, s61, v134
v_mfma_f32_16x16x32_bf16 a[32:35], a[104:107], a[192:195], a[32:35]
v_fmac_f32 v247, s61, v135
v_mfma_f32_16x16x32_bf16 a[32:35], a[108:111], a[196:199], a[32:35]
s_waitcnt lgkmcnt(2)
v_fmac_f32 v190, s63, v134
v_fmac_f32 v191, s63, v135
v_mfma_f32_16x16x32_bf16 a[32:35], a[112:115], a[200:203], a[32:35]
global_load_dwordx4 a[96:99], v3, s[20:21] offset:-2048
v_fmac_f32 v78, s64, v134
v_mfma_f32_16x16x32_bf16 a[36:39], a[124:127], a[200:203], a[36:39]
ds_read_b128 a[188:191], v2 offset:3392
v_mfma_f32_16x16x32_bf16 a[36:39], a[120:123], a[196:199], a[36:39]
v_fmac_f32 v79, s64, v135
v_mfma_f32_16x16x32_bf16 a[36:39], a[116:119], a[192:195], a[36:39]
v_fmac_f32 v134, s65, v78
v_fmac_f32 v135, s65, v79
v_mfma_f32_16x16x32_bf16 a[44:47], a[116:119], a[196:199], a[44:47]
v_fma_f32 v248, s60, v80, v192
v_mfma_f32_16x16x32_bf16 a[44:47], a[120:123], a[200:203], a[44:47]
v_fma_f32 v249, s60, v81, v193
v_mfma_f32_16x16x32_bf16 a[44:47], a[124:127], a[204:207], a[44:47]
global_load_dwordx4 a[100:103], v3, s[20:21] offset:-1024
v_fma_f32 v192, s62, v80, -v192
v_mfma_f32_16x16x32_bf16 a[40:43], a[112:115], a[204:207], a[40:43]
ds_read_b128 a[192:195], v2 offset:4448
v_fma_f32 v193, s62, v81, -v193
v_mfma_f32_16x16x32_bf16 a[40:43], a[108:111], a[200:203], a[40:43]
v_fmac_f32 v248, s61, v136
v_mfma_f32_16x16x32_bf16 a[40:43], a[104:107], a[196:199], a[40:43]
v_fmac_f32 v249, s61, v137
v_fmac_f32 v192, s63, v136
v_mfma_f32_16x16x32_bf16 a[48:51], a[104:107], a[200:203], a[48:51]
v_fmac_f32 v193, s63, v137
v_mfma_f32_16x16x32_bf16 a[48:51], a[108:111], a[204:207], a[48:51]
v_fmac_f32 v80, s64, v136
v_mfma_f32_16x16x32_bf16 a[48:51], a[112:115], a[208:211], a[48:51]
v_fmac_f32 v81, s64, v137
v_fmac_f32 v136, s65, v80
v_mfma_f32_16x16x32_bf16 a[52:55], a[124:127], a[208:211], a[52:55]
ds_read_b128 a[196:199], v2 offset:5504
v_mfma_f32_16x16x32_bf16 a[52:55], a[120:123], a[204:207], a[52:55]
v_fmac_f32 v137, s65, v81
v_fma_f32 v250, s60, v82, v194
v_mfma_f32_16x16x32_bf16 a[52:55], a[116:119], a[200:203], a[52:55]
s_waitcnt vmcnt(18)
v_fma_f32 v251, s60, v83, v195
v_mfma_f32_16x16x32_bf16 a[0:3], a[128:131], a[176:179], a[0:3]
s_waitcnt lgkmcnt(2) vmcnt(14)
ds_read_b128 a[200:203], v2 offset:6560
v_mfma_f32_16x16x32_bf16 a[0:3], a[132:135], a[180:183], a[0:3]
global_load_dwordx4 a[104:107], v3, s[20:21] offset:0
v_fma_f32 v194, s62, v82, -v194
v_mfma_f32_16x16x32_bf16 a[0:3], a[136:139], a[184:187], a[0:3]
ds_read_b128 a[204:207], v2 offset:7616
v_fma_f32 v195, s62, v83, -v195
v_mfma_f32_16x16x32_bf16 a[4:7], a[148:151], a[184:187], a[4:7]
v_fmac_f32 v250, s61, v138
v_mfma_f32_16x16x32_bf16 a[4:7], a[144:147], a[180:183], a[4:7]
ds_read_b128 a[208:211], v2 offset:8672
v_mfma_f32_16x16x32_bf16 a[4:7], a[140:143], a[176:179], a[4:7]
v_fmac_f32 v251, s61, v139
v_fmac_f32 v194, s63, v138
v_mfma_f32_16x16x32_bf16 a[12:15], a[140:143], a[180:183], a[12:15]
v_fmac_f32 v195, s63, v139
v_mfma_f32_16x16x32_bf16 a[12:15], a[144:147], a[184:187], a[12:15]
global_load_dwordx4 a[108:111], v3, s[20:21] offset:1024
v_fmac_f32 v82, s64, v138
v_mfma_f32_16x16x32_bf16 a[12:15], a[148:151], a[188:191], a[12:15]
v_fmac_f32 v83, s64, v139
v_fmac_f32 v138, s65, v82
v_mfma_f32_16x16x32_bf16 a[8:11], a[136:139], a[188:191], a[8:11]
v_fmac_f32 v139, s65, v83
v_mfma_f32_16x16x32_bf16 a[8:11], a[132:135], a[184:187], a[8:11]
v_fma_f32 v252, s60, v84, v196
v_mfma_f32_16x16x32_bf16 a[8:11], a[128:131], a[180:183], a[8:11]
v_fma_f32 v253, s60, v85, v197
v_mfma_f32_16x16x32_bf16 a[16:19], a[128:131], a[184:187], a[16:19]
s_waitcnt lgkmcnt(1)
v_fma_f32 v196, s62, v84, -v196
v_fma_f32 v197, s62, v85, -v197
v_mfma_f32_16x16x32_bf16 a[16:19], a[132:135], a[188:191], a[16:19]
global_load_dwordx4 a[112:115], v3, s[20:21] offset:2048
v_fmac_f32 v252, s61, v140
v_mfma_f32_16x16x32_bf16 a[16:19], a[136:139], a[192:195], a[16:19]
s_waitcnt vmcnt(16)
v_fmac_f32 v253, s61, v141
v_mfma_f32_16x16x32_bf16 a[20:23], a[148:151], a[192:195], a[20:23]
s_nop 0
v_fmac_f32 v196, s63, v140
s_waitcnt lgkmcnt(0)
s_barrier
v_mfma_f32_16x16x32_bf16 a[20:23], a[144:147], a[188:191], a[20:23]
ds_read_b128 a[176:179], v1 offset:0
v_fmac_f32 v197, s63, v141
v_mfma_f32_16x16x32_bf16 a[20:23], a[140:143], a[184:187], a[20:23]
v_fmac_f32 v84, s64, v140
v_mfma_f32_16x16x32_bf16 a[28:31], a[140:143], a[188:191], a[28:31]
s_add_u32 s8, s8, 3280896
s_addc_u32 s9, s9, 0
v_mfma_f32_16x16x32_bf16 a[28:31], a[144:147], a[192:195], a[28:31]
s_add_u32 m0, s23, 63360
ds_read_b128 a[180:183], v1 offset:1056
v_mfma_f32_16x16x32_bf16 a[28:31], a[148:151], a[196:199], a[28:31]
buffer_load_dwordx4 v4, s[8:11], 0 offen offset:0 lds
v_fmac_f32 v85, s64, v141
v_mfma_f32_16x16x32_bf16 a[24:27], a[136:139], a[196:199], a[24:27]
ds_read_b128 a[184:187], v1 offset:2112
v_fmac_f32 v140, s65, v84
v_mfma_f32_16x16x32_bf16 a[24:27], a[132:135], a[192:195], a[24:27]
v_fmac_f32 v141, s65, v85
v_fma_f32 v254, s60, v86, v198
v_mfma_f32_16x16x32_bf16 a[24:27], a[128:131], a[188:191], a[24:27]
global_load_dwordx4 a[116:119], v3, s[20:21] offset:3072
v_fma_f32 v255, s60, v87, v199
v_mfma_f32_16x16x32_bf16 a[32:35], a[128:131], a[192:195], a[32:35]
v_fma_f32 v198, s62, v86, -v198
v_mfma_f32_16x16x32_bf16 a[32:35], a[132:135], a[196:199], a[32:35]
v_fma_f32 v199, s62, v87, -v199
v_fmac_f32 v254, s61, v142
v_mfma_f32_16x16x32_bf16 a[32:35], a[136:139], a[200:203], a[32:35]
s_add_u32 s20, s20, 8192
s_addc_u32 s21, s21, 0
v_fmac_f32 v255, s61, v143
v_mfma_f32_16x16x32_bf16 a[36:39], a[148:151], a[200:203], a[36:39]
global_load_dwordx4 a[120:123], v3, s[20:21] offset:-4096
v_mfma_f32_16x16x32_bf16 a[36:39], a[144:147], a[196:199], a[36:39]
ds_read_b128 a[188:191], v1 offset:3168
v_fmac_f32 v198, s63, v142
v_mfma_f32_16x16x32_bf16 a[36:39], a[140:143], a[192:195], a[36:39]
v_fmac_f32 v199, s63, v143
v_fmac_f32 v86, s64, v142
v_mfma_f32_16x16x32_bf16 a[44:47], a[140:143], a[196:199], a[44:47]
v_fmac_f32 v87, s64, v143
v_mfma_f32_16x16x32_bf16 a[44:47], a[144:147], a[200:203], a[44:47]
v_fmac_f32 v142, s65, v86
v_mfma_f32_16x16x32_bf16 a[44:47], a[148:151], a[204:207], a[44:47]
global_load_dwordx4 a[124:127], v3, s[20:21] offset:-3072
v_fmac_f32 v143, s65, v87
v_mfma_f32_16x16x32_bf16 a[40:43], a[136:139], a[204:207], a[40:43]
ds_read_b128 a[192:195], v1 offset:4224
v_mfma_f32_16x16x32_bf16 a[40:43], a[132:135], a[200:203], a[40:43]
s_add_u32 m0, s23, 63392
v_mfma_f32_16x16x32_bf16 a[40:43], a[128:131], a[196:199], a[40:43]
buffer_load_dwordx4 v4, s[8:11], 0 offen offset:1024 lds
v_mfma_f32_16x16x32_bf16 a[48:51], a[128:131], a[200:203], a[48:51]
v_mfma_f32_16x16x32_bf16 a[48:51], a[132:135], a[204:207], a[48:51]
v_mfma_f32_16x16x32_bf16 a[48:51], a[136:139], a[208:211], a[48:51]
v_mfma_f32_16x16x32_bf16 a[52:55], a[148:151], a[208:211], a[52:55]
ds_read_b128 a[196:199], v1 offset:5280
v_mfma_f32_16x16x32_bf16 a[52:55], a[144:147], a[204:207], a[52:55]
v_mfma_f32_16x16x32_bf16 a[52:55], a[140:143], a[200:203], a[52:55]
s_waitcnt vmcnt(18) lgkmcnt(2)
L_h4:
v_mfma_f32_16x16x32_bf16 v[32:35], a[56:59], a[176:179], v[32:35]
v_mfma_f32_16x16x32_bf16 v[32:35], a[60:63], a[180:183], v[32:35]
global_load_dwordx4 a[128:131], v3, s[20:21] offset:-2048
v_mfma_f32_16x16x32_bf16 v[32:35], a[64:67], a[184:187], v[32:35]
s_waitcnt vmcnt(16)
ds_read_b128 a[200:203], v1 offset:6336
v_mfma_f32_16x16x32_bf16 v[36:39], a[76:79], a[184:187], v[36:39]
v_mfma_f32_16x16x32_bf16 v[36:39], a[72:75], a[180:183], v[36:39]
v_mfma_f32_16x16x32_bf16 v[36:39], a[68:71], a[176:179], v[36:39]
v_mfma_f32_16x16x32_bf16 v[44:47], a[68:71], a[180:183], v[44:47]
v_mfma_f32_16x16x32_bf16 v[44:47], a[72:75], a[184:187], v[44:47]
global_load_dwordx4 a[132:135], v3, s[20:21] offset:-1024
v_mfma_f32_16x16x32_bf16 v[44:47], a[76:79], a[188:191], v[44:47]
s_add_u32 m0, s23, 63424
ds_read_b128 a[204:207], v1 offset:7392
v_mfma_f32_16x16x32_bf16 v[40:43], a[64:67], a[188:191], v[40:43]
ds_read_b128 a[176:179], v1 offset:32
v_accvgpr_read_b32 v10, a0
v_mfma_f32_16x16x32_bf16 v[40:43], a[60:63], a[184:187], v[40:43]
buffer_load_dwordx4 v4, s[8:11], 0 offen offset:2048 lds
v_accvgpr_read_b32 v11, a1
v_mfma_f32_16x16x32_bf16 v[40:43], a[56:59], a[180:183], v[40:43]
v_mfma_f32_16x16x32_bf16 v[48:51], a[56:59], a[184:187], v[48:51]
v_fmac_f32 v144, 0.5, v10
v_mfma_f32_16x16x32_bf16 v[48:51], a[60:63], a[188:191], v[48:51]
s_waitcnt lgkmcnt(2)
ds_read_b128 a[208:211], v1 offset:8448
v_mfma_f32_16x16x32_bf16 v[48:51], a[64:67], a[192:195], v[48:51]
global_load_dwordx4 a[136:139], v3, s[20:21] offset:0
v_fmac_f32 v145, 0.5, v11
v_mfma_f32_16x16x32_bf16 v[52:55], a[76:79], a[192:195], v[52:55]
ds_read_b128 a[180:183], v1 offset:1088
v_mfma_f32_16x16x32_bf16 v[52:55], a[72:75], a[188:191], v[52:55]
v_mfma_f32_16x16x32_bf16 v[52:55], a[68:71], a[184:187], v[52:55]
v_fmac_f32 v200, 0.5, v10
v_mfma_f32_16x16x32_bf16 v[60:63], a[68:71], a[188:191], v[60:63]
v_fmac_f32 v201, 0.5, v11
v_mfma_f32_16x16x32_bf16 v[60:63], a[72:75], a[192:195], v[60:63]
v_mfma_f32_16x16x32_bf16 v[60:63], a[76:79], a[196:199], v[60:63]
global_load_dwordx4 a[140:143], v3, s[20:21] offset:1024
v_accvgpr_read_b32 v12, a2
v_mfma_f32_16x16x32_bf16 v[56:59], a[64:67], a[196:199], v[56:59]
ds_read_b128 a[184:187], v1 offset:2144
v_mfma_f32_16x16x32_bf16 v[56:59], a[60:63], a[192:195], v[56:59]
v_accvgpr_read_b32 v13, a3
v_mfma_f32_16x16x32_bf16 v[56:59], a[56:59], a[188:191], v[56:59]
v_mfma_f32_16x16x32_bf16 v[64:67], a[56:59], a[192:195], v[64:67]
s_add_u32 m0, s23, 63456
v_fmac_f32 v146, 0.5, v12
v_mfma_f32_16x16x32_bf16 v[64:67], a[60:63], a[196:199], v[64:67]
buffer_load_dwordx4 v4, s[8:11], 0 offen offset:3072 lds
v_mfma_f32_16x16x32_bf16 v[64:67], a[64:67], a[200:203], v[64:67]
v_fmac_f32 v147, 0.5, v13
v_mfma_f32_16x16x32_bf16 v[68:71], a[76:79], a[200:203], v[68:71]
ds_read_b128 a[188:191], v1 offset:3200
v_mfma_f32_16x16x32_bf16 v[68:71], a[72:75], a[196:199], v[68:71]
global_load_dwordx4 a[144:147], v3, s[20:21] offset:2048
v_fmac_f32 v202, 0.5, v12
v_mfma_f32_16x16x32_bf16 v[68:71], a[68:71], a[192:195], v[68:71]
v_mfma_f32_16x16x32_bf16 v[76:79], a[68:71], a[196:199], v[76:79]
v_fmac_f32 v203, 0.5, v13
v_mfma_f32_16x16x32_bf16 v[76:79], a[72:75], a[200:203], v[76:79]
s_waitcnt lgkmcnt(1)
v_accvgpr_read_b32 v10, a4
v_mfma_f32_16x16x32_bf16 v[76:79], a[76:79], a[204:207], v[76:79]
global_load_dwordx4 a[148:151], v3, s[20:21] offset:3072
v_mfma_f32_16x16x32_bf16 v[72:75], a[64:67], a[204:207], v[72:75]
ds_read_b128 a[192:195], v1 offset:4256
v_mfma_f32_16x16x32_bf16 v[72:75], a[60:63], a[200:203], v[72:75]
v_accvgpr_read_b32 v11, a5
v_mfma_f32_16x16x32_bf16 v[72:75], a[56:59], a[196:199], v[72:75]
v_fmac_f32 v148, 0.5, v10
v_mfma_f32_16x16x32_bf16 v[80:83], a[56:59], a[200:203], v[80:83]
v_fmac_f32 v149, 0.5, v11
v_mfma_f32_16x16x32_bf16 v[80:83], a[60:63], a[204:207], v[80:83]
v_mfma_f32_16x16x32_bf16 v[80:83], a[64:67], a[208:211], v[80:83]
v_fmac_f32 v204, 0.5, v10
v_mfma_f32_16x16x32_bf16 v[84:87], a[76:79], a[208:211], v[84:87]
ds_read_b128 a[196:199], v1 offset:5312
v_mfma_f32_16x16x32_bf16 v[84:87], a[72:75], a[204:207], v[84:87]
s_add_u32 m0, s23, 67584
v_fmac_f32 v205, 0.5, v11
v_mfma_f32_16x16x32_bf16 v[84:87], a[68:71], a[200:203], v[84:87]
s_waitcnt vmcnt(19)
buffer_load_dwordx4 v4, s[8:11], s12 offen offset:0 lds
v_mfma_f32_16x16x32_bf16 v[32:35], a[80:83], a[176:179], v[32:35]
v_accvgpr_read_b32 v12, a6
v_mfma_f32_16x16x32_bf16 v[32:35], a[84:87], a[180:183], v[32:35]
s_add_u32 s20, s20, 8192
s_addc_u32 s21, s21, 0
v_mfma_f32_16x16x32_bf16 v[32:35], a[88:91], a[184:187], v[32:35]
s_waitcnt vmcnt(17)
global_load_dwordx4 a[56:59], v3, s[20:21] offset:-4096
v_mfma_f32_16x16x32_bf16 v[36:39], a[100:103], a[184:187], v[36:39]
ds_read_b128 a[200:203], v1 offset:6368
v_accvgpr_read_b32 v13, a7
v_mfma_f32_16x16x32_bf16 v[36:39], a[96:99], a[180:183], v[36:39]
v_fmac_f32 v150, 0.5, v12
v_mfma_f32_16x16x32_bf16 v[36:39], a[92:95], a[176:179], v[36:39]
v_mfma_f32_16x16x32_bf16 v[44:47], a[92:95], a[180:183], v[44:47]
v_fmac_f32 v151, 0.5, v13
v_mfma_f32_16x16x32_bf16 v[44:47], a[96:99], a[184:187], v[44:47]
s_waitcnt lgkmcnt(1)
global_load_dwordx4 a[60:63], v3, s[20:21] offset:-3072
v_mfma_f32_16x16x32_bf16 v[44:47], a[100:103], a[188:191], v[44:47]
ds_read_b128 a[204:207], v1 offset:7424
v_fmac_f32 v206, 0.5, v12
v_mfma_f32_16x16x32_bf16 v[40:43], a[88:91], a[188:191], v[40:43]
ds_read_b128 a[176:179], v1 offset:64
v_mfma_f32_16x16x32_bf16 v[40:43], a[84:87], a[184:187], v[40:43]
v_mfma_f32_16x16x32_bf16 v[40:43], a[80:83], a[180:183], v[40:43]
v_fmac_f32 v207, 0.5, v13
v_mfma_f32_16x16x32_bf16 v[48:51], a[80:83], a[184:187], v[48:51]
v_accvgpr_read_b32 v10, a8
v_mfma_f32_16x16x32_bf16 v[48:51], a[84:87], a[188:191], v[48:51]
ds_read_b128 a[208:211], v1 offset:8480
v_mfma_f32_16x16x32_bf16 v[48:51], a[88:91], a[192:195], v[48:51]
s_add_u32 m0, s23, 67616
global_load_dwordx4 a[64:67], v3, s[20:21] offset:-2048
v_mfma_f32_16x16x32_bf16 v[52:55], a[100:103], a[192:195], v[52:55]
ds_read_b128 a[180:183], v1 offset:1120
v_mfma_f32_16x16x32_bf16 v[52:55], a[96:99], a[188:191], v[52:55]
v_accvgpr_read_b32 v11, a9
v_mfma_f32_16x16x32_bf16 v[52:55], a[92:95], a[184:187], v[52:55]
buffer_load_dwordx4 v4, s[8:11], s12 offen offset:1024 lds
v_mfma_f32_16x16x32_bf16 v[60:63], a[92:95], a[188:191], v[60:63]
v_fmac_f32 v152, 0.5, v10
v_mfma_f32_16x16x32_bf16 v[60:63], a[96:99], a[192:195], v[60:63]
v_fmac_f32 v153, 0.5, v11
v_mfma_f32_16x16x32_bf16 v[60:63], a[100:103], a[196:199], v[60:63]
global_load_dwordx4 a[68:71], v3, s[20:21] offset:-1024
v_mfma_f32_16x16x32_bf16 v[56:59], a[88:91], a[196:199], v[56:59]
ds_read_b128 a[184:187], v1 offset:2176
v_mfma_f32_16x16x32_bf16 v[56:59], a[84:87], a[192:195], v[56:59]
v_fmac_f32 v208, 0.5, v10
v_mfma_f32_16x16x32_bf16 v[56:59], a[80:83], a[188:191], v[56:59]
v_fmac_f32 v209, 0.5, v11
v_mfma_f32_16x16x32_bf16 v[64:67], a[80:83], a[192:195], v[64:67]
v_mfma_f32_16x16x32_bf16 v[64:67], a[84:87], a[196:199], v[64:67]
s_waitcnt lgkmcnt(1)
v_accvgpr_read_b32 v12, a10
v_mfma_f32_16x16x32_bf16 v[64:67], a[88:91], a[200:203], v[64:67]
global_load_dwordx4 a[72:75], v3, s[20:21] offset:0
v_accvgpr_read_b32 v13, a11
v_mfma_f32_16x16x32_bf16 v[68:71], a[100:103], a[200:203], v[68:71]
ds_read_b128 a[188:191], v1 offset:3232
v_mfma_f32_16x16x32_bf16 v[68:71], a[96:99], a[196:199], v[68:71]
v_mfma_f32_16x16x32_bf16 v[68:71], a[92:95], a[192:195], v[68:71]
v_fmac_f32 v154, 0.5, v12
v_mfma_f32_16x16x32_bf16 v[76:79], a[92:95], a[196:199], v[76:79]
s_add_u32 m0, s23, 67648
v_mfma_f32_16x16x32_bf16 v[76:79], a[96:99], a[200:203], v[76:79]
buffer_load_dwordx4 v4, s[8:11], s12 offen offset:2048 lds
v_mfma_f32_16x16x32_bf16 v[76:79], a[100:103], a[204:207], v[76:79]
v_fmac_f32 v155, 0.5, v13
v_fmac_f32 v210, 0.5, v12
v_mfma_f32_16x16x32_bf16 v[72:75], a[88:91], a[204:207], v[72:75]
ds_read_b128 a[192:195], v1 offset:4288
v_mfma_f32_16x16x32_bf16 v[72:75], a[84:87], a[200:203], v[72:75]
global_load_dwordx4 a[76:79], v3, s[20:21] offset:1024
v_mfma_f32_16x16x32_bf16 v[72:75], a[80:83], a[196:199], v[72:75]
L_stub4:
s_cmp_eq_u32 s37, 1
s_cbranch_scc1 L_stub8
v_fmac_f32 v211, 0.5, v13
v_mfma_f32_16x16x32_bf16 v[80:83], a[80:83], a[200:203], v[80:83]
v_accvgpr_read_b32 v10, a12
v_mfma_f32_16x16x32_bf16 v[80:83], a[84:87], a[204:207], v[80:83]
v_accvgpr_read_b32 v11, a13
v_mfma_f32_16x16x32_bf16 v[80:83], a[88:91], a[208:211], v[80:83]
v_fmac_f32 v156, 0.5, v10
v_mfma_f32_16x16x32_bf16 v[84:87], a[100:103], a[208:211], v[84:87]
ds_read_b128 a[196:199], v1 offset:5344
v_mfma_f32_16x16x32_bf16 v[84:87], a[96:99], a[204:207], v[84:87]
v_mfma_f32_16x16x32_bf16 v[84:87], a[92:95], a[200:203], v[84:87]
s_waitcnt vmcnt(22)
v_fmac_f32 v157, 0.5, v11
v_mfma_f32_16x16x32_bf16 v[32:35], a[104:107], a[176:179], v[32:35]
v_fmac_f32 v212, 0.5, v10
v_mfma_f32_16x16x32_bf16 v[32:35], a[108:111], a[180:183], v[32:35]
s_waitcnt lgkmcnt(1)
global_load_dwordx4 a[80:83], v3, s[20:21] offset:2048
v_mfma_f32_16x16x32_bf16 v[32:35], a[112:115], a[184:187], v[32:35]
s_waitcnt vmcnt(19)
ds_read_b128 a[200:203], v1 offset:6400
v_mfma_f32_16x16x32_bf16 v[36:39], a[124:127], a[184:187], v[36:39]
v_fmac_f32 v213, 0.5, v11
v_mfma_f32_16x16x32_bf16 v[36:39], a[120:123], a[180:183], v[36:39]
s_add_u32 m0, s23, 67680
v_mfma_f32_16x16x32_bf16 v[36:39], a[116:119], a[176:179], v[36:39]
buffer_load_dwordx4 v4, s[8:11], s12 offen offset:3072 lds
v_mfma_f32_16x16x32_bf16 v[44:47], a[116:119], a[180:183], v[44:47]
v_accvgpr_read_b32 v12, a14
v_mfma_f32_16x16x32_bf16 v[44:47], a[120:123], a[184:187], v[44:47]
ds_read_b128 a[204:207], v1 offset:7456
v_mfma_f32_16x16x32_bf16 v[44:47], a[124:127], a[188:191], v[44:47]
global_load_dwordx4 a[84:87], v3, s[20:21] offset:3072
v_accvgpr_read_b32 v13, a15
v_mfma_f32_16x16x32_bf16 v[40:43], a[112:115], a[188:191], v[40:43]
ds_read_b128 a[176:179], v1 offset:96
v_mfma_f32_16x16x32_bf16 v[40:43], a[108:111], a[184:187], v[40:43]
v_fmac_f32 v158, 0.5, v12
v_mfma_f32_16x16x32_bf16 v[40:43], a[104:107], a[180:183], v[40:43]
v_mfma_f32_16x16x32_bf16 v[48:51], a[104:107], a[184:187], v[48:51]
v_fmac_f32 v159, 0.5, v13
v_mfma_f32_16x16x32_bf16 v[48:51], a[108:111], a[188:191], v[48:51]
s_add_u32 s20, s20, 8192
s_addc_u32 s21, s21, 0
v_mfma_f32_16x16x32_bf16 v[48:51], a[112:115], a[192:195], v[48:51]
ds_read_b128 a[208:211], v1 offset:8512
v_fmac_f32 v214, 0.5, v12
v_mfma_f32_16x16x32_bf16 v[52:55], a[124:127], a[192:195], v[52:55]
global_load_dwordx4 a[88:91], v3, s[20:21] offset:-4096
v_mfma_f32_16x16x32_bf16 v[52:55], a[120:123], a[188:191], v[52:55]
ds_read_b128 a[180:183], v1 offset:1152
v_fmac_f32 v215, 0.5, v13
v_mfma_f32_16x16x32_bf16 v[52:55], a[116:119], a[184:187], v[52:55]
v_mfma_f32_16x16x32_bf16 v[60:63], a[116:119], a[188:191], v[60:63]
v_accvgpr_read_b32 v10, a16
v_mfma_f32_16x16x32_bf16 v[60:63], a[120:123], a[192:195], v[60:63]
s_waitcnt lgkmcnt(2)
v_mfma_f32_16x16x32_bf16 v[60:63], a[124:127], a[196:199], v[60:63]
s_add_u32 m0, s23, 71808
global_load_dwordx4 a[92:95], v3, s[20:21] offset:-3072
v_mfma_f32_16x16x32_bf16 v[56:59], a[112:115], a[196:199], v[56:59]
ds_read_b128 a[184:187], v1 offset:2208
v_accvgpr_read_b32 v11, a17
v_mfma_f32_16x16x32_bf16 v[56:59], a[108:111], a[192:195], v[56:59]
v_mfma_f32_16x16x32_bf16 v[56:59], a[104:107], a[188:191], v[56:59]
buffer_load_dwordx4 v4, s[8:11], s13 offen offset:0 lds
v_mfma_f32_16x16x32_bf16 v[64:67], a[104:107], a[192:195], v[64:67]
v_fmac_f32 v160, 0.5, v10
v_fmac_f32 v161, 0.5, v11
v_mfma_f32_16x16x32_bf16 v[64:67], a[108:111], a[196:199], v[64:67]
v_mfma_f32_16x16x32_bf16 v[64:67], a[112:115], a[200:203], v[64:67]
global_load_dwordx4 a[96:99], v3, s[20:21] offset:-2048
v_fmac_f32 v216, 0.5, v10
v_mfma_f32_16x16x32_bf16 v[68:71], a[124:127], a[200:203], v[68:71]
ds_read_b128 a[188:191], v1 offset:3264
v_mfma_f32_16x16x32_bf16 v[68:71], a[120:123], a[196:199], v[68:71]
v_fmac_f32 v217, 0.5, v11
v_mfma_f32_16x16x32_bf16 v[68:71], a[116:119], a[192:195], v[68:71]
v_mfma_f32_16x16x32_bf16 v[76:79], a[116:119], a[196:199], v[76:79]
v_accvgpr_read_b32 v12, a18
v_mfma_f32_16x16x32_bf16 v[76:79], a[120:123], a[200:203], v[76:79]
v_accvgpr_read_b32 v13, a19
v_mfma_f32_16x16x32_bf16 v[76:79], a[124:127], a[204:207], v[76:79]
global_load_dwordx4 a[100:103], v3, s[20:21] offset:-1024
v_mfma_f32_16x16x32_bf16 v[72:75], a[112:115], a[204:207], v[72:75]
ds_read_b128 a[192:195], v1 offset:4320
v_mfma_f32_16x16x32_bf16 v[72:75], a[108:111], a[200:203], v[72:75]
v_fmac_f32 v162, 0.5, v12
v_mfma_f32_16x16x32_bf16 v[72:75], a[104:107], a[196:199], v[72:75]
v_fmac_f32 v163, 0.5, v13
v_mfma_f32_16x16x32_bf16 v[80:83], a[104:107], a[200:203], v[80:83]
s_add_u32 m0, s23, 71840
v_mfma_f32_16x16x32_bf16 v[80:83], a[108:111], a[204:207], v[80:83]
s_waitcnt lgkmcnt(1)
buffer_load_dwordx4 v4, s[8:11], s13 offen offset:1024 lds
v_mfma_f32_16x16x32_bf16 v[80:83], a[112:115], a[208:211], v[80:83]
v_fmac_f32 v218, 0.5, v12
v_fmac_f32 v219, 0.5, v13
v_mfma_f32_16x16x32_bf16 v[84:87], a[124:127], a[208:211], v[84:87]
ds_read_b128 a[196:199], v1 offset:5376
v_mfma_f32_16x16x32_bf16 v[84:87], a[120:123], a[204:207], v[84:87]
v_mfma_f32_16x16x32_bf16 v[84:87], a[116:119], a[200:203], v[84:87]
s_waitcnt vmcnt(22)
v_accvgpr_read_b32 v10, a20
v_mfma_f32_16x16x32_bf16 v[32:35], a[128:131], a[176:179], v[32:35]
v_accvgpr_read_b32 v11, a21
v_mfma_f32_16x16x32_bf16 v[32:35], a[132:135], a[180:183], v[32:35]
s_waitcnt vmcnt(18)
global_load_dwordx4 a[104:107], v3, s[20:21] offset:0
v_mfma_f32_16x16x32_bf16 v[32:35], a[136:139], a[184:187], v[32:35]
ds_read_b128 a[200:203], v1 offset:6432
v_fmac_f32 v164, 0.5, v10
v_mfma_f32_16x16x32_bf16 v[36:39], a[148:151], a[184:187], v[36:39]
v_mfma_f32_16x16x32_bf16 v[36:39], a[144:147], a[180:183], v[36:39]
v_fmac_f32 v165, 0.5, v11
v_mfma_f32_16x16x32_bf16 v[36:39], a[140:143], a[176:179], v[36:39]
v_fmac_f32 v220, 0.5, v10
v_mfma_f32_16x16x32_bf16 v[44:47], a[140:143], a[180:183], v[44:47]
v_mfma_f32_16x16x32_bf16 v[44:47], a[144:147], a[184:187], v[44:47]
global_load_dwordx4 a[108:111], v3, s[20:21] offset:1024
v_mfma_f32_16x16x32_bf16 v[44:47], a[148:151], a[188:191], v[44:47]
ds_read_b128 a[204:207], v1 offset:7488
v_fmac_f32 v221, 0.5, v11
v_mfma_f32_16x16x32_bf16 v[40:43], a[136:139], a[188:191], v[40:43]
ds_read_b128 a[176:179], v1 offset:128
v_mfma_f32_16x16x32_bf16 v[40:43], a[132:135], a[184:187], v[40:43]
s_add_u32 m0, s23, 71872
v_mfma_f32_16x16x32_bf16 v[40:43], a[128:131], a[180:183], v[40:43]
buffer_load_dwordx4 v4, s[8:11], s13 offen offset:2048 lds
v_mfma_f32_16x16x32_bf16 v[48:51], a[128:131], a[184:187], v[48:51]
v_accvgpr_read_b32 v12, a22
v_mfma_f32_16x16x32_bf16 v[48:51], a[132:135], a[188:191], v[48:51]
s_waitcnt lgkmcnt(2)
ds_read_b128 a[208:211], v1 offset:8544
v_mfma_f32_16x16x32_bf16 v[48:51], a[136:139], a[192:195], v[48:51]
global_load_dwordx4 a[112:115], v3, s[20:21] offset:2048
v_accvgpr_read_b32 v13, a23
v_mfma_f32_16x16x32_bf16 v[52:55], a[148:151], a[192:195], v[52:55]
ds_read_b128 a[180:183], v1 offset:1184
v_mfma_f32_16x16x32_bf16 v[52:55], a[144:147], a[188:191], v[52:55]
v_fmac_f32 v166, 0.5, v12
v_mfma_f32_16x16x32_bf16 v[52:55], a[140:143], a[184:187], v[52:55]
v_fmac_f32 v167, 0.5, v13
v_mfma_f32_16x16x32_bf16 v[60:63], a[140:143], a[188:191], v[60:63]
v_mfma_f32_16x16x32_bf16 v[60:63], a[144:147], a[192:195], v[60:63]
v_fmac_f32 v222, 0.5, v12
v_mfma_f32_16x16x32_bf16 v[60:63], a[148:151], a[196:199], v[60:63]
global_load_dwordx4 a[116:119], v3, s[20:21] offset:3072
v_fmac_f32 v223, 0.5, v13
v_mfma_f32_16x16x32_bf16 v[56:59], a[136:139], a[196:199], v[56:59]
ds_read_b128 a[184:187], v1 offset:2240
v_mfma_f32_16x16x32_bf16 v[56:59], a[132:135], a[192:195], v[56:59]
v_mfma_f32_16x16x32_bf16 v[56:59], a[128:131], a[188:191], v[56:59]
v_accvgpr_read_b32 v10, a24
v_mfma_f32_16x16x32_bf16 v[64:67], a[128:131], a[192:195], v[64:67]
v_mfma_f32_16x16x32_bf16 v[64:67], a[132:135], a[196:199], v[64:67]
v_accvgpr_read_b32 v11, a25
v_mfma_f32_16x16x32_bf16 v[64:67], a[136:139], a[200:203], v[64:67]
s_add_u32 m0, s23, 71904
v_fmac_f32 v168, 0.5, v10
v_mfma_f32_16x16x32_bf16 v[68:71], a[148:151], a[200:203], v[68:71]
s_add_u32 s20, s20, 8192
s_addc_u32 s21, s21, 0
v_mfma_f32_16x16x32_bf16 v[68:71], a[144:147], a[196:199], v[68:71]
buffer_load_dwordx4 v4, s[8:11], s13 offen offset:3072 lds
v_mfma_f32_16x16x32_bf16 v[68:71], a[140:143], a[192:195], v[68:71]
ds_read_b128 a[188:191], v1 offset:3296
v_fmac_f32 v169, 0.5, v11
v_mfma_f32_16x16x32_bf16 v[76:79], a[140:143], a[196:199], v[76:79]
s_waitcnt lgkmcnt(2)
v_mfma_f32_16x16x32_bf16 v[76:79], a[144:147], a[200:203], v[76:79]
global_load_dwordx4 a[120:123], v3, s[20:21] offset:-4096
v_fmac_f32 v224, 0.5, v10
v_mfma_f32_16x16x32_bf16 v[76:79], a[148:151], a[204:207], v[76:79]
v_fmac_f32 v225, 0.5, v11
v_mfma_f32_16x16x32_bf16 v[72:75], a[136:139], a[204:207], v[72:75]
ds_read_b128 a[192:195], v1 offset:4352
v_mfma_f32_16x16x32_bf16 v[72:75], a[132:135], a[200:203], v[72:75]
global_load_dwordx4 a[124:127], v3, s[20:21] offset:-3072
v_mfma_f32_16x16x32_bf16 v[72:75], a[128:131], a[196:199], v[72:75]
v_accvgpr_read_b32 v12, a26
v_mfma_f32_16x16x32_bf16 v[80:83], a[128:131], a[200:203], v[80:83]
v_accvgpr_read_b32 v13, a27
v_mfma_f32_16x16x32_bf16 v[80:83], a[132:135], a[204:207], v[80:83]
v_fmac_f32 v170, 0.5, v12
v_mfma_f32_16x16x32_bf16 v[80:83], a[136:139], a[208:211], v[80:83]
v_fmac_f32 v171, 0.5, v13
v_mfma_f32_16x16x32_bf16 v[84:87], a[148:151], a[208:211], v[84:87]
ds_read_b128 a[196:199], v1 offset:5408
v_mfma_f32_16x16x32_bf16 v[84:87], a[144:147], a[204:207], v[84:87]
v_mfma_f32_16x16x32_bf16 v[84:87], a[140:143], a[200:203], v[84:87]
s_waitcnt vmcnt(22)
v_fmac_f32 v226, 0.5, v12
v_mfma_f32_16x16x32_bf16 v[32:35], a[56:59], a[176:179], v[32:35]
s_add_u32 m0, s23, 76032
v_mfma_f32_16x16x32_bf16 v[32:35], a[60:63], a[180:183], v[32:35]
s_waitcnt lgkmcnt(1) vmcnt(17)
buffer_load_dwordx4 v4, s[8:11], s14 offen offset:0 lds
v_mfma_f32_16x16x32_bf16 v[32:35], a[64:67], a[184:187], v[32:35]
ds_read_b128 a[200:203], v1 offset:6464
v_fmac_f32 v227, 0.5, v13
v_mfma_f32_16x16x32_bf16 v[36:39], a[76:79], a[184:187], v[36:39]
v_accvgpr_read_b32 v10, a28
v_mfma_f32_16x16x32_bf16 v[36:39], a[72:75], a[180:183], v[36:39]
global_load_dwordx4 a[128:131], v3, s[20:21] offset:-2048
v_mfma_f32_16x16x32_bf16 v[36:39], a[68:71], a[176:179], v[36:39]
v_accvgpr_read_b32 v11, a29
v_mfma_f32_16x16x32_bf16 v[44:47], a[68:71], a[180:183], v[44:47]
v_fmac_f32 v172, 0.5, v10
v_mfma_f32_16x16x32_bf16 v[44:47], a[72:75], a[184:187], v[44:47]
global_load_dwordx4 a[132:135], v3, s[20:21] offset:-1024
v_mfma_f32_16x16x32_bf16 v[44:47], a[76:79], a[188:191], v[44:47]
ds_read_b128 a[204:207], v1 offset:7520
v_mfma_f32_16x16x32_bf16 v[40:43], a[64:67], a[188:191], v[40:43]
ds_read_b128 a[176:179], v1 offset:160
v_mfma_f32_16x16x32_bf16 v[40:43], a[60:63], a[184:187], v[40:43]
v_fmac_f32 v173, 0.5, v11
v_mfma_f32_16x16x32_bf16 v[40:43], a[56:59], a[180:183], v[40:43]
v_fmac_f32 v228, 0.5, v10
v_mfma_f32_16x16x32_bf16 v[48:51], a[56:59], a[184:187], v[48:51]
v_mfma_f32_16x16x32_bf16 v[48:51], a[60:63], a[188:191], v[48:51]
ds_read_b128 a[208:211], v1 offset:8576
v_mfma_f32_16x16x32_bf16 v[48:51], a[64:67], a[192:195], v[48:51]
global_load_dwordx4 a[136:139], v3, s[20:21] offset:0
v_fmac_f32 v229, 0.5, v11
v_mfma_f32_16x16x32_bf16 v[52:55], a[76:79], a[192:195], v[52:55]
ds_read_b128 a[180:183], v1 offset:1216
v_mfma_f32_16x16x32_bf16 v[52:55], a[72:75], a[188:191], v[52:55]
s_add_u32 m0, s23, 76064
v_mfma_f32_16x16x32_bf16 v[52:55], a[68:71], a[184:187], v[52:55]
buffer_load_dwordx4 v4, s[8:11], s14 offen offset:1024 lds
v_mfma_f32_16x16x32_bf16 v[60:63], a[68:71], a[188:191], v[60:63]
v_accvgpr_read_b32 v12, a30
v_accvgpr_read_b32 v13, a31
v_mfma_f32_16x16x32_bf16 v[60:63], a[72:75], a[192:195], v[60:63]
s_waitcnt lgkmcnt(2)
v_mfma_f32_16x16x32_bf16 v[60:63], a[76:79], a[196:199], v[60:63]
global_load_dwordx4 a[140:143], v3, s[20:21] offset:1024
v_fmac_f32 v174, 0.5, v12
v_mfma_f32_16x16x32_bf16 v[56:59], a[64:67], a[196:199], v[56:59]
ds_read_b128 a[184:187], v1 offset:2272
v_mfma_f32_16x16x32_bf16 v[56:59], a[60:63], a[192:195], v[56:59]
v_fmac_f32 v175, 0.5, v13
v_mfma_f32_16x16x32_bf16 v[56:59], a[56:59], a[188:191], v[56:59]
v_mfma_f32_16x16x32_bf16 v[64:67], a[56:59], a[192:195], v[64:67]
v_fmac_f32 v230, 0.5, v12
v_mfma_f32_16x16x32_bf16 v[64:67], a[60:63], a[196:199], v[64:67]
v_fmac_f32 v231, 0.5, v13
v_mfma_f32_16x16x32_bf16 v[64:67], a[64:67], a[200:203], v[64:67]
global_load_dwordx4 a[144:147], v3, s[20:21] offset:2048
v_mfma_f32_16x16x32_bf16 v[68:71], a[76:79], a[200:203], v[68:71]
ds_read_b128 a[188:191], v1 offset:3328
v_mfma_f32_16x16x32_bf16 v[68:71], a[72:75], a[196:199], v[68:71]
v_accvgpr_read_b32 v10, a32
v_mfma_f32_16x16x32_bf16 v[68:71], a[68:71], a[192:195], v[68:71]
v_mfma_f32_16x16x32_bf16 v[76:79], a[68:71], a[196:199], v[76:79]
v_accvgpr_read_b32 v11, a33
v_mfma_f32_16x16x32_bf16 v[76:79], a[72:75], a[200:203], v[76:79]
v_fmac_f32 v176, 0.5, v10
v_mfma_f32_16x16x32_bf16 v[76:79], a[76:79], a[204:207], v[76:79]
s_add_u32 m0, s23, 76096
global_load_dwordx4 a[148:151], v3, s[20:21] offset:3072
v_mfma_f32_16x16x32_bf16 v[72:75], a[64:67], a[204:207], v[72:75]
ds_read_b128 a[192:195], v1 offset:4384
v_mfma_f32_16x16x32_bf16 v[72:75], a[60:63], a[200:203], v[72:75]
v_fmac_f32 v177, 0.5, v11
v_mfma_f32_16x16x32_bf16 v[72:75], a[56:59], a[196:199], v[72:75]
buffer_load_dwordx4 v4, s[8:11], s14 offen offset:2048 lds
v_mfma_f32_16x16x32_bf16 v[80:83], a[56:59], a[200:203], v[80:83]
v_fmac_f32 v232, 0.5, v10
v_mfma_f32_16x16x32_bf16 v[80:83], a[60:63], a[204:207], v[80:83]
s_waitcnt lgkmcnt(1)
v_fmac_f32 v233, 0.5, v11
v_mfma_f32_16x16x32_bf16 v[80:83], a[64:67], a[208:211], v[80:83]
v_accvgpr_read_b32 v12, a34
v_mfma_f32_16x16x32_bf16 v[84:87], a[76:79], a[208:211], v[84:87]
ds_read_b128 a[196:199], v1 offset:5440
v_mfma_f32_16x16x32_bf16 v[84:87], a[72:75], a[204:207], v[84:87]
v_accvgpr_read_b32 v13, a35
v_mfma_f32_16x16x32_bf16 v[84:87], a[68:71], a[200:203], v[84:87]
s_waitcnt vmcnt(22)
v_mfma_f32_16x16x32_bf16 v[32:35], a[80:83], a[176:179], v[32:35]
v_fmac_f32 v178, 0.5, v12
v_mfma_f32_16x16x32_bf16 v[32:35], a[84:87], a[180:183], v[32:35]
s_waitcnt vmcnt(18)
s_add_u32 s20, s20, 8192
s_addc_u32 s21, s21, 0
v_mfma_f32_16x16x32_bf16 v[32:35], a[88:91], a[184:187], v[32:35]
global_load_dwordx4 a[56:59], v3, s[20:21] offset:-4096
v_fmac_f32 v179, 0.5, v13
v_mfma_f32_16x16x32_bf16 v[36:39], a[100:103], a[184:187], v[36:39]
ds_read_b128 a[200:203], v1 offset:6496
v_mfma_f32_16x16x32_bf16 v[36:39], a[96:99], a[180:183], v[36:39]
v_fmac_f32 v234, 0.5, v12
v_mfma_f32_16x16x32_bf16 v[36:39], a[92:95], a[176:179], v[36:39]
v_fmac_f32 v235, 0.5, v13
v_mfma_f32_16x16x32_bf16 v[44:47], a[92:95], a[180:183], v[44:47]
v_mfma_f32_16x16x32_bf16 v[44:47], a[96:99], a[184:187], v[44:47]
global_load_dwordx4 a[60:63], v3, s[20:21] offset:-3072
v_mfma_f32_16x16x32_bf16 v[44:47], a[100:103], a[188:191], v[44:47]
ds_read_b128 a[204:207], v1 offset:7552
v_accvgpr_read_b32 v10, a36
v_mfma_f32_16x16x32_bf16 v[40:43], a[88:91], a[188:191], v[40:43]
ds_read_b128 a[176:179], v1 offset:192
v_mfma_f32_16x16x32_bf16 v[40:43], a[84:87], a[184:187], v[40:43]
v_accvgpr_read_b32 v11, a37
v_mfma_f32_16x16x32_bf16 v[40:43], a[80:83], a[180:183], v[40:43]
v_mfma_f32_16x16x32_bf16 v[48:51], a[80:83], a[184:187], v[48:51]
v_fmac_f32 v180, 0.5, v10
v_mfma_f32_16x16x32_bf16 v[48:51], a[84:87], a[188:191], v[48:51]
s_waitcnt lgkmcnt(2)
ds_read_b128 a[208:211], v1 offset:8608
v_mfma_f32_16x16x32_bf16 v[48:51], a[88:91], a[192:195], v[48:51]
global_load_dwordx4 a[64:67], v3, s[20:21] offset:-2048
v_fmac_f32 v181, 0.5, v11
v_mfma_f32_16x16x32_bf16 v[52:55], a[100:103], a[192:195], v[52:55]
ds_read_b128 a[180:183], v1 offset:1248
v_mfma_f32_16x16x32_bf16 v[52:55], a[96:99], a[188:191], v[52:55]
v_fmac_f32 v236, 0.5, v10
v_mfma_f32_16x16x32_bf16 v[52:55], a[92:95], a[184:187], v[52:55]
v_mfma_f32_16x16x32_bf16 v[60:63], a[92:95], a[188:191], v[60:63]
v_fmac_f32 v237, 0.5, v11
v_mfma_f32_16x16x32_bf16 v[60:63], a[96:99], a[192:195], v[60:63]
v_accvgpr_read_b32 v12, a38
v_mfma_f32_16x16x32_bf16 v[60:63], a[100:103], a[196:199], v[60:63]
global_load_dwordx4 a[68:71], v3, s[20:21] offset:-1024
v_mfma_f32_16x16x32_bf16 v[56:59], a[88:91], a[196:199], v[56:59]
ds_read_b128 a[184:187], v1 offset:2304
v_mfma_f32_16x16x32_bf16 v[56:59], a[84:87], a[192:195], v[56:59]
v_accvgpr_read_b32 v13, a39
v_mfma_f32_16x16x32_bf16 v[56:59], a[80:83], a[188:191], v[56:59]
v_fmac_f32 v182, 0.5, v12
v_mfma_f32_16x16x32_bf16 v[64:67], a[80:83], a[192:195], v[64:67]
v_mfma_f32_16x16x32_bf16 v[64:67], a[84:87], a[196:199], v[64:67]
v_fmac_f32 v183, 0.5, v13
v_mfma_f32_16x16x32_bf16 v[64:67], a[88:91], a[200:203], v[64:67]
global_load_dwordx4 a[72:75], v3, s[20:21] offset:0
v_fmac_f32 v238, 0.5, v12
v_mfma_f32_16x16x32_bf16 v[68:71], a[100:103], a[200:203], v[68:71]
ds_read_b128 a[188:191], v1 offset:3360
v_mfma_f32_16x16x32_bf16 v[68:71], a[96:99], a[196:199], v[68:71]
v_fmac_f32 v239, 0.5, v13
v_mfma_f32_16x16x32_bf16 v[68:71], a[92:95], a[192:195], v[68:71]
v_mfma_f32_16x16x32_bf16 v[76:79], a[92:95], a[196:199], v[76:79]
v_accvgpr_read_b32 v10, a40
v_mfma_f32_16x16x32_bf16 v[76:79], a[96:99], a[200:203], v[76:79]
s_waitcnt lgkmcnt(1)
v_accvgpr_read_b32 v11, a41
v_mfma_f32_16x16x32_bf16 v[76:79], a[100:103], a[204:207], v[76:79]
global_load_dwordx4 a[76:79], v3, s[20:21] offset:1024
v_mfma_f32_16x16x32_bf16 v[72:75], a[88:91], a[204:207], v[72:75]
ds_read_b128 a[192:195], v1 offset:4416
v_mfma_f32_16x16x32_bf16 v[72:75], a[84:87], a[200:203], v[72:75]
v_fmac_f32 v184, 0.5, v10
v_mfma_f32_16x16x32_bf16 v[72:75], a[80:83], a[196:199], v[72:75]
v_fmac_f32 v185, 0.5, v11
v_mfma_f32_16x16x32_bf16 v[80:83], a[80:83], a[200:203], v[80:83]
v_fmac_f32 v240, 0.5, v10
v_mfma_f32_16x16x32_bf16 v[80:83], a[84:87], a[204:207], v[80:83]
v_mfma_f32_16x16x32_bf16 v[80:83], a[88:91], a[208:211], v[80:83]
v_fmac_f32 v241, 0.5, v11
v_mfma_f32_16x16x32_bf16 v[84:87], a[100:103], a[208:211], v[84:87]
ds_read_b128 a[196:199], v1 offset:5472
v_mfma_f32_16x16x32_bf16 v[84:87], a[96:99], a[204:207], v[84:87]
v_accvgpr_read_b32 v12, a42
v_mfma_f32_16x16x32_bf16 v[84:87], a[92:95], a[200:203], v[84:87]
s_waitcnt vmcnt(19)
v_accvgpr_read_b32 v13, a43
v_mfma_f32_16x16x32_bf16 v[32:35], a[104:107], a[176:179], v[32:35]
s_waitcnt vmcnt(15)
s_mov_b32 s36, L_h6-L_pc
v_mfma_f32_16x16x32_bf16 v[32:35], a[108:111], a[180:183], v[32:35]
s_mov_b32 s30, L_h7+128-L_pc
global_load_dwordx4 a[80:83], v3, s[20:21] offset:2048
v_mfma_f32_16x16x32_bf16 v[32:35], a[112:115], a[184:187], v[32:35]
ds_read_b128 a[200:203], v1 offset:6528
v_fmac_f32 v186, 0.5, v12
v_mfma_f32_16x16x32_bf16 v[36:39], a[124:127], a[184:187], v[36:39]
v_fmac_f32 v187, 0.5, v13
v_mfma_f32_16x16x32_bf16 v[36:39], a[120:123], a[180:183], v[36:39]
buffer_load_dword a252, v8, s[28:31], s36 offen
v_mfma_f32_16x16x32_bf16 v[36:39], a[116:119], a[176:179], v[36:39]
v_fmac_f32 v242, 0.5, v12
v_mfma_f32_16x16x32_bf16 v[44:47], a[116:119], a[180:183], v[44:47]
v_fmac_f32 v243, 0.5, v13
v_mfma_f32_16x16x32_bf16 v[44:47], a[120:123], a[184:187], v[44:47]
s_waitcnt lgkmcnt(1)
global_load_dwordx4 a[84:87], v3, s[20:21] offset:3072
v_mfma_f32_16x16x32_bf16 v[44:47], a[124:127], a[188:191], v[44:47]
ds_read_b128 a[204:207], v1 offset:7584
v_accvgpr_read_b32 v10, a44
v_mfma_f32_16x16x32_bf16 v[40:43], a[112:115], a[188:191], v[40:43]
ds_read_b128 a[176:179], v1 offset:224
v_mfma_f32_16x16x32_bf16 v[40:43], a[108:111], a[184:187], v[40:43]
v_mfma_f32_16x16x32_bf16 v[40:43], a[104:107], a[180:183], v[40:43]
v_accvgpr_read_b32 v11, a45
v_mfma_f32_16x16x32_bf16 v[48:51], a[104:107], a[184:187], v[48:51]
v_fmac_f32 v188, 0.5, v10
v_mfma_f32_16x16x32_bf16 v[48:51], a[108:111], a[188:191], v[48:51]
s_add_u32 s20, s20, 8192
s_addc_u32 s21, s21, 0
v_mfma_f32_16x16x32_bf16 v[48:51], a[112:115], a[192:195], v[48:51]
ds_read_b128 a[208:211], v1 offset:8640
v_mfma_f32_16x16x32_bf16 v[52:55], a[124:127], a[192:195], v[52:55]
global_load_dwordx4 a[88:91], v3, s[20:21] offset:-4096
v_mfma_f32_16x16x32_bf16 v[52:55], a[120:123], a[188:191], v[52:55]
ds_read_b128 a[180:183], v1 offset:1280
v_fmac_f32 v189, 0.5, v11
v_mfma_f32_16x16x32_bf16 v[52:55], a[116:119], a[184:187], v[52:55]
v_fmac_f32 v244, 0.5, v10
v_mfma_f32_16x16x32_bf16 v[60:63], a[116:119], a[188:191], v[60:63]
v_mfma_f32_16x16x32_bf16 v[60:63], a[120:123], a[192:195], v[60:63]
v_fmac_f32 v245, 0.5, v11
v_mfma_f32_16x16x32_bf16 v[60:63], a[124:127], a[196:199], v[60:63]
global_load_dwordx4 a[92:95], v3, s[20:21] offset:-3072
v_accvgpr_read_b32 v12, a46
v_mfma_f32_16x16x32_bf16 v[56:59], a[112:115], a[196:199], v[56:59]
ds_read_b128 a[184:187], v1 offset:2336
v_mfma_f32_16x16x32_bf16 v[56:59], a[108:111], a[192:195], v[56:59]
v_accvgpr_read_b32 v13, a47
v_mfma_f32_16x16x32_bf16 v[56:59], a[104:107], a[188:191], v[56:59]
v_mfma_f32_16x16x32_bf16 v[64:67], a[104:107], a[192:195], v[64:67]
v_fmac_f32 v190, 0.5, v12
v_mfma_f32_16x16x32_bf16 v[64:67], a[108:111], a[196:199], v[64:67]
s_waitcnt lgkmcnt(2)
v_fmac_f32 v191, 0.5, v13
v_mfma_f32_16x16x32_bf16 v[64:67], a[112:115], a[200:203], v[64:67]
global_load_dwordx4 a[96:99], v3, s[20:21] offset:-2048
v_mfma_f32_16x16x32_bf16 v[68:71], a[124:127], a[200:203], v[68:71]
ds_read_b128 a[188:191], v1 offset:3392
v_mfma_f32_16x16x32_bf16 v[68:71], a[120:123], a[196:199], v[68:71]
v_fmac_f32 v246, 0.5, v12
v_mfma_f32_16x16x32_bf16 v[68:71], a[116:119], a[192:195], v[68:71]
v_fmac_f32 v247, 0.5, v13
v_mfma_f32_16x16x32_bf16 v[76:79], a[116:119], a[196:199], v[76:79]
v_mfma_f32_16x16x32_bf16 v[76:79], a[120:123], a[200:203], v[76:79]
v_accvgpr_read_b32 v10, a48
v_mfma_f32_16x16x32_bf16 v[76:79], a[124:127], a[204:207], v[76:79]
global_load_dwordx4 a[100:103], v3, s[20:21] offset:-1024
v_accvgpr_read_b32 v11, a49
v_mfma_f32_16x16x32_bf16 v[72:75], a[112:115], a[204:207], v[72:75]
ds_read_b128 a[192:195], v1 offset:4448
v_mfma_f32_16x16x32_bf16 v[72:75], a[108:111], a[200:203], v[72:75]
v_mfma_f32_16x16x32_bf16 v[72:75], a[104:107], a[196:199], v[72:75]
v_fmac_f32 v192, 0.5, v10
v_mfma_f32_16x16x32_bf16 v[80:83], a[104:107], a[200:203], v[80:83]
v_fmac_f32 v193, 0.5, v11
v_mfma_f32_16x16x32_bf16 v[80:83], a[108:111], a[204:207], v[80:83]
v_fmac_f32 v248, 0.5, v10
v_mfma_f32_16x16x32_bf16 v[80:83], a[112:115], a[208:211], v[80:83]
v_fmac_f32 v249, 0.5, v11
v_mfma_f32_16x16x32_bf16 v[84:87], a[124:127], a[208:211], v[84:87]
ds_read_b128 a[196:199], v1 offset:5504
v_mfma_f32_16x16x32_bf16 v[84:87], a[120:123], a[204:207], v[84:87]
v_mfma_f32_16x16x32_bf16 v[84:87], a[116:119], a[200:203], v[84:87]
s_waitcnt vmcnt(18)
v_accvgpr_read_b32 v12, a50
v_mfma_f32_16x16x32_bf16 v[32:35], a[128:131], a[176:179], v[32:35]
s_waitcnt lgkmcnt(2)
ds_read_b128 a[200:203], v1 offset:6560
v_mfma_f32_16x16x32_bf16 v[32:35], a[132:135], a[180:183], v[32:35]
global_load_dwordx4 a[104:107], v3, s[20:21] offset:0
v_accvgpr_read_b32 v13, a51
v_mfma_f32_16x16x32_bf16 v[32:35], a[136:139], a[184:187], v[32:35]
s_waitcnt vmcnt(15)
ds_read_b128 a[204:207], v1 offset:7616
v_mfma_f32_16x16x32_bf16 v[36:39], a[148:151], a[184:187], v[36:39]
v_fmac_f32 v194, 0.5, v12
v_mfma_f32_16x16x32_bf16 v[36:39], a[144:147], a[180:183], v[36:39]
ds_read_b128 a[208:211], v1 offset:8672
v_mfma_f32_16x16x32_bf16 v[36:39], a[140:143], a[176:179], v[36:39]
v_mfma_f32_16x16x32_bf16 v[44:47], a[140:143], a[180:183], v[44:47]
v_fmac_f32 v195, 0.5, v13
v_mfma_f32_16x16x32_bf16 v[44:47], a[144:147], a[184:187], v[44:47]
global_load_dwordx4 a[108:111], v3, s[20:21] offset:1024
v_fmac_f32 v250, 0.5, v12
v_mfma_f32_16x16x32_bf16 v[44:47], a[148:151], a[188:191], v[44:47]
v_mfma_f32_16x16x32_bf16 v[40:43], a[136:139], a[188:191], v[40:43]
v_fmac_f32 v251, 0.5, v13
v_mfma_f32_16x16x32_bf16 v[40:43], a[132:135], a[184:187], v[40:43]
v_accvgpr_read_b32 v10, a52
v_mfma_f32_16x16x32_bf16 v[40:43], a[128:131], a[180:183], v[40:43]
v_mfma_f32_16x16x32_bf16 v[48:51], a[128:131], a[184:187], v[48:51]
s_waitcnt lgkmcnt(1)
v_accvgpr_read_b32 v11, a53
v_mfma_f32_16x16x32_bf16 v[48:51], a[132:135], a[188:191], v[48:51]
global_load_dwordx4 a[112:115], v3, s[20:21] offset:2048
v_fmac_f32 v196, 0.5, v10
v_mfma_f32_16x16x32_bf16 v[48:51], a[136:139], a[192:195], v[48:51]
s_waitcnt vmcnt(16)
v_fmac_f32 v197, 0.5, v11
v_mfma_f32_16x16x32_bf16 v[52:55], a[148:151], a[192:195], v[52:55]
s_nop 0
s_waitcnt lgkmcnt(0)
s_barrier
v_mfma_f32_16x16x32_bf16 v[52:55], a[144:147], a[188:191], v[52:55]
ds_read_b128 a[176:179], v2 offset:0
v_mfma_f32_16x16x32_bf16 v[52:55], a[140:143], a[184:187], v[52:55]
v_fmac_f32 v252, 0.5, v10
v_mfma_f32_16x16x32_bf16 v[60:63], a[140:143], a[188:191], v[60:63]
s_add_u32 s8, s8, 3280896
s_addc_u32 s9, s9, 0
v_mfma_f32_16x16x32_bf16 v[60:63], a[144:147], a[192:195], v[60:63]
s_add_u32 m0, s23, 0
ds_read_b128 a[180:183], v2 offset:1056
v_mfma_f32_16x16x32_bf16 v[60:63], a[148:151], a[196:199], v[60:63]
buffer_load_dwordx4 v4, s[8:11], 0 offen offset:0 lds
v_fmac_f32 v253, 0.5, v11
v_mfma_f32_16x16x32_bf16 v[56:59], a[136:139], a[196:199], v[56:59]
ds_read_b128 a[184:187], v2 offset:2112
v_mfma_f32_16x16x32_bf16 v[56:59], a[132:135], a[192:195], v[56:59]
v_accvgpr_read_b32 v12, a54
v_mfma_f32_16x16x32_bf16 v[56:59], a[128:131], a[188:191], v[56:59]
global_load_dwordx4 a[116:119], v3, s[20:21] offset:3072
v_mfma_f32_16x16x32_bf16 v[64:67], a[128:131], a[192:195], v[64:67]
v_accvgpr_read_b32 v13, a55
v_mfma_f32_16x16x32_bf16 v[64:67], a[132:135], a[196:199], v[64:67]
v_fmac_f32 v198, 0.5, v12
v_mfma_f32_16x16x32_bf16 v[64:67], a[136:139], a[200:203], v[64:67]
s_add_u32 s20, s20, 8192
s_addc_u32 s21, s21, 0
v_mfma_f32_16x16x32_bf16 v[68:71], a[148:151], a[200:203], v[68:71]
global_load_dwordx4 a[120:123], v3, s[20:21] offset:-4096
v_mfma_f32_16x16x32_bf16 v[68:71], a[144:147], a[196:199], v[68:71]
ds_read_b128 a[188:191], v2 offset:3168
v_fmac_f32 v199, 0.5, v13
v_mfma_f32_16x16x32_bf16 v[68:71], a[140:143], a[192:195], v[68:71]
v_fmac_f32 v254, 0.5, v12
v_mfma_f32_16x16x32_bf16 v[76:79], a[140:143], a[196:199], v[76:79]
v_mfma_f32_16x16x32_bf16 v[76:79], a[144:147], a[200:203], v[76:79]
v_fmac_f32 v255, 0.5, v13
v_mfma_f32_16x16x32_bf16 v[76:79], a[148:151], a[204:207], v[76:79]
global_load_dwordx4 a[124:127], v3, s[20:21] offset:-3072
v_mfma_f32_16x16x32_bf16 v[72:75], a[136:139], a[204:207], v[72:75]
ds_read_b128 a[192:195], v2 offset:4224
v_mfma_f32_16x16x32_bf16 v[72:75], a[132:135], a[200:203], v[72:75]
s_add_u32 m0, s23, 32
v_mfma_f32_16x16x32_bf16 v[72:75], a[128:131], a[196:199], v[72:75]
buffer_load_dwordx4 v4, s[8:11], 0 offen offset:1024 lds
v_mfma_f32_16x16x32_bf16 v[80:83], a[128:131], a[200:203], v[80:83]
v_mfma_f32_16x16x32_bf16 v[80:83], a[132:135], a[204:207], v[80:83]
v_mfma_f32_16x16x32_bf16 v[80:83], a[136:139], a[208:211], v[80:83]
v_mfma_f32_16x16x32_bf16 v[84:87], a[148:151], a[208:211], v[84:87]
ds_read_b128 a[196:199], v2 offset:5280
v_mfma_f32_16x16x32_bf16 v[84:87], a[144:147], a[204:207], v[84:87]
v_mfma_f32_16x16x32_bf16 v[84:87], a[140:143], a[200:203], v[84:87]
s_waitcnt vmcnt(18) lgkmcnt(2)
L_h5:
v_mfma_f32_16x16x32_bf16 v[88:91], a[56:59], a[176:179], v[88:91]
v_mfma_f32_16x16x32_bf16 v[88:91], a[60:63], a[180:183], v[88:91]
global_load_dwordx4 a[128:131], v3, s[20:21] offset:-2048
v_mfma_f32_16x16x32_bf16 v[88:91], a[64:67], a[184:187], v[88:91]
s_waitcnt vmcnt(16)
ds_read_b128 a[200:203], v2 offset:6336
v_mfma_f32_16x16x32_bf16 v[92:95], a[76:79], a[184:187], v[92:95]
v_mfma_f32_16x16x32_bf16 v[92:95], a[72:75], a[180:183], v[92:95]
v_mfma_f32_16x16x32_bf16 v[92:95], a[68:71], a[176:179], v[92:95]
v_mfma_f32_16x16x32_bf16 v[100:103], a[68:71], a[180:183], v[100:103]
v_mfma_f32_16x16x32_bf16 v[100:103], a[72:75], a[184:187], v[100:103]
global_load_dwordx4 a[132:135], v3, s[20:21] offset:-1024
v_mfma_f32_16x16x32_bf16 v[100:103], a[76:79], a[188:191], v[100:103]
s_add_u32 m0, s23, 64
ds_read_b128 a[204:207], v2 offset:7392
v_mfma_f32_16x16x32_bf16 v[96:99], a[64:67], a[188:191], v[96:99]
ds_read_b128 a[176:179], v2 offset:32
v_fmac_f32 v144, s66, v32
v_mfma_f32_16x16x32_bf16 v[96:99], a[60:63], a[184:187], v[96:99]
buffer_load_dwordx4 v4, s[8:11], 0 offen offset:2048 lds
v_mfma_f32_16x16x32_bf16 v[96:99], a[56:59], a[180:183], v[96:99]
v_mfma_f32_16x16x32_bf16 v[104:107], a[56:59], a[184:187], v[104:107]
v_fmac_f32 v200, s67, v32
v_mfma_f32_16x16x32_bf16 v[104:107], a[60:63], a[188:191], v[104:107]
s_waitcnt lgkmcnt(2)
ds_read_b128 a[208:211], v2 offset:8448
v_mfma_f32_16x16x32_bf16 v[104:107], a[64:67], a[192:195], v[104:107]
global_load_dwordx4 a[136:139], v3, s[20:21] offset:0
v_mfma_f32_16x16x32_bf16 v[108:111], a[76:79], a[192:195], v[108:111]
ds_read_b128 a[180:183], v2 offset:1088
v_mfma_f32_16x16x32_bf16 v[108:111], a[72:75], a[188:191], v[108:111]
L_stub5:
s_cmp_eq_u32 s37, 1
s_cbranch_scc1 L_stub9
v_fmac_f32 v145, s66, v33
v_mfma_f32_16x16x32_bf16 v[108:111], a[68:71], a[184:187], v[108:111]
v_mfma_f32_16x16x32_bf16 v[116:119], a[68:71], a[188:191], v[116:119]
v_fmac_f32 v201, s67, v33
v_mfma_f32_16x16x32_bf16 v[116:119], a[72:75], a[192:195], v[116:119]
v_mfma_f32_16x16x32_bf16 v[116:119], a[76:79], a[196:199], v[116:119]
global_load_dwordx4 a[140:143], v3, s[20:21] offset:1024
v_fmac_f32 v146, s66, v34
v_mfma_f32_16x16x32_bf16 v[112:115], a[64:67], a[196:199], v[112:115]
ds_read_b128 a[184:187], v2 offset:2144
v_mfma_f32_16x16x32_bf16 v[112:115], a[60:63], a[192:195], v[112:115]
v_mfma_f32_16x16x32_bf16 v[112:115], a[56:59], a[188:191], v[112:115]
v_fmac_f32 v202, s67, v34
v_mfma_f32_16x16x32_bf16 v[120:123], a[56:59], a[192:195], v[120:123]
s_add_u32 m0, s23, 96
v_mfma_f32_16x16x32_bf16 v[120:123], a[60:63], a[196:199], v[120:123]
buffer_load_dwordx4 v4, s[8:11], 0 offen offset:3072 lds
v_mfma_f32_16x16x32_bf16 v[120:123], a[64:67], a[200:203], v[120:123]
v_fmac_f32 v147, s66, v35
v_mfma_f32_16x16x32_bf16 v[124:127], a[76:79], a[200:203], v[124:127]
ds_read_b128 a[188:191], v2 offset:3200
v_mfma_f32_16x16x32_bf16 v[124:127], a[72:75], a[196:199], v[124:127]
global_load_dwordx4 a[144:147], v3, s[20:21] offset:2048
v_mfma_f32_16x16x32_bf16 v[124:127], a[68:71], a[192:195], v[124:127]
v_mfma_f32_16x16x32_bf16 v[132:135], a[68:71], a[196:199], v[132:135]
v_fmac_f32 v203, s67, v35
v_mfma_f32_16x16x32_bf16 v[132:135], a[72:75], a[200:203], v[132:135]
s_waitcnt lgkmcnt(1)
v_mfma_f32_16x16x32_bf16 v[132:135], a[76:79], a[204:207], v[132:135]
global_load_dwordx4 a[148:151], v3, s[20:21] offset:3072
v_fmac_f32 v148, s66, v36
v_mfma_f32_16x16x32_bf16 v[128:131], a[64:67], a[204:207], v[128:131]
ds_read_b128 a[192:195], v2 offset:4256
v_mfma_f32_16x16x32_bf16 v[128:131], a[60:63], a[200:203], v[128:131]
v_mfma_f32_16x16x32_bf16 v[128:131], a[56:59], a[196:199], v[128:131]
v_fmac_f32 v204, s67, v36
v_mfma_f32_16x16x32_bf16 v[136:139], a[56:59], a[200:203], v[136:139]
v_fmac_f32 v149, s66, v37
v_mfma_f32_16x16x32_bf16 v[136:139], a[60:63], a[204:207], v[136:139]
v_mfma_f32_16x16x32_bf16 v[136:139], a[64:67], a[208:211], v[136:139]
v_fmac_f32 v205, s67, v37
v_mfma_f32_16x16x32_bf16 v[140:143], a[76:79], a[208:211], v[140:143]
ds_read_b128 a[196:199], v2 offset:5312
v_mfma_f32_16x16x32_bf16 v[140:143], a[72:75], a[204:207], v[140:143]
s_add_u32 m0, s23, 4224
v_mfma_f32_16x16x32_bf16 v[140:143], a[68:71], a[200:203], v[140:143]
s_waitcnt vmcnt(19)
buffer_load_dwordx4 v4, s[8:11], s12 offen offset:0 lds
v_mfma_f32_16x16x32_bf16 v[88:91], a[80:83], a[176:179], v[88:91]
v_fmac_f32 v150, s66, v38
v_mfma_f32_16x16x32_bf16 v[88:91], a[84:87], a[180:183], v[88:91]
s_add_u32 s20, s20, 8192
s_addc_u32 s21, s21, 0
v_mfma_f32_16x16x32_bf16 v[88:91], a[88:91], a[184:187], v[88:91]
s_waitcnt vmcnt(17)
global_load_dwordx4 a[56:59], v3, s[20:21] offset:-4096
v_mfma_f32_16x16x32_bf16 v[92:95], a[100:103], a[184:187], v[92:95]
ds_read_b128 a[200:203], v2 offset:6368
v_fmac_f32 v206, s67, v38
v_mfma_f32_16x16x32_bf16 v[92:95], a[96:99], a[180:183], v[92:95]
v_mfma_f32_16x16x32_bf16 v[92:95], a[92:95], a[176:179], v[92:95]
v_fmac_f32 v151, s66, v39
v_mfma_f32_16x16x32_bf16 v[100:103], a[92:95], a[180:183], v[100:103]
v_mfma_f32_16x16x32_bf16 v[100:103], a[96:99], a[184:187], v[100:103]
s_waitcnt lgkmcnt(1)
global_load_dwordx4 a[60:63], v3, s[20:21] offset:-3072
v_mfma_f32_16x16x32_bf16 v[100:103], a[100:103], a[188:191], v[100:103]
ds_read_b128 a[204:207], v2 offset:7424
v_fmac_f32 v207, s67, v39
v_mfma_f32_16x16x32_bf16 v[96:99], a[88:91], a[188:191], v[96:99]
ds_read_b128 a[176:179], v2 offset:64
v_mfma_f32_16x16x32_bf16 v[96:99], a[84:87], a[184:187], v[96:99]
v_mfma_f32_16x16x32_bf16 v[96:99], a[80:83], a[180:183], v[96:99]
v_mfma_f32_16x16x32_bf16 v[104:107], a[80:83], a[184:187], v[104:107]
v_fmac_f32 v152, s66, v40
v_mfma_f32_16x16x32_bf16 v[104:107], a[84:87], a[188:191], v[104:107]
ds_read_b128 a[208:211], v2 offset:8480
v_mfma_f32_16x16x32_bf16 v[104:107], a[88:91], a[192:195], v[104:107]
s_add_u32 m0, s23, 4256
global_load_dwordx4 a[64:67], v3, s[20:21] offset:-2048
v_mfma_f32_16x16x32_bf16 v[108:111], a[100:103], a[192:195], v[108:111]
ds_read_b128 a[180:183], v2 offset:1120
v_mfma_f32_16x16x32_bf16 v[108:111], a[96:99], a[188:191], v[108:111]
v_mfma_f32_16x16x32_bf16 v[108:111], a[92:95], a[184:187], v[108:111]
buffer_load_dwordx4 v4, s[8:11], s12 offen offset:1024 lds
v_mfma_f32_16x16x32_bf16 v[116:119], a[92:95], a[188:191], v[116:119]
v_fmac_f32 v208, s67, v40
v_mfma_f32_16x16x32_bf16 v[116:119], a[96:99], a[192:195], v[116:119]
v_fmac_f32 v153, s66, v41
v_mfma_f32_16x16x32_bf16 v[116:119], a[100:103], a[196:199], v[116:119]
global_load_dwordx4 a[68:71], v3, s[20:21] offset:-1024
v_mfma_f32_16x16x32_bf16 v[112:115], a[88:91], a[196:199], v[112:115]
ds_read_b128 a[184:187], v2 offset:2176
v_mfma_f32_16x16x32_bf16 v[112:115], a[84:87], a[192:195], v[112:115]
v_fmac_f32 v209, s67, v41
v_mfma_f32_16x16x32_bf16 v[112:115], a[80:83], a[188:191], v[112:115]
v_mfma_f32_16x16x32_bf16 v[120:123], a[80:83], a[192:195], v[120:123]
v_fmac_f32 v154, s66, v42
v_mfma_f32_16x16x32_bf16 v[120:123], a[84:87], a[196:199], v[120:123]
s_waitcnt lgkmcnt(1)
v_mfma_f32_16x16x32_bf16 v[120:123], a[88:91], a[200:203], v[120:123]
global_load_dwordx4 a[72:75], v3, s[20:21] offset:0
v_fmac_f32 v210, s67, v42
v_mfma_f32_16x16x32_bf16 v[124:127], a[100:103], a[200:203], v[124:127]
ds_read_b128 a[188:191], v2 offset:3232
v_mfma_f32_16x16x32_bf16 v[124:127], a[96:99], a[196:199], v[124:127]
v_mfma_f32_16x16x32_bf16 v[124:127], a[92:95], a[192:195], v[124:127]
v_mfma_f32_16x16x32_bf16 v[132:135], a[92:95], a[196:199], v[132:135]
s_add_u32 m0, s23, 4288
v_fmac_f32 v155, s66, v43
v_mfma_f32_16x16x32_bf16 v[132:135], a[96:99], a[200:203], v[132:135]
buffer_load_dwordx4 v4, s[8:11], s12 offen offset:2048 lds
v_mfma_f32_16x16x32_bf16 v[132:135], a[100:103], a[204:207], v[132:135]
v_mfma_f32_16x16x32_bf16 v[128:131], a[88:91], a[204:207], v[128:131]
ds_read_b128 a[192:195], v2 offset:4288
v_mfma_f32_16x16x32_bf16 v[128:131], a[84:87], a[200:203], v[128:131]
global_load_dwordx4 a[76:79], v3, s[20:21] offset:1024
v_fmac_f32 v211, s67, v43
v_mfma_f32_16x16x32_bf16 v[128:131], a[80:83], a[196:199], v[128:131]
v_mfma_f32_16x16x32_bf16 v[136:139], a[80:83], a[200:203], v[136:139]
v_fmac_f32 v156, s66, v44
v_mfma_f32_16x16x32_bf16 v[136:139], a[84:87], a[204:207], v[136:139]
v_fmac_f32 v212, s67, v44
v_mfma_f32_16x16x32_bf16 v[136:139], a[88:91], a[208:211], v[136:139]
v_mfma_f32_16x16x32_bf16 v[140:143], a[100:103], a[208:211], v[140:143]
ds_read_b128 a[196:199], v2 offset:5344
v_mfma_f32_16x16x32_bf16 v[140:143], a[96:99], a[204:207], v[140:143]
v_fmac_f32 v157, s66, v45
v_mfma_f32_16x16x32_bf16 v[140:143], a[92:95], a[200:203], v[140:143]
s_waitcnt vmcnt(22)
v_mfma_f32_16x16x32_bf16 v[88:91], a[104:107], a[176:179], v[88:91]
v_fmac_f32 v213, s67, v45
v_mfma_f32_16x16x32_bf16 v[88:91], a[108:111], a[180:183], v[88:91]
s_waitcnt lgkmcnt(1)
global_load_dwordx4 a[80:83], v3, s[20:21] offset:2048
v_mfma_f32_16x16x32_bf16 v[88:91], a[112:115], a[184:187], v[88:91]
s_waitcnt vmcnt(19)
ds_read_b128 a[200:203], v2 offset:6400
v_mfma_f32_16x16x32_bf16 v[92:95], a[124:127], a[184:187], v[92:95]
v_mfma_f32_16x16x32_bf16 v[92:95], a[120:123], a[180:183], v[92:95]
s_add_u32 m0, s23, 4320
v_fmac_f32 v158, s66, v46
v_mfma_f32_16x16x32_bf16 v[92:95], a[116:119], a[176:179], v[92:95]
buffer_load_dwordx4 v4, s[8:11], s12 offen offset:3072 lds
v_mfma_f32_16x16x32_bf16 v[100:103], a[116:119], a[180:183], v[100:103]
v_mfma_f32_16x16x32_bf16 v[100:103], a[120:123], a[184:187], v[100:103]
ds_read_b128 a[204:207], v2 offset:7456
v_mfma_f32_16x16x32_bf16 v[100:103], a[124:127], a[188:191], v[100:103]
global_load_dwordx4 a[84:87], v3, s[20:21] offset:3072
v_fmac_f32 v214, s67, v46
v_mfma_f32_16x16x32_bf16 v[96:99], a[112:115], a[188:191], v[96:99]
ds_read_b128 a[176:179], v2 offset:96
v_mfma_f32_16x16x32_bf16 v[96:99], a[108:111], a[184:187], v[96:99]
v_mfma_f32_16x16x32_bf16 v[96:99], a[104:107], a[180:183], v[96:99]
v_fmac_f32 v159, s66, v47
v_mfma_f32_16x16x32_bf16 v[104:107], a[104:107], a[184:187], v[104:107]
v_mfma_f32_16x16x32_bf16 v[104:107], a[108:111], a[188:191], v[104:107]
s_add_u32 s20, s20, 8192
s_addc_u32 s21, s21, 0
v_mfma_f32_16x16x32_bf16 v[104:107], a[112:115], a[192:195], v[104:107]
ds_read_b128 a[208:211], v2 offset:8512
v_fmac_f32 v215, s67, v47
v_mfma_f32_16x16x32_bf16 v[108:111], a[124:127], a[192:195], v[108:111]
global_load_dwordx4 a[88:91], v3, s[20:21] offset:-4096
v_mfma_f32_16x16x32_bf16 v[108:111], a[120:123], a[188:191], v[108:111]
ds_read_b128 a[180:183], v2 offset:1152
v_mfma_f32_16x16x32_bf16 v[108:111], a[116:119], a[184:187], v[108:111]
v_fmac_f32 v160, s66, v48
v_mfma_f32_16x16x32_bf16 v[116:119], a[116:119], a[188:191], v[116:119]
v_mfma_f32_16x16x32_bf16 v[116:119], a[120:123], a[192:195], v[116:119]
s_waitcnt lgkmcnt(2)
v_mfma_f32_16x16x32_bf16 v[116:119], a[124:127], a[196:199], v[116:119]
s_add_u32 m0, s23, 8448
global_load_dwordx4 a[92:95], v3, s[20:21] offset:-3072
v_mfma_f32_16x16x32_bf16 v[112:115], a[112:115], a[196:199], v[112:115]
ds_read_b128 a[184:187], v2 offset:2208
v_fmac_f32 v216, s67, v48
v_mfma_f32_16x16x32_bf16 v[112:115], a[108:111], a[192:195], v[112:115]
v_mfma_f32_16x16x32_bf16 v[112:115], a[104:107], a[188:191], v[112:115]
buffer_load_dwordx4 v4, s[8:11], s13 offen offset:0 lds
v_mfma_f32_16x16x32_bf16 v[120:123], a[104:107], a[192:195], v[120:123]
v_fmac_f32 v161, s66, v49
v_mfma_f32_16x16x32_bf16 v[120:123], a[108:111], a[196:199], v[120:123]
v_mfma_f32_16x16x32_bf16 v[120:123], a[112:115], a[200:203], v[120:123]
global_load_dwordx4 a[96:99], v3, s[20:21] offset:-2048
v_fmac_f32 v217, s67, v49
v_mfma_f32_16x16x32_bf16 v[124:127], a[124:127], a[200:203], v[124:127]
ds_read_b128 a[188:191], v2 offset:3264
v_mfma_f32_16x16x32_bf16 v[124:127], a[120:123], a[196:199], v[124:127]
v_mfma_f32_16x16x32_bf16 v[124:127], a[116:119], a[192:195], v[124:127]
v_fmac_f32 v162, s66, v50
v_mfma_f32_16x16x32_bf16 v[132:135], a[116:119], a[196:199], v[132:135]
v_mfma_f32_16x16x32_bf16 v[132:135], a[120:123], a[200:203], v[132:135]
v_fmac_f32 v218, s67, v50
v_mfma_f32_16x16x32_bf16 v[132:135], a[124:127], a[204:207], v[132:135]
global_load_dwordx4 a[100:103], v3, s[20:21] offset:-1024
v_mfma_f32_16x16x32_bf16 v[128:131], a[112:115], a[204:207], v[128:131]
ds_read_b128 a[192:195], v2 offset:4320
v_mfma_f32_16x16x32_bf16 v[128:131], a[108:111], a[200:203], v[128:131]
v_mfma_f32_16x16x32_bf16 v[128:131], a[104:107], a[196:199], v[128:131]
v_fmac_f32 v163, s66, v51
v_mfma_f32_16x16x32_bf16 v[136:139], a[104:107], a[200:203], v[136:139]
s_add_u32 m0, s23, 8480
v_mfma_f32_16x16x32_bf16 v[136:139], a[108:111], a[204:207], v[136:139]
s_waitcnt lgkmcnt(1)
buffer_load_dwordx4 v4, s[8:11], s13 offen offset:1024 lds
v_mfma_f32_16x16x32_bf16 v[136:139], a[112:115], a[208:211], v[136:139]
v_fmac_f32 v219, s67, v51
v_mfma_f32_16x16x32_bf16 v[140:143], a[124:127], a[208:211], v[140:143]
ds_read_b128 a[196:199], v2 offset:5376
v_mfma_f32_16x16x32_bf16 v[140:143], a[120:123], a[204:207], v[140:143]
v_fmac_f32 v164, s66, v52
v_mfma_f32_16x16x32_bf16 v[140:143], a[116:119], a[200:203], v[140:143]
s_waitcnt vmcnt(22)
v_mfma_f32_16x16x32_bf16 v[88:91], a[128:131], a[176:179], v[88:91]
v_fmac_f32 v220, s67, v52
v_mfma_f32_16x16x32_bf16 v[88:91], a[132:135], a[180:183], v[88:91]
global_load_dwordx4 a[104:107], v3, s[20:21] offset:0
v_mfma_f32_16x16x32_bf16 v[88:91], a[136:139], a[184:187], v[88:91]
s_waitcnt vmcnt(19)
ds_read_b128 a[200:203], v2 offset:6432
v_mfma_f32_16x16x32_bf16 v[92:95], a[148:151], a[184:187], v[92:95]
v_fmac_f32 v165, s66, v53
v_mfma_f32_16x16x32_bf16 v[92:95], a[144:147], a[180:183], v[92:95]
v_mfma_f32_16x16x32_bf16 v[92:95], a[140:143], a[176:179], v[92:95]
v_fmac_f32 v221, s67, v53
v_mfma_f32_16x16x32_bf16 v[100:103], a[140:143], a[180:183], v[100:103]
v_mfma_f32_16x16x32_bf16 v[100:103], a[144:147], a[184:187], v[100:103]
global_load_dwordx4 a[108:111], v3, s[20:21] offset:1024
v_mfma_f32_16x16x32_bf16 v[100:103], a[148:151], a[188:191], v[100:103]
ds_read_b128 a[204:207], v2 offset:7488
v_fmac_f32 v166, s66, v54
v_mfma_f32_16x16x32_bf16 v[96:99], a[136:139], a[188:191], v[96:99]
ds_read_b128 a[176:179], v2 offset:128
v_mfma_f32_16x16x32_bf16 v[96:99], a[132:135], a[184:187], v[96:99]
s_add_u32 m0, s23, 8512
v_mfma_f32_16x16x32_bf16 v[96:99], a[128:131], a[180:183], v[96:99]
buffer_load_dwordx4 v4, s[8:11], s13 offen offset:2048 lds
v_mfma_f32_16x16x32_bf16 v[104:107], a[128:131], a[184:187], v[104:107]
s_waitcnt lgkmcnt(2)
v_mfma_f32_16x16x32_bf16 v[104:107], a[132:135], a[188:191], v[104:107]
ds_read_b128 a[208:211], v2 offset:8544
v_fmac_f32 v222, s67, v54
v_mfma_f32_16x16x32_bf16 v[104:107], a[136:139], a[192:195], v[104:107]
global_load_dwordx4 a[112:115], v3, s[20:21] offset:2048
v_mfma_f32_16x16x32_bf16 v[108:111], a[148:151], a[192:195], v[108:111]
ds_read_b128 a[180:183], v2 offset:1184
v_mfma_f32_16x16x32_bf16 v[108:111], a[144:147], a[188:191], v[108:111]
v_fmac_f32 v167, s66, v55
v_mfma_f32_16x16x32_bf16 v[108:111], a[140:143], a[184:187], v[108:111]
v_mfma_f32_16x16x32_bf16 v[116:119], a[140:143], a[188:191], v[116:119]
v_fmac_f32 v223, s67, v55
v_mfma_f32_16x16x32_bf16 v[116:119], a[144:147], a[192:195], v[116:119]
v_mfma_f32_16x16x32_bf16 v[116:119], a[148:151], a[196:199], v[116:119]
global_load_dwordx4 a[116:119], v3, s[20:21] offset:3072
v_fmac_f32 v168, s66, v56
v_mfma_f32_16x16x32_bf16 v[112:115], a[136:139], a[196:199], v[112:115]
ds_read_b128 a[184:187], v2 offset:2240
v_mfma_f32_16x16x32_bf16 v[112:115], a[132:135], a[192:195], v[112:115]
v_mfma_f32_16x16x32_bf16 v[112:115], a[128:131], a[188:191], v[112:115]
v_mfma_f32_16x16x32_bf16 v[120:123], a[128:131], a[192:195], v[120:123]
v_fmac_f32 v224, s67, v56
v_mfma_f32_16x16x32_bf16 v[120:123], a[132:135], a[196:199], v[120:123]
v_mfma_f32_16x16x32_bf16 v[120:123], a[136:139], a[200:203], v[120:123]
s_add_u32 m0, s23, 8544
v_mfma_f32_16x16x32_bf16 v[124:127], a[148:151], a[200:203], v[124:127]
s_add_u32 s20, s20, 8192
s_addc_u32 s21, s21, 0
v_mfma_f32_16x16x32_bf16 v[124:127], a[144:147], a[196:199], v[124:127]
buffer_load_dwordx4 v4, s[8:11], s13 offen offset:3072 lds
v_mfma_f32_16x16x32_bf16 v[124:127], a[140:143], a[192:195], v[124:127]
ds_read_b128 a[188:191], v2 offset:3296
v_fmac_f32 v169, s66, v57
v_mfma_f32_16x16x32_bf16 v[132:135], a[140:143], a[196:199], v[132:135]
s_waitcnt lgkmcnt(2)
v_mfma_f32_16x16x32_bf16 v[132:135], a[144:147], a[200:203], v[132:135]
global_load_dwordx4 a[120:123], v3, s[20:21] offset:-4096
v_fmac_f32 v225, s67, v57
v_mfma_f32_16x16x32_bf16 v[132:135], a[148:151], a[204:207], v[132:135]
v_mfma_f32_16x16x32_bf16 v[128:131], a[136:139], a[204:207], v[128:131]
ds_read_b128 a[192:195], v2 offset:4352
v_mfma_f32_16x16x32_bf16 v[128:131], a[132:135], a[200:203], v[128:131]
global_load_dwordx4 a[124:127], v3, s[20:21] offset:-3072
v_fmac_f32 v170, s66, v58
v_mfma_f32_16x16x32_bf16 v[128:131], a[128:131], a[196:199], v[128:131]
v_mfma_f32_16x16x32_bf16 v[136:139], a[128:131], a[200:203], v[136:139]
v_fmac_f32 v226, s67, v58
v_mfma_f32_16x16x32_bf16 v[136:139], a[132:135], a[204:207], v[136:139]
v_fmac_f32 v171, s66, v59
v_mfma_f32_16x16x32_bf16 v[136:139], a[136:139], a[208:211], v[136:139]
v_mfma_f32_16x16x32_bf16 v[140:143], a[148:151], a[208:211], v[140:143]
ds_read_b128 a[196:199], v2 offset:5408
v_mfma_f32_16x16x32_bf16 v[140:143], a[144:147], a[204:207], v[140:143]
v_fmac_f32 v227, s67, v59
v_mfma_f32_16x16x32_bf16 v[140:143], a[140:143], a[200:203], v[140:143]
s_waitcnt vmcnt(22)
v_mfma_f32_16x16x32_bf16 v[88:91], a[56:59], a[176:179], v[88:91]
s_add_u32 m0, s23, 12672
v_mfma_f32_16x16x32_bf16 v[88:91], a[60:63], a[180:183], v[88:91]
s_waitcnt lgkmcnt(1) vmcnt(17)
buffer_load_dwordx4 v4, s[8:11], s14 offen offset:0 lds
v_mfma_f32_16x16x32_bf16 v[88:91], a[64:67], a[184:187], v[88:91]
ds_read_b128 a[200:203], v2 offset:6464
v_fmac_f32 v172, s66, v60
v_mfma_f32_16x16x32_bf16 v[92:95], a[76:79], a[184:187], v[92:95]
v_mfma_f32_16x16x32_bf16 v[92:95], a[72:75], a[180:183], v[92:95]
global_load_dwordx4 a[128:131], v3, s[20:21] offset:-2048
v_mfma_f32_16x16x32_bf16 v[92:95], a[68:71], a[176:179], v[92:95]
v_fmac_f32 v228, s67, v60
v_mfma_f32_16x16x32_bf16 v[100:103], a[68:71], a[180:183], v[100:103]
v_mfma_f32_16x16x32_bf16 v[100:103], a[72:75], a[184:187], v[100:103]
global_load_dwordx4 a[132:135], v3, s[20:21] offset:-1024
v_mfma_f32_16x16x32_bf16 v[100:103], a[76:79], a[188:191], v[100:103]
ds_read_b128 a[204:207], v2 offset:7520
v_fmac_f32 v173, s66, v61
v_mfma_f32_16x16x32_bf16 v[96:99], a[64:67], a[188:191], v[96:99]
ds_read_b128 a[176:179], v2 offset:160
v_mfma_f32_16x16x32_bf16 v[96:99], a[60:63], a[184:187], v[96:99]
v_mfma_f32_16x16x32_bf16 v[96:99], a[56:59], a[180:183], v[96:99]
v_fmac_f32 v229, s67, v61
v_mfma_f32_16x16x32_bf16 v[104:107], a[56:59], a[184:187], v[104:107]
v_mfma_f32_16x16x32_bf16 v[104:107], a[60:63], a[188:191], v[104:107]
ds_read_b128 a[208:211], v2 offset:8576
v_mfma_f32_16x16x32_bf16 v[104:107], a[64:67], a[192:195], v[104:107]
global_load_dwordx4 a[136:139], v3, s[20:21] offset:0
v_fmac_f32 v174, s66, v62
v_mfma_f32_16x16x32_bf16 v[108:111], a[76:79], a[192:195], v[108:111]
ds_read_b128 a[180:183], v2 offset:1216
v_mfma_f32_16x16x32_bf16 v[108:111], a[72:75], a[188:191], v[108:111]
s_add_u32 m0, s23, 12704
v_mfma_f32_16x16x32_bf16 v[108:111], a[68:71], a[184:187], v[108:111]
buffer_load_dwordx4 v4, s[8:11], s14 offen offset:1024 lds
v_mfma_f32_16x16x32_bf16 v[116:119], a[68:71], a[188:191], v[116:119]
v_fmac_f32 v230, s67, v62
v_mfma_f32_16x16x32_bf16 v[116:119], a[72:75], a[192:195], v[116:119]
s_waitcnt lgkmcnt(2)
v_mfma_f32_16x16x32_bf16 v[116:119], a[76:79], a[196:199], v[116:119]
global_load_dwordx4 a[140:143], v3, s[20:21] offset:1024
v_fmac_f32 v175, s66, v63
v_mfma_f32_16x16x32_bf16 v[112:115], a[64:67], a[196:199], v[112:115]
ds_read_b128 a[184:187], v2 offset:2272
v_mfma_f32_16x16x32_bf16 v[112:115], a[60:63], a[192:195], v[112:115]
v_mfma_f32_16x16x32_bf16 v[112:115], a[56:59], a[188:191], v[112:115]
v_fmac_f32 v231, s67, v63
v_mfma_f32_16x16x32_bf16 v[120:123], a[56:59], a[192:195], v[120:123]
v_mfma_f32_16x16x32_bf16 v[120:123], a[60:63], a[196:199], v[120:123]
v_fmac_f32 v176, s66, v64
v_mfma_f32_16x16x32_bf16 v[120:123], a[64:67], a[200:203], v[120:123]
global_load_dwordx4 a[144:147], v3, s[20:21] offset:2048
v_mfma_f32_16x16x32_bf16 v[124:127], a[76:79], a[200:203], v[124:127]
ds_read_b128 a[188:191], v2 offset:3328
v_mfma_f32_16x16x32_bf16 v[124:127], a[72:75], a[196:199], v[124:127]
v_fmac_f32 v232, s67, v64
v_mfma_f32_16x16x32_bf16 v[124:127], a[68:71], a[192:195], v[124:127]
v_mfma_f32_16x16x32_bf16 v[132:135], a[68:71], a[196:199], v[132:135]
v_mfma_f32_16x16x32_bf16 v[132:135], a[72:75], a[200:203], v[132:135]
v_mfma_f32_16x16x32_bf16 v[132:135], a[76:79], a[204:207], v[132:135]
s_add_u32 m0, s23, 12736
global_load_dwordx4 a[148:151], v3, s[20:21] offset:3072
v_mfma_f32_16x16x32_bf16 v[128:131], a[64:67], a[204:207], v[128:131]
ds_read_b128 a[192:195], v2 offset:4384
v_fmac_f32 v177, s66, v65
v_mfma_f32_16x16x32_bf16 v[128:131], a[60:63], a[200:203], v[128:131]
v_mfma_f32_16x16x32_bf16 v[128:131], a[56:59], a[196:199], v[128:131]
buffer_load_dwordx4 v4, s[8:11], s14 offen offset:2048 lds
v_mfma_f32_16x16x32_bf16 v[136:139], a[56:59], a[200:203], v[136:139]
v_fmac_f32 v233, s67, v65
v_mfma_f32_16x16x32_bf16 v[136:139], a[60:63], a[204:207], v[136:139]
s_waitcnt lgkmcnt(1)
v_fmac_f32 v178, s66, v66
v_mfma_f32_16x16x32_bf16 v[136:139], a[64:67], a[208:211], v[136:139]
v_mfma_f32_16x16x32_bf16 v[140:143], a[76:79], a[208:211], v[140:143]
ds_read_b128 a[196:199], v2 offset:5440
v_mfma_f32_16x16x32_bf16 v[140:143], a[72:75], a[204:207], v[140:143]
v_fmac_f32 v234, s67, v66
v_mfma_f32_16x16x32_bf16 v[140:143], a[68:71], a[200:203], v[140:143]
s_waitcnt vmcnt(22)
v_mfma_f32_16x16x32_bf16 v[88:91], a[80:83], a[176:179], v[88:91]
v_fmac_f32 v179, s66, v67
v_mfma_f32_16x16x32_bf16 v[88:91], a[84:87], a[180:183], v[88:91]
s_add_u32 s20, s20, 8192
s_addc_u32 s21, s21, 0
v_mfma_f32_16x16x32_bf16 v[88:91], a[88:91], a[184:187], v[88:91]
s_waitcnt vmcnt(18)
global_load_dwordx4 a[56:59], v3, s[20:21] offset:-4096
v_mfma_f32_16x16x32_bf16 v[92:95], a[100:103], a[184:187], v[92:95]
ds_read_b128 a[200:203], v2 offset:6496
v_fmac_f32 v235, s67, v67
v_mfma_f32_16x16x32_bf16 v[92:95], a[96:99], a[180:183], v[92:95]
v_mfma_f32_16x16x32_bf16 v[92:95], a[92:95], a[176:179], v[92:95]
v_fmac_f32 v180, s66, v68
v_mfma_f32_16x16x32_bf16 v[100:103], a[92:95], a[180:183], v[100:103]
v_mfma_f32_16x16x32_bf16 v[100:103], a[96:99], a[184:187], v[100:103]
global_load_dwordx4 a[60:63], v3, s[20:21] offset:-3072
v_mfma_f32_16x16x32_bf16 v[100:103], a[100:103], a[188:191], v[100:103]
ds_read_b128 a[204:207], v2 offset:7552
v_fmac_f32 v236, s67, v68
v_mfma_f32_16x16x32_bf16 v[96:99], a[88:91], a[188:191], v[96:99]
ds_read_b128 a[176:179], v2 offset:192
v_mfma_f32_16x16x32_bf16 v[96:99], a[84:87], a[184:187], v[96:99]
v_mfma_f32_16x16x32_bf16 v[96:99], a[80:83], a[180:183], v[96:99]
v_fmac_f32 v181, s66, v69
v_mfma_f32_16x16x32_bf16 v[104:107], a[80:83], a[184:187], v[104:107]
v_mfma_f32_16x16x32_bf16 v[104:107], a[84:87], a[188:191], v[104:107]
s_waitcnt lgkmcnt(2)
ds_read_b128 a[208:211], v2 offset:8608
v_mfma_f32_16x16x32_bf16 v[104:107], a[88:91], a[192:195], v[104:107]
global_load_dwordx4 a[64:67], v3, s[20:21] offset:-2048
v_fmac_f32 v237, s67, v69
v_mfma_f32_16x16x32_bf16 v[108:111], a[100:103], a[192:195], v[108:111]
ds_read_b128 a[180:183], v2 offset:1248
v_mfma_f32_16x16x32_bf16 v[108:111], a[96:99], a[188:191], v[108:111]
v_mfma_f32_16x16x32_bf16 v[108:111], a[92:95], a[184:187], v[108:111]
v_fmac_f32 v182, s66, v70
v_mfma_f32_16x16x32_bf16 v[116:119], a[92:95], a[188:191], v[116:119]
v_mfma_f32_16x16x32_bf16 v[116:119], a[96:99], a[192:195], v[116:119]
v_fmac_f32 v238, s67, v70
v_mfma_f32_16x16x32_bf16 v[116:119], a[100:103], a[196:199], v[116:119]
global_load_dwordx4 a[68:71], v3, s[20:21] offset:-1024
v_mfma_f32_16x16x32_bf16 v[112:115], a[88:91], a[196:199], v[112:115]
ds_read_b128 a[184:187], v2 offset:2304
v_mfma_f32_16x16x32_bf16 v[112:115], a[84:87], a[192:195], v[112:115]
v_fmac_f32 v183, s66, v71
v_mfma_f32_16x16x32_bf16 v[112:115], a[80:83], a[188:191], v[112:115]
v_mfma_f32_16x16x32_bf16 v[120:123], a[80:83], a[192:195], v[120:123]
v_fmac_f32 v239, s67, v71
v_mfma_f32_16x16x32_bf16 v[120:123], a[84:87], a[196:199], v[120:123]
v_mfma_f32_16x16x32_bf16 v[120:123], a[88:91], a[200:203], v[120:123]
global_load_dwordx4 a[72:75], v3, s[20:21] offset:0
v_fmac_f32 v184, s66, v72
v_mfma_f32_16x16x32_bf16 v[124:127], a[100:103], a[200:203], v[124:127]
ds_read_b128 a[188:191], v2 offset:3360
v_mfma_f32_16x16x32_bf16 v[124:127], a[96:99], a[196:199], v[124:127]
v_mfma_f32_16x16x32_bf16 v[124:127], a[92:95], a[192:195], v[124:127]
v_mfma_f32_16x16x32_bf16 v[132:135], a[92:95], a[196:199], v[132:135]
v_fmac_f32 v240, s67, v72
v_mfma_f32_16x16x32_bf16 v[132:135], a[96:99], a[200:203], v[132:135]
s_waitcnt lgkmcnt(1)
v_mfma_f32_16x16x32_bf16 v[132:135], a[100:103], a[204:207], v[132:135]
global_load_dwordx4 a[76:79], v3, s[20:21] offset:1024
v_fmac_f32 v185, s66, v73
v_mfma_f32_16x16x32_bf16 v[128:131], a[88:91], a[204:207], v[128:131]
ds_read_b128 a[192:195], v2 offset:4416
v_mfma_f32_16x16x32_bf16 v[128:131], a[84:87], a[200:203], v[128:131]
v_mfma_f32_16x16x32_bf16 v[128:131], a[80:83], a[196:199], v[128:131]
v_fmac_f32 v241, s67, v73
v_mfma_f32_16x16x32_bf16 v[136:139], a[80:83], a[200:203], v[136:139]
v_fmac_f32 v186, s66, v74
v_mfma_f32_16x16x32_bf16 v[136:139], a[84:87], a[204:207], v[136:139]
v_mfma_f32_16x16x32_bf16 v[136:139], a[88:91], a[208:211], v[136:139]
v_fmac_f32 v242, s67, v74
v_mfma_f32_16x16x32_bf16 v[140:143], a[100:103], a[208:211], v[140:143]
ds_read_b128 a[196:199], v2 offset:5472
v_mfma_f32_16x16x32_bf16 v[140:143], a[96:99], a[204:207], v[140:143]
v_mfma_f32_16x16x32_bf16 v[140:143], a[92:95], a[200:203], v[140:143]
s_waitcnt vmcnt(19)
v_fmac_f32 v187, s66, v75
v_mfma_f32_16x16x32_bf16 v[88:91], a[104:107], a[176:179], v[88:91]
s_waitcnt vmcnt(15)
s_mov_b32 s36, L_h7-L_pc
v_mfma_f32_16x16x32_bf16 v[88:91], a[108:111], a[180:183], v[88:91]
s_mov_b32 s30, L_h8+128-L_pc
global_load_dwordx4 a[80:83], v3, s[20:21] offset:2048
v_mfma_f32_16x16x32_bf16 v[88:91], a[112:115], a[184:187], v[88:91]
ds_read_b128 a[200:203], v2 offset:6528
v_fmac_f32 v243, s67, v75
v_mfma_f32_16x16x32_bf16 v[92:95], a[124:127], a[184:187], v[92:95]
v_mfma_f32_16x16x32_bf16 v[92:95], a[120:123], a[180:183], v[92:95]
buffer_load_dword a252, v8, s[28:31], s36 offen
v_mfma_f32_16x16x32_bf16 v[92:95], a[116:119], a[176:179], v[92:95]
v_fmac_f32 v188, s66, v76
v_mfma_f32_16x16x32_bf16 v[100:103], a[116:119], a[180:183], v[100:103]
v_fmac_f32 v244, s67, v76
v_mfma_f32_16x16x32_bf16 v[100:103], a[120:123], a[184:187], v[100:103]
s_waitcnt lgkmcnt(1)
global_load_dwordx4 a[84:87], v3, s[20:21] offset:3072
v_mfma_f32_16x16x32_bf16 v[100:103], a[124:127], a[188:191], v[100:103]
ds_read_b128 a[204:207], v2 offset:7584
v_mfma_f32_16x16x32_bf16 v[96:99], a[112:115], a[188:191], v[96:99]
ds_read_b128 a[176:179], v2 offset:224
v_mfma_f32_16x16x32_bf16 v[96:99], a[108:111], a[184:187], v[96:99]
v_fmac_f32 v189, s66, v77
v_mfma_f32_16x16x32_bf16 v[96:99], a[104:107], a[180:183], v[96:99]
v_mfma_f32_16x16x32_bf16 v[104:107], a[104:107], a[184:187], v[104:107]
v_fmac_f32 v245, s67, v77
v_mfma_f32_16x16x32_bf16 v[104:107], a[108:111], a[188:191], v[104:107]
s_add_u32 s20, s20, 8192
s_addc_u32 s21, s21, 0
v_mfma_f32_16x16x32_bf16 v[104:107], a[112:115], a[192:195], v[104:107]
ds_read_b128 a[208:211], v2 offset:8640
v_mfma_f32_16x16x32_bf16 v[108:111], a[124:127], a[192:195], v[108:111]
global_load_dwordx4 a[88:91], v3, s[20:21] offset:-4096
v_mfma_f32_16x16x32_bf16 v[108:111], a[120:123], a[188:191], v[108:111]
ds_read_b128 a[180:183], v2 offset:1280
v_fmac_f32 v190, s66, v78
v_mfma_f32_16x16x32_bf16 v[108:111], a[116:119], a[184:187], v[108:111]
v_mfma_f32_16x16x32_bf16 v[116:119], a[116:119], a[188:191], v[116:119]
v_fmac_f32 v246, s67, v78
v_mfma_f32_16x16x32_bf16 v[116:119], a[120:123], a[192:195], v[116:119]
v_mfma_f32_16x16x32_bf16 v[116:119], a[124:127], a[196:199], v[116:119]
global_load_dwordx4 a[92:95], v3, s[20:21] offset:-3072
v_fmac_f32 v191, s66, v79
v_mfma_f32_16x16x32_bf16 v[112:115], a[112:115], a[196:199], v[112:115]
ds_read_b128 a[184:187], v2 offset:2336
v_mfma_f32_16x16x32_bf16 v[112:115], a[108:111], a[192:195], v[112:115]
v_mfma_f32_16x16x32_bf16 v[112:115], a[104:107], a[188:191], v[112:115]
v_fmac_f32 v247, s67, v79
v_mfma_f32_16x16x32_bf16 v[120:123], a[104:107], a[192:195], v[120:123]
v_mfma_f32_16x16x32_bf16 v[120:123], a[108:111], a[196:199], v[120:123]
s_waitcnt lgkmcnt(2)
v_fmac_f32 v192, s66, v80
v_mfma_f32_16x16x32_bf16 v[120:123], a[112:115], a[200:203], v[120:123]
global_load_dwordx4 a[96:99], v3, s[20:21] offset:-2048
v_mfma_f32_16x16x32_bf16 v[124:127], a[124:127], a[200:203], v[124:127]
ds_read_b128 a[188:191], v2 offset:3392
v_mfma_f32_16x16x32_bf16 v[124:127], a[120:123], a[196:199], v[124:127]
v_fmac_f32 v248, s67, v80
v_mfma_f32_16x16x32_bf16 v[124:127], a[116:119], a[192:195], v[124:127]
v_mfma_f32_16x16x32_bf16 v[132:135], a[116:119], a[196:199], v[132:135]
v_mfma_f32_16x16x32_bf16 v[132:135], a[120:123], a[200:203], v[132:135]
v_fmac_f32 v193, s66, v81
v_mfma_f32_16x16x32_bf16 v[132:135], a[124:127], a[204:207], v[132:135]
global_load_dwordx4 a[100:103], v3, s[20:21] offset:-1024
v_mfma_f32_16x16x32_bf16 v[128:131], a[112:115], a[204:207], v[128:131]
ds_read_b128 a[192:195], v2 offset:4448
v_mfma_f32_16x16x32_bf16 v[128:131], a[108:111], a[200:203], v[128:131]
v_fmac_f32 v249, s67, v81
v_mfma_f32_16x16x32_bf16 v[128:131], a[104:107], a[196:199], v[128:131]
v_mfma_f32_16x16x32_bf16 v[136:139], a[104:107], a[200:203], v[136:139]
v_fmac_f32 v194, s66, v82
v_mfma_f32_16x16x32_bf16 v[136:139], a[108:111], a[204:207], v[136:139]
v_fmac_f32 v250, s67, v82
v_mfma_f32_16x16x32_bf16 v[136:139], a[112:115], a[208:211], v[136:139]
v_mfma_f32_16x16x32_bf16 v[140:143], a[124:127], a[208:211], v[140:143]
ds_read_b128 a[196:199], v2 offset:5504
v_mfma_f32_16x16x32_bf16 v[140:143], a[120:123], a[204:207], v[140:143]
v_fmac_f32 v195, s66, v83
v_mfma_f32_16x16x32_bf16 v[140:143], a[116:119], a[200:203], v[140:143]
s_waitcnt vmcnt(18)
v_mfma_f32_16x16x32_bf16 v[88:91], a[128:131], a[176:179], v[88:91]
s_waitcnt lgkmcnt(2)
ds_read_b128 a[200:203], v2 offset:6560
v_mfma_f32_16x16x32_bf16 v[88:91], a[132:135], a[180:183], v[88:91]
global_load_dwordx4 a[104:107], v3, s[20:21] offset:0
v_fmac_f32 v251, s67, v83
v_mfma_f32_16x16x32_bf16 v[88:91], a[136:139], a[184:187], v[88:91]
s_waitcnt vmcnt(15)
ds_read_b128 a[204:207], v2 offset:7616
v_mfma_f32_16x16x32_bf16 v[92:95], a[148:151], a[184:187], v[92:95]
v_mfma_f32_16x16x32_bf16 v[92:95], a[144:147], a[180:183], v[92:95]
ds_read_b128 a[208:211], v2 offset:8672
v_mfma_f32_16x16x32_bf16 v[92:95], a[140:143], a[176:179], v[92:95]
v_fmac_f32 v196, s66, v84
v_mfma_f32_16x16x32_bf16 v[100:103], a[140:143], a[180:183], v[100:103]
v_mfma_f32_16x16x32_bf16 v[100:103], a[144:147], a[184:187], v[100:103]
global_load_dwordx4 a[108:111], v3, s[20:21] offset:1024
v_fmac_f32 v252, s67, v84
v_mfma_f32_16x16x32_bf16 v[100:103], a[148:151], a[188:191], v[100:103]
v_mfma_f32_16x16x32_bf16 v[96:99], a[136:139], a[188:191], v[96:99]
v_fmac_f32 v197, s66, v85
v_mfma_f32_16x16x32_bf16 v[96:99], a[132:135], a[184:187], v[96:99]
v_mfma_f32_16x16x32_bf16 v[96:99], a[128:131], a[180:183], v[96:99]
v_fmac_f32 v253, s67, v85
v_mfma_f32_16x16x32_bf16 v[104:107], a[128:131], a[184:187], v[104:107]
s_waitcnt lgkmcnt(1)
v_mfma_f32_16x16x32_bf16 v[104:107], a[132:135], a[188:191], v[104:107]
global_load_dwordx4 a[112:115], v3, s[20:21] offset:2048
v_fmac_f32 v198, s66, v86
v_mfma_f32_16x16x32_bf16 v[104:107], a[136:139], a[192:195], v[104:107]
s_waitcnt vmcnt(16)
v_mfma_f32_16x16x32_bf16 v[108:111], a[148:151], a[192:195], v[108:111]
s_nop 0
s_waitcnt lgkmcnt(0)
s_barrier
v_mfma_f32_16x16x32_bf16 v[108:111], a[144:147], a[188:191], v[108:111]
ds_read_b128 a[176:179], v1 offset:0
v_fmac_f32 v254, s67, v86
v_mfma_f32_16x16x32_bf16 v[108:111], a[140:143], a[184:187], v[108:111]
v_mfma_f32_16x16x32_bf16 v[116:119], a[140:143], a[188:191], v[116:119]
s_add_u32 s8, s8, 3280896
s_addc_u32 s9, s9, 0
v_mfma_f32_16x16x32_bf16 v[116:119], a[144:147], a[192:195], v[116:119]
s_add_u32 m0, s23, 63360
ds_read_b128 a[180:183], v1 offset:1056
v_mfma_f32_16x16x32_bf16 v[116:119], a[148:151], a[196:199], v[116:119]
L_stub6:
s_cmp_eq_u32 s37, 1
s_cbranch_scc1 L_stub10
buffer_load_dwordx4 v4, s[8:11], 0 offen offset:0 lds
v_fmac_f32 v199, s66, v87
v_mfma_f32_16x16x32_bf16 v[112:115], a[136:139], a[196:199], v[112:115]
ds_read_b128 a[184:187], v1 offset:2112
v_mfma_f32_16x16x32_bf16 v[112:115], a[132:135], a[192:195], v[112:115]
v_mfma_f32_16x16x32_bf16 v[112:115], a[128:131], a[188:191], v[112:115]
global_load_dwordx4 a[116:119], v3, s[20:21] offset:3072
v_fmac_f32 v255, s67, v87
v_mfma_f32_16x16x32_bf16 v[120:123], a[128:131], a[192:195], v[120:123]
v_mfma_f32_16x16x32_bf16 v[120:123], a[132:135], a[196:199], v[120:123]
v_mfma_f32_16x16x32_bf16 v[120:123], a[136:139], a[200:203], v[120:123]
s_add_u32 s20, s20, 8192
s_addc_u32 s21, s21, 0
v_mfma_f32_16x16x32_bf16 v[124:127], a[148:151], a[200:203], v[124:127]
global_load_dwordx4 a[120:123], v3, s[20:21] offset:-4096
v_mfma_f32_16x16x32_bf16 v[124:127], a[144:147], a[196:199], v[124:127]
ds_read_b128 a[188:191], v1 offset:3168
v_mfma_f32_16x16x32_bf16 v[124:127], a[140:143], a[192:195], v[124:127]
v_mfma_f32_16x16x32_bf16 v[132:135], a[140:143], a[196:199], v[132:135]
v_mfma_f32_16x16x32_bf16 v[132:135], a[144:147], a[200:203], v[132:135]
v_mfma_f32_16x16x32_bf16 v[132:135], a[148:151], a[204:207], v[132:135]
global_load_dwordx4 a[124:127], v3, s[20:21] offset:-3072
v_mfma_f32_16x16x32_bf16 v[128:131], a[136:139], a[204:207], v[128:131]
ds_read_b128 a[192:195], v1 offset:4224
v_mfma_f32_16x16x32_bf16 v[128:131], a[132:135], a[200:203], v[128:131]
s_add_u32 m0, s23, 63392
v_mfma_f32_16x16x32_bf16 v[128:131], a[128:131], a[196:199], v[128:131]
s_mov_b32 s60, 0xbccba68d
v_mfma_f32_16x16x32_bf16 v[136:139], a[128:131], a[200:203], v[136:139]
s_mov_b32 s61, 0xbd4177d3
v_mfma_f32_16x16x32_bf16 v[136:139], a[132:135], a[204:207], v[136:139]
s_mov_b32 s62, 0xbeef9b1d
v_mfma_f32_16x16x32_bf16 v[136:139], a[136:139], a[208:211], v[136:139]
s_mov_b32 s63, 0xbd770f71
v_mfma_f32_16x16x32_bf16 v[140:143], a[148:151], a[208:211], v[140:143]
s_mov_b32 s64, 0xbf63a028
ds_read_b128 a[196:199], v1 offset:5280
v_mfma_f32_16x16x32_bf16 v[140:143], a[144:147], a[204:207], v[140:143]
s_mov_b32 s65, 0xbe7c377d
v_mfma_f32_16x16x32_bf16 v[140:143], a[140:143], a[200:203], v[140:143]
s_waitcnt vmcnt(17) lgkmcnt(2)
s_mov_b32 s66, 0xbdeab512
L_h6:
v_mfma_f32_16x16x32_bf16 v[200:203], a[56:59], a[176:179], v[200:203]
s_mov_b32 s67, 0xbd020821
v_mfma_f32_16x16x32_bf16 v[200:203], a[60:63], a[180:183], v[200:203]
buffer_load_dwordx4 v4, s[8:11], 0 offen offset:1024 lds
v_mfma_f32_16x16x32_bf16 v[200:203], a[64:67], a[184:187], v[200:203]
s_waitcnt vmcnt(15)
ds_read_b128 a[200:203], v1 offset:6336
v_mfma_f32_16x16x32_bf16 v[204:207], a[76:79], a[184:187], v[204:207]
v_mfma_f32_16x16x32_bf16 v[204:207], a[72:75], a[180:183], v[204:207]
global_load_dwordx4 a[128:131], v3, s[20:21] offset:-2048
v_mfma_f32_16x16x32_bf16 v[204:207], a[68:71], a[176:179], v[204:207]
v_mfma_f32_16x16x32_bf16 v[212:215], a[68:71], a[180:183], v[212:215]
v_mfma_f32_16x16x32_bf16 v[212:215], a[72:75], a[184:187], v[212:215]
global_load_dwordx4 a[132:135], v3, s[20:21] offset:-1024
v_mfma_f32_16x16x32_bf16 v[212:215], a[76:79], a[188:191], v[212:215]
s_add_u32 m0, s23, 63424
ds_read_b128 a[204:207], v1 offset:7392
v_mfma_f32_16x16x32_bf16 v[208:211], a[64:67], a[188:191], v[208:211]
ds_read_b128 a[176:179], v1 offset:32
v_mfma_f32_16x16x32_bf16 v[208:211], a[60:63], a[184:187], v[208:211]
buffer_load_dwordx4 v4, s[8:11], 0 offen offset:2048 lds
v_mfma_f32_16x16x32_bf16 v[208:211], a[56:59], a[180:183], v[208:211]
v_mfma_f32_16x16x32_bf16 v[216:219], a[56:59], a[184:187], v[216:219]
s_waitcnt lgkmcnt(2)
v_mfma_f32_16x16x32_bf16 v[216:219], a[60:63], a[188:191], v[216:219]
ds_read_b128 a[208:211], v1 offset:8448
v_fmac_f32 v200, s61, v88
v_mfma_f32_16x16x32_bf16 v[216:219], a[64:67], a[192:195], v[216:219]
global_load_dwordx4 a[136:139], v3, s[20:21] offset:0
v_fmac_f32 v201, s61, v89
v_mfma_f32_16x16x32_bf16 v[220:223], a[76:79], a[192:195], v[220:223]
ds_read_b128 a[180:183], v1 offset:1088
v_fmac_f32 v202, s61, v90
v_mfma_f32_16x16x32_bf16 v[220:223], a[72:75], a[188:191], v[220:223]
v_fmac_f32 v203, s61, v91
v_fmac_f32 v204, s61, v92
v_mfma_f32_16x16x32_bf16 v[220:223], a[68:71], a[184:187], v[220:223]
v_fmac_f32 v205, s61, v93
v_fmac_f32 v206, s61, v94
v_mfma_f32_16x16x32_bf16 v[228:231], a[68:71], a[188:191], v[228:231]
v_fmac_f32 v207, s61, v95
v_mfma_f32_16x16x32_bf16 v[228:231], a[72:75], a[192:195], v[228:231]
v_fmac_f32 v208, s61, v96
v_fmac_f32 v209, s61, v97
v_mfma_f32_16x16x32_bf16 v[228:231], a[76:79], a[196:199], v[228:231]
global_load_dwordx4 a[140:143], v3, s[20:21] offset:1024
v_fmac_f32 v210, s61, v98
v_mfma_f32_16x16x32_bf16 v[224:227], a[64:67], a[196:199], v[224:227]
ds_read_b128 a[184:187], v1 offset:2144
v_fmac_f32 v211, s61, v99
v_mfma_f32_16x16x32_bf16 v[224:227], a[60:63], a[192:195], v[224:227]
v_fmac_f32 v212, s61, v100
v_fmac_f32 v213, s61, v101
v_mfma_f32_16x16x32_bf16 v[224:227], a[56:59], a[188:191], v[224:227]
v_fmac_f32 v214, s61, v102
v_mfma_f32_16x16x32_bf16 v[232:235], a[56:59], a[192:195], v[232:235]
s_add_u32 m0, s23, 63456
v_accvgpr_read_b32 v10, a0
v_fmac_f32 v215, s61, v103
v_mfma_f32_16x16x32_bf16 v[232:235], a[60:63], a[196:199], v[232:235]
buffer_load_dwordx4 v4, s[8:11], 0 offen offset:3072 lds
v_fmac_f32 v216, s61, v104
v_mfma_f32_16x16x32_bf16 v[232:235], a[64:67], a[200:203], v[232:235]
v_fmac_f32 v217, s61, v105
v_fmac_f32 v218, s61, v106
v_mfma_f32_16x16x32_bf16 v[236:239], a[76:79], a[200:203], v[236:239]
ds_read_b128 a[188:191], v1 offset:3200
v_accvgpr_read_b32 v13, a1
v_mfma_f32_16x16x32_bf16 v[236:239], a[72:75], a[196:199], v[236:239]
global_load_dwordx4 a[144:147], v3, s[20:21] offset:2048
v_fmac_f32 v219, s61, v107
v_mfma_f32_16x16x32_bf16 v[236:239], a[68:71], a[192:195], v[236:239]
v_fmac_f32 v220, s61, v108
v_fmac_f32 v221, s61, v109
v_mfma_f32_16x16x32_bf16 v[244:247], a[68:71], a[196:199], v[244:247]
v_fmac_f32 v222, s61, v110
v_fmac_f32 v144, s60, v88
v_mfma_f32_16x16x32_bf16 v[244:247], a[72:75], a[200:203], v[244:247]
s_waitcnt lgkmcnt(1)
v_fmac_f32 v223, s61, v111
v_fmac_f32 v224, s61, v112
v_mfma_f32_16x16x32_bf16 v[244:247], a[76:79], a[204:207], v[244:247]
global_load_dwordx4 a[148:151], v3, s[20:21] offset:3072
v_fmac_f32 v225, s61, v113
v_mfma_f32_16x16x32_bf16 v[240:243], a[64:67], a[204:207], v[240:243]
ds_read_b128 a[192:195], v1 offset:4256
v_fmac_f32 v145, s60, v89
v_mfma_f32_16x16x32_bf16 v[240:243], a[60:63], a[200:203], v[240:243]
v_fmac_f32 v226, s61, v114
v_fmac_f32 v227, s61, v115
v_mfma_f32_16x16x32_bf16 v[240:243], a[56:59], a[196:199], v[240:243]
v_fmac_f32 v228, s61, v116
v_fmac_f32 v229, s61, v117
v_mfma_f32_16x16x32_bf16 v[248:251], a[56:59], a[200:203], v[248:251]
v_fma_f32 v11, s62, v32, v10
v_fmac_f32 v230, s61, v118
v_mfma_f32_16x16x32_bf16 v[248:251], a[60:63], a[204:207], v[248:251]
v_fmac_f32 v231, s61, v119
v_fma_f32 v14, s62, v33, v13
v_mfma_f32_16x16x32_bf16 v[248:251], a[64:67], a[208:211], v[248:251]
v_fmac_f32 v232, s61, v120
v_fmac_f32 v233, s61, v121
v_mfma_f32_16x16x32_bf16 v[252:255], a[76:79], a[208:211], v[252:255]
ds_read_b128 a[196:199], v1 offset:5312
v_fmac_f32 v234, s61, v122
v_mfma_f32_16x16x32_bf16 v[252:255], a[72:75], a[204:207], v[252:255]
s_add_u32 m0, s23, 67584
v_fma_f32 v12, s64, v32, v10
v_fmac_f32 v235, s61, v123
v_mfma_f32_16x16x32_bf16 v[252:255], a[68:71], a[200:203], v[252:255]
s_waitcnt vmcnt(19)
buffer_load_dwordx4 v4, s[8:11], s12 offen offset:0 lds
v_mfma_f32_16x16x32_bf16 v[200:203], a[80:83], a[176:179], v[200:203]
s_waitcnt vmcnt(17)
v_fmac_f32 v236, s61, v124
v_fmac_f32 v237, s61, v125
v_mfma_f32_16x16x32_bf16 v[200:203], a[84:87], a[180:183], v[200:203]
s_add_u32 s20, s20, 8192
s_addc_u32 s21, s21, 0
v_fmac_f32 v238, s61, v126
v_mfma_f32_16x16x32_bf16 v[200:203], a[88:91], a[184:187], v[200:203]
global_load_dwordx4 a[56:59], v3, s[20:21] offset:-4096
v_fmac_f32 v239, s61, v127
v_mfma_f32_16x16x32_bf16 v[204:207], a[100:103], a[184:187], v[204:207]
ds_read_b128 a[200:203], v1 offset:6368
v_fma_f32 v15, s64, v33, v13
v_mfma_f32_16x16x32_bf16 v[204:207], a[96:99], a[180:183], v[204:207]
v_fmac_f32 v240, s61, v128
v_fmac_f32 v241, s61, v129
v_mfma_f32_16x16x32_bf16 v[204:207], a[92:95], a[176:179], v[204:207]
v_fmac_f32 v242, s61, v130
v_fmac_f32 v243, s61, v131
v_mfma_f32_16x16x32_bf16 v[212:215], a[92:95], a[180:183], v[212:215]
s_waitcnt lgkmcnt(2)
v_fmac_f32 v11, s63, v88
v_fmac_f32 v244, s61, v132
v_mfma_f32_16x16x32_bf16 v[212:215], a[96:99], a[184:187], v[212:215]
global_load_dwordx4 a[60:63], v3, s[20:21] offset:-3072
v_fmac_f32 v245, s61, v133
v_mfma_f32_16x16x32_bf16 v[212:215], a[100:103], a[188:191], v[212:215]
ds_read_b128 a[204:207], v1 offset:7424
v_fmac_f32 v246, s61, v134
v_mfma_f32_16x16x32_bf16 v[208:211], a[88:91], a[188:191], v[208:211]
ds_read_b128 a[176:179], v1 offset:64
v_fmac_f32 v14, s63, v89
v_mfma_f32_16x16x32_bf16 v[208:211], a[84:87], a[184:187], v[208:211]
v_fmac_f32 v247, s61, v135
v_fmac_f32 v248, s61, v136
v_mfma_f32_16x16x32_bf16 v[208:211], a[80:83], a[180:183], v[208:211]
v_fmac_f32 v249, s61, v137
v_fma_f32 v32, s65, v32, v10
v_mfma_f32_16x16x32_bf16 v[216:219], a[80:83], a[184:187], v[216:219]
v_fmac_f32 v250, s61, v138
v_fmac_f32 v251, s61, v139
v_mfma_f32_16x16x32_bf16 v[216:219], a[84:87], a[188:191], v[216:219]
ds_read_b128 a[208:211], v1 offset:8480
v_fmac_f32 v252, s61, v140
v_mfma_f32_16x16x32_bf16 v[216:219], a[88:91], a[192:195], v[216:219]
s_add_u32 m0, s23, 67616
v_fmac_f32 v253, s61, v141
v_fma_f32 v33, s65, v33, v13
v_mfma_f32_16x16x32_bf16 v[220:223], a[100:103], a[192:195], v[220:223]
global_load_dwordx4 a[64:67], v3, s[20:21] offset:-2048
v_fmac_f32 v254, s61, v142
v_mfma_f32_16x16x32_bf16 v[220:223], a[96:99], a[188:191], v[220:223]
ds_read_b128 a[180:183], v1 offset:1120
v_accvgpr_write_b32 a0, v11
v_mfma_f32_16x16x32_bf16 v[220:223], a[92:95], a[184:187], v[220:223]
v_fmac_f32 v255, s61, v143
v_accvgpr_write_b32 a1, v14
v_mfma_f32_16x16x32_bf16 v[228:231], a[92:95], a[188:191], v[228:231]
buffer_load_dwordx4 v4, s[8:11], s12 offen offset:1024 lds
v_mfma_f32_16x16x32_bf16 v[228:231], a[96:99], a[192:195], v[228:231]
s_waitcnt lgkmcnt(2)
v_fmac_f32 v32, s66, v88
v_fmac_f32 v33, s66, v89
v_mfma_f32_16x16x32_bf16 v[228:231], a[100:103], a[196:199], v[228:231]
v_fma_f32 v88, s67, v88, v12
v_fma_f32 v89, s67, v89, v15
v_mfma_f32_16x16x32_bf16 v[224:227], a[88:91], a[196:199], v[224:227]
global_load_dwordx4 a[68:71], v3, s[20:21] offset:-1024
v_accvgpr_read_b32 v10, a2
v_mfma_f32_16x16x32_bf16 v[224:227], a[84:87], a[192:195], v[224:227]
ds_read_b128 a[184:187], v1 offset:2176
v_accvgpr_read_b32 v13, a3
v_mfma_f32_16x16x32_bf16 v[224:227], a[80:83], a[188:191], v[224:227]
v_fmac_f32 v146, s60, v90
v_fmac_f32 v147, s60, v91
v_mfma_f32_16x16x32_bf16 v[232:235], a[80:83], a[192:195], v[232:235]
v_fma_f32 v11, s62, v34, v10
v_fma_f32 v14, s62, v35, v13
v_mfma_f32_16x16x32_bf16 v[232:235], a[84:87], a[196:199], v[232:235]
v_fma_f32 v12, s64, v34, v10
v_fma_f32 v15, s64, v35, v13
v_mfma_f32_16x16x32_bf16 v[232:235], a[88:91], a[200:203], v[232:235]
global_load_dwordx4 a[72:75], v3, s[20:21] offset:0
v_fmac_f32 v11, s63, v90
v_mfma_f32_16x16x32_bf16 v[236:239], a[100:103], a[200:203], v[236:239]
ds_read_b128 a[188:191], v1 offset:3232
v_fmac_f32 v14, s63, v91
v_mfma_f32_16x16x32_bf16 v[236:239], a[96:99], a[196:199], v[236:239]
v_fma_f32 v34, s65, v34, v10
v_fma_f32 v35, s65, v35, v13
v_mfma_f32_16x16x32_bf16 v[236:239], a[92:95], a[192:195], v[236:239]
v_accvgpr_write_b32 a2, v11
v_accvgpr_write_b32 a3, v14
v_mfma_f32_16x16x32_bf16 v[244:247], a[92:95], a[196:199], v[244:247]
s_add_u32 m0, s23, 67648
v_fmac_f32 v34, s66, v90
v_fmac_f32 v35, s66, v91
v_mfma_f32_16x16x32_bf16 v[244:247], a[96:99], a[200:203], v[244:247]
buffer_load_dwordx4 v4, s[8:11], s12 offen offset:2048 lds
v_mfma_f32_16x16x32_bf16 v[244:247], a[100:103], a[204:207], v[244:247]
v_fma_f32 v90, s67, v90, v12
v_fma_f32 v91, s67, v91, v15
v_mfma_f32_16x16x32_bf16 v[240:243], a[88:91], a[204:207], v[240:243]
ds_read_b128 a[192:195], v1 offset:4288
v_accvgpr_read_b32 v10, a4
v_mfma_f32_16x16x32_bf16 v[240:243], a[84:87], a[200:203], v[240:243]
global_load_dwordx4 a[76:79], v3, s[20:21] offset:1024
v_accvgpr_read_b32 v13, a5
v_mfma_f32_16x16x32_bf16 v[240:243], a[80:83], a[196:199], v[240:243]
v_fmac_f32 v148, s60, v92
v_fmac_f32 v149, s60, v93
v_mfma_f32_16x16x32_bf16 v[248:251], a[80:83], a[200:203], v[248:251]
v_fma_f32 v11, s62, v36, v10
v_fma_f32 v14, s62, v37, v13
v_mfma_f32_16x16x32_bf16 v[248:251], a[84:87], a[204:207], v[248:251]
s_waitcnt lgkmcnt(1)
v_fma_f32 v12, s64, v36, v10
v_fma_f32 v15, s64, v37, v13
v_mfma_f32_16x16x32_bf16 v[248:251], a[88:91], a[208:211], v[248:251]
v_fmac_f32 v11, s63, v92
v_fmac_f32 v14, s63, v93
v_mfma_f32_16x16x32_bf16 v[252:255], a[100:103], a[208:211], v[252:255]
ds_read_b128 a[196:199], v1 offset:5344
v_fma_f32 v36, s65, v36, v10
v_mfma_f32_16x16x32_bf16 v[252:255], a[96:99], a[204:207], v[252:255]
v_fma_f32 v37, s65, v37, v13
v_accvgpr_write_b32 a4, v11
v_mfma_f32_16x16x32_bf16 v[252:255], a[92:95], a[200:203], v[252:255]
s_waitcnt vmcnt(22)
v_accvgpr_write_b32 a5, v14
v_fmac_f32 v36, s66, v92
v_mfma_f32_16x16x32_bf16 v[200:203], a[104:107], a[176:179], v[200:203]
s_waitcnt vmcnt(18)
v_fmac_f32 v37, s66, v93
v_fma_f32 v92, s67, v92, v12
v_mfma_f32_16x16x32_bf16 v[200:203], a[108:111], a[180:183], v[200:203]
global_load_dwordx4 a[80:83], v3, s[20:21] offset:2048
v_fma_f32 v93, s67, v93, v15
v_mfma_f32_16x16x32_bf16 v[200:203], a[112:115], a[184:187], v[200:203]
ds_read_b128 a[200:203], v1 offset:6400
v_accvgpr_read_b32 v10, a6
v_mfma_f32_16x16x32_bf16 v[204:207], a[124:127], a[184:187], v[204:207]
v_accvgpr_read_b32 v13, a7
v_fmac_f32 v150, s60, v94
v_mfma_f32_16x16x32_bf16 v[204:207], a[120:123], a[180:183], v[204:207]
s_add_u32 m0, s23, 67680
v_fmac_f32 v151, s60, v95
v_fma_f32 v11, s62, v38, v10
v_mfma_f32_16x16x32_bf16 v[204:207], a[116:119], a[176:179], v[204:207]
buffer_load_dwordx4 v4, s[8:11], s12 offen offset:3072 lds
v_mfma_f32_16x16x32_bf16 v[212:215], a[116:119], a[180:183], v[212:215]
v_fma_f32 v14, s62, v39, v13
v_fma_f32 v12, s64, v38, v10
v_mfma_f32_16x16x32_bf16 v[212:215], a[120:123], a[184:187], v[212:215]
ds_read_b128 a[204:207], v1 offset:7456
v_fma_f32 v15, s64, v39, v13
v_fmac_f32 v11, s63, v94
v_mfma_f32_16x16x32_bf16 v[212:215], a[124:127], a[188:191], v[212:215]
global_load_dwordx4 a[84:87], v3, s[20:21] offset:3072
v_fmac_f32 v14, s63, v95
v_mfma_f32_16x16x32_bf16 v[208:211], a[112:115], a[188:191], v[208:211]
ds_read_b128 a[176:179], v1 offset:96
v_fma_f32 v38, s65, v38, v10
v_mfma_f32_16x16x32_bf16 v[208:211], a[108:111], a[184:187], v[208:211]
v_fma_f32 v39, s65, v39, v13
v_accvgpr_write_b32 a6, v11
v_mfma_f32_16x16x32_bf16 v[208:211], a[104:107], a[180:183], v[208:211]
v_accvgpr_write_b32 a7, v14
v_fmac_f32 v38, s66, v94
v_mfma_f32_16x16x32_bf16 v[216:219], a[104:107], a[184:187], v[216:219]
s_waitcnt lgkmcnt(2)
v_fmac_f32 v39, s66, v95
v_fma_f32 v94, s67, v94, v12
v_mfma_f32_16x16x32_bf16 v[216:219], a[108:111], a[188:191], v[216:219]
s_add_u32 s20, s20, 8192
s_addc_u32 s21, s21, 0
v_fma_f32 v95, s67, v95, v15
v_mfma_f32_16x16x32_bf16 v[216:219], a[112:115], a[192:195], v[216:219]
ds_read_b128 a[208:211], v1 offset:8512
v_accvgpr_read_b32 v10, a8
v_accvgpr_read_b32 v13, a9
v_mfma_f32_16x16x32_bf16 v[220:223], a[124:127], a[192:195], v[220:223]
global_load_dwordx4 a[88:91], v3, s[20:21] offset:-4096
v_fmac_f32 v152, s60, v96
v_mfma_f32_16x16x32_bf16 v[220:223], a[120:123], a[188:191], v[220:223]
ds_read_b128 a[180:183], v1 offset:1152
v_fmac_f32 v153, s60, v97
v_mfma_f32_16x16x32_bf16 v[220:223], a[116:119], a[184:187], v[220:223]
v_fma_f32 v11, s62, v40, v10
v_fma_f32 v14, s62, v41, v13
v_mfma_f32_16x16x32_bf16 v[228:231], a[116:119], a[188:191], v[228:231]
v_fma_f32 v12, s64, v40, v10
v_fma_f32 v15, s64, v41, v13
v_mfma_f32_16x16x32_bf16 v[228:231], a[120:123], a[192:195], v[228:231]
v_fmac_f32 v11, s63, v96
v_fmac_f32 v14, s63, v97
v_mfma_f32_16x16x32_bf16 v[228:231], a[124:127], a[196:199], v[228:231]
s_add_u32 m0, s23, 71808
v_fma_f32 v40, s65, v40, v10
v_fma_f32 v41, s65, v41, v13
v_mfma_f32_16x16x32_bf16 v[224:227], a[112:115], a[196:199], v[224:227]
global_load_dwordx4 a[92:95], v3, s[20:21] offset:-3072
v_accvgpr_write_b32 a8, v11
v_mfma_f32_16x16x32_bf16 v[224:227], a[108:111], a[192:195], v[224:227]
ds_read_b128 a[184:187], v1 offset:2208
v_accvgpr_write_b32 a9, v14
v_mfma_f32_16x16x32_bf16 v[224:227], a[104:107], a[188:191], v[224:227]
v_fmac_f32 v40, s66, v96
v_fmac_f32 v41, s66, v97
v_mfma_f32_16x16x32_bf16 v[232:235], a[104:107], a[192:195], v[232:235]
buffer_load_dwordx4 v4, s[8:11], s13 offen offset:0 lds
v_mfma_f32_16x16x32_bf16 v[232:235], a[108:111], a[196:199], v[232:235]
v_fma_f32 v96, s67, v96, v12
v_fma_f32 v97, s67, v97, v15
v_mfma_f32_16x16x32_bf16 v[232:235], a[112:115], a[200:203], v[232:235]
v_accvgpr_read_b32 v10, a10
v_accvgpr_read_b32 v13, a11
v_fmac_f32 v154, s60, v98
v_mfma_f32_16x16x32_bf16 v[236:239], a[124:127], a[200:203], v[236:239]
global_load_dwordx4 a[96:99], v3, s[20:21] offset:-2048
v_fmac_f32 v155, s60, v99
v_mfma_f32_16x16x32_bf16 v[236:239], a[120:123], a[196:199], v[236:239]
ds_read_b128 a[188:191], v1 offset:3264
v_fma_f32 v11, s62, v42, v10
v_mfma_f32_16x16x32_bf16 v[236:239], a[116:119], a[192:195], v[236:239]
v_fma_f32 v14, s62, v43, v13
v_fma_f32 v12, s64, v42, v10
v_mfma_f32_16x16x32_bf16 v[244:247], a[116:119], a[196:199], v[244:247]
v_fma_f32 v15, s64, v43, v13
v_fmac_f32 v11, s63, v98
v_mfma_f32_16x16x32_bf16 v[244:247], a[120:123], a[200:203], v[244:247]
s_waitcnt lgkmcnt(2)
v_fmac_f32 v14, s63, v99
v_fma_f32 v42, s65, v42, v10
v_mfma_f32_16x16x32_bf16 v[244:247], a[124:127], a[204:207], v[244:247]
global_load_dwordx4 a[100:103], v3, s[20:21] offset:-1024
v_fma_f32 v43, s65, v43, v13
v_mfma_f32_16x16x32_bf16 v[240:243], a[112:115], a[204:207], v[240:243]
ds_read_b128 a[192:195], v1 offset:4320
v_accvgpr_write_b32 a10, v11
v_mfma_f32_16x16x32_bf16 v[240:243], a[108:111], a[200:203], v[240:243]
v_accvgpr_write_b32 a11, v14
v_fmac_f32 v42, s66, v98
v_mfma_f32_16x16x32_bf16 v[240:243], a[104:107], a[196:199], v[240:243]
v_fmac_f32 v43, s66, v99
v_fma_f32 v98, s67, v98, v12
v_mfma_f32_16x16x32_bf16 v[248:251], a[104:107], a[200:203], v[248:251]
s_add_u32 m0, s23, 71840
v_fma_f32 v99, s67, v99, v15
v_accvgpr_read_b32 v10, a12
v_mfma_f32_16x16x32_bf16 v[248:251], a[108:111], a[204:207], v[248:251]
buffer_load_dwordx4 v4, s[8:11], s13 offen offset:1024 lds
v_mfma_f32_16x16x32_bf16 v[248:251], a[112:115], a[208:211], v[248:251]
v_accvgpr_read_b32 v13, a13
v_fmac_f32 v156, s60, v100
v_mfma_f32_16x16x32_bf16 v[252:255], a[124:127], a[208:211], v[252:255]
ds_read_b128 a[196:199], v1 offset:5376
v_fmac_f32 v157, s60, v101
v_mfma_f32_16x16x32_bf16 v[252:255], a[120:123], a[204:207], v[252:255]
v_fma_f32 v11, s62, v44, v10
v_fma_f32 v14, s62, v45, v13
v_mfma_f32_16x16x32_bf16 v[252:255], a[116:119], a[200:203], v[252:255]
s_waitcnt vmcnt(22)
v_fma_f32 v12, s64, v44, v10
v_fma_f32 v15, s64, v45, v13
v_mfma_f32_16x16x32_bf16 v[200:203], a[128:131], a[176:179], v[200:203]
s_waitcnt lgkmcnt(2) vmcnt(18)
v_fmac_f32 v11, s63, v100
v_fmac_f32 v14, s63, v101
v_mfma_f32_16x16x32_bf16 v[200:203], a[132:135], a[180:183], v[200:203]
global_load_dwordx4 a[104:107], v3, s[20:21] offset:0
v_fma_f32 v44, s65, v44, v10
v_mfma_f32_16x16x32_bf16 v[200:203], a[136:139], a[184:187], v[200:203]
ds_read_b128 a[200:203], v1 offset:6432
v_fma_f32 v45, s65, v45, v13
v_mfma_f32_16x16x32_bf16 v[204:207], a[148:151], a[184:187], v[204:207]
v_accvgpr_write_b32 a12, v11
v_accvgpr_write_b32 a13, v14
v_mfma_f32_16x16x32_bf16 v[204:207], a[144:147], a[180:183], v[204:207]
v_fmac_f32 v44, s66, v100
v_fmac_f32 v45, s66, v101
v_mfma_f32_16x16x32_bf16 v[204:207], a[140:143], a[176:179], v[204:207]
v_fma_f32 v100, s67, v100, v12
v_fma_f32 v101, s67, v101, v15
v_mfma_f32_16x16x32_bf16 v[212:215], a[140:143], a[180:183], v[212:215]
v_accvgpr_read_b32 v10, a14
v_accvgpr_read_b32 v13, a15
v_mfma_f32_16x16x32_bf16 v[212:215], a[144:147], a[184:187], v[212:215]
global_load_dwordx4 a[108:111], v3, s[20:21] offset:1024
v_fmac_f32 v158, s60, v102
v_mfma_f32_16x16x32_bf16 v[212:215], a[148:151], a[188:191], v[212:215]
ds_read_b128 a[204:207], v1 offset:7488
v_fmac_f32 v159, s60, v103
v_mfma_f32_16x16x32_bf16 v[208:211], a[136:139], a[188:191], v[208:211]
ds_read_b128 a[176:179], v1 offset:128
v_fma_f32 v11, s62, v46, v10
v_mfma_f32_16x16x32_bf16 v[208:211], a[132:135], a[184:187], v[208:211]
s_add_u32 m0, s23, 71872
v_fma_f32 v14, s62, v47, v13
v_fma_f32 v12, s64, v46, v10
v_mfma_f32_16x16x32_bf16 v[208:211], a[128:131], a[180:183], v[208:211]
buffer_load_dwordx4 v4, s[8:11], s13 offen offset:2048 lds
v_mfma_f32_16x16x32_bf16 v[216:219], a[128:131], a[184:187], v[216:219]
s_waitcnt lgkmcnt(2)
v_fma_f32 v15, s64, v47, v13
v_fmac_f32 v11, s63, v102
v_fmac_f32 v14, s63, v103
v_mfma_f32_16x16x32_bf16 v[216:219], a[132:135], a[188:191], v[216:219]
ds_read_b128 a[208:211], v1 offset:8544
v_fma_f32 v46, s65, v46, v10
v_mfma_f32_16x16x32_bf16 v[216:219], a[136:139], a[192:195], v[216:219]
global_load_dwordx4 a[112:115], v3, s[20:21] offset:2048
v_fma_f32 v47, s65, v47, v13
v_mfma_f32_16x16x32_bf16 v[220:223], a[148:151], a[192:195], v[220:223]
ds_read_b128 a[180:183], v1 offset:1184
v_accvgpr_write_b32 a14, v11
v_mfma_f32_16x16x32_bf16 v[220:223], a[144:147], a[188:191], v[220:223]
v_accvgpr_write_b32 a15, v14
v_fmac_f32 v46, s66, v102
v_mfma_f32_16x16x32_bf16 v[220:223], a[140:143], a[184:187], v[220:223]
v_fmac_f32 v47, s66, v103
v_fma_f32 v102, s67, v102, v12
v_mfma_f32_16x16x32_bf16 v[228:231], a[140:143], a[188:191], v[228:231]
v_fma_f32 v103, s67, v103, v15
v_accvgpr_read_b32 v10, a16
v_mfma_f32_16x16x32_bf16 v[228:231], a[144:147], a[192:195], v[228:231]
v_accvgpr_read_b32 v13, a17
v_fmac_f32 v160, s60, v104
v_mfma_f32_16x16x32_bf16 v[228:231], a[148:151], a[196:199], v[228:231]
global_load_dwordx4 a[116:119], v3, s[20:21] offset:3072
v_fmac_f32 v161, s60, v105
v_mfma_f32_16x16x32_bf16 v[224:227], a[136:139], a[196:199], v[224:227]
ds_read_b128 a[184:187], v1 offset:2240
v_fma_f32 v11, s62, v48, v10
v_mfma_f32_16x16x32_bf16 v[224:227], a[132:135], a[192:195], v[224:227]
v_fma_f32 v14, s62, v49, v13
v_fma_f32 v12, s64, v48, v10
v_mfma_f32_16x16x32_bf16 v[224:227], a[128:131], a[188:191], v[224:227]
v_fma_f32 v15, s64, v49, v13
v_fmac_f32 v11, s63, v104
v_mfma_f32_16x16x32_bf16 v[232:235], a[128:131], a[192:195], v[232:235]
v_fmac_f32 v14, s63, v105
v_fma_f32 v48, s65, v48, v10
v_mfma_f32_16x16x32_bf16 v[232:235], a[132:135], a[196:199], v[232:235]
v_fma_f32 v49, s65, v49, v13
v_accvgpr_write_b32 a16, v11
v_mfma_f32_16x16x32_bf16 v[232:235], a[136:139], a[200:203], v[232:235]
s_add_u32 m0, s23, 71904
v_accvgpr_write_b32 a17, v14
v_fmac_f32 v48, s66, v104
v_mfma_f32_16x16x32_bf16 v[236:239], a[148:151], a[200:203], v[236:239]
s_add_u32 s20, s20, 8192
s_addc_u32 s21, s21, 0
v_fmac_f32 v49, s66, v105
v_mfma_f32_16x16x32_bf16 v[236:239], a[144:147], a[196:199], v[236:239]
buffer_load_dwordx4 v4, s[8:11], s13 offen offset:3072 lds
v_fma_f32 v104, s67, v104, v12
v_mfma_f32_16x16x32_bf16 v[236:239], a[140:143], a[192:195], v[236:239]
ds_read_b128 a[188:191], v1 offset:3296
v_fma_f32 v105, s67, v105, v15
v_mfma_f32_16x16x32_bf16 v[244:247], a[140:143], a[196:199], v[244:247]
s_waitcnt lgkmcnt(2)
v_accvgpr_read_b32 v10, a18
v_accvgpr_read_b32 v13, a19
v_mfma_f32_16x16x32_bf16 v[244:247], a[144:147], a[200:203], v[244:247]
global_load_dwordx4 a[120:123], v3, s[20:21] offset:-4096
v_fmac_f32 v162, s60, v106
v_mfma_f32_16x16x32_bf16 v[244:247], a[148:151], a[204:207], v[244:247]
v_fmac_f32 v163, s60, v107
v_fma_f32 v11, s62, v50, v10
v_fma_f32 v14, s62, v51, v13
v_mfma_f32_16x16x32_bf16 v[240:243], a[136:139], a[204:207], v[240:243]
ds_read_b128 a[192:195], v1 offset:4352
v_fma_f32 v12, s64, v50, v10
v_mfma_f32_16x16x32_bf16 v[240:243], a[132:135], a[200:203], v[240:243]
global_load_dwordx4 a[124:127], v3, s[20:21] offset:-3072
v_fma_f32 v15, s64, v51, v13
v_mfma_f32_16x16x32_bf16 v[240:243], a[128:131], a[196:199], v[240:243]
v_fmac_f32 v11, s63, v106
v_fmac_f32 v14, s63, v107
v_mfma_f32_16x16x32_bf16 v[248:251], a[128:131], a[200:203], v[248:251]
v_fma_f32 v50, s65, v50, v10
v_fma_f32 v51, s65, v51, v13
v_mfma_f32_16x16x32_bf16 v[248:251], a[132:135], a[204:207], v[248:251]
v_accvgpr_write_b32 a18, v11
v_accvgpr_write_b32 a19, v14
v_mfma_f32_16x16x32_bf16 v[248:251], a[136:139], a[208:211], v[248:251]
v_fmac_f32 v50, s66, v106
v_fmac_f32 v51, s66, v107
v_mfma_f32_16x16x32_bf16 v[252:255], a[148:151], a[208:211], v[252:255]
ds_read_b128 a[196:199], v1 offset:5408
v_fma_f32 v106, s67, v106, v12
v_mfma_f32_16x16x32_bf16 v[252:255], a[144:147], a[204:207], v[252:255]
v_fma_f32 v107, s67, v107, v15
v_accvgpr_read_b32 v10, a20
v_mfma_f32_16x16x32_bf16 v[252:255], a[140:143], a[200:203], v[252:255]
s_waitcnt vmcnt(22)
v_accvgpr_read_b32 v13, a21
v_fmac_f32 v164, s60, v108
v_mfma_f32_16x16x32_bf16 v[200:203], a[56:59], a[176:179], v[200:203]
s_add_u32 m0, s23, 76032
v_fmac_f32 v165, s60, v109
v_fma_f32 v11, s62, v52, v10
v_mfma_f32_16x16x32_bf16 v[200:203], a[60:63], a[180:183], v[200:203]
s_waitcnt lgkmcnt(1) vmcnt(17)
buffer_load_dwordx4 v4, s[8:11], s14 offen offset:0 lds
v_mfma_f32_16x16x32_bf16 v[200:203], a[64:67], a[184:187], v[200:203]
ds_read_b128 a[200:203], v1 offset:6464
v_fma_f32 v14, s62, v53, v13
v_fma_f32 v12, s64, v52, v10
v_mfma_f32_16x16x32_bf16 v[204:207], a[76:79], a[184:187], v[204:207]
v_fma_f32 v15, s64, v53, v13
v_fmac_f32 v11, s63, v108
v_mfma_f32_16x16x32_bf16 v[204:207], a[72:75], a[180:183], v[204:207]
global_load_dwordx4 a[128:131], v3, s[20:21] offset:-2048
v_fmac_f32 v14, s63, v109
v_mfma_f32_16x16x32_bf16 v[204:207], a[68:71], a[176:179], v[204:207]
v_fma_f32 v52, s65, v52, v10
v_fma_f32 v53, s65, v53, v13
v_mfma_f32_16x16x32_bf16 v[212:215], a[68:71], a[180:183], v[212:215]
v_accvgpr_write_b32 a20, v11
v_accvgpr_write_b32 a21, v14
v_mfma_f32_16x16x32_bf16 v[212:215], a[72:75], a[184:187], v[212:215]
global_load_dwordx4 a[132:135], v3, s[20:21] offset:-1024
v_fmac_f32 v52, s66, v108
v_mfma_f32_16x16x32_bf16 v[212:215], a[76:79], a[188:191], v[212:215]
ds_read_b128 a[204:207], v1 offset:7520
v_fmac_f32 v53, s66, v109
v_mfma_f32_16x16x32_bf16 v[208:211], a[64:67], a[188:191], v[208:211]
L_stub7:
s_cmp_eq_u32 s37, 1
s_cbranch_scc1 L_stub11
ds_read_b128 a[176:179], v1 offset:160
v_fma_f32 v108, s67, v108, v12
v_mfma_f32_16x16x32_bf16 v[208:211], a[60:63], a[184:187], v[208:211]
v_fma_f32 v109, s67, v109, v15
v_accvgpr_read_b32 v10, a22
v_mfma_f32_16x16x32_bf16 v[208:211], a[56:59], a[180:183], v[208:211]
v_accvgpr_read_b32 v13, a23
v_fmac_f32 v166, s60, v110
v_mfma_f32_16x16x32_bf16 v[216:219], a[56:59], a[184:187], v[216:219]
v_fmac_f32 v167, s60, v111
v_fma_f32 v11, s62, v54, v10
v_mfma_f32_16x16x32_bf16 v[216:219], a[60:63], a[188:191], v[216:219]
ds_read_b128 a[208:211], v1 offset:8576
v_fma_f32 v14, s62, v55, v13
v_mfma_f32_16x16x32_bf16 v[216:219], a[64:67], a[192:195], v[216:219]
global_load_dwordx4 a[136:139], v3, s[20:21] offset:0
v_fma_f32 v12, s64, v54, v10
v_mfma_f32_16x16x32_bf16 v[220:223], a[76:79], a[192:195], v[220:223]
ds_read_b128 a[180:183], v1 offset:1216
v_fma_f32 v15, s64, v55, v13
v_mfma_f32_16x16x32_bf16 v[220:223], a[72:75], a[188:191], v[220:223]
s_add_u32 m0, s23, 76064
v_fmac_f32 v11, s63, v110
v_fmac_f32 v14, s63, v111
v_mfma_f32_16x16x32_bf16 v[220:223], a[68:71], a[184:187], v[220:223]
buffer_load_dwordx4 v4, s[8:11], s14 offen offset:1024 lds
v_mfma_f32_16x16x32_bf16 v[228:231], a[68:71], a[188:191], v[228:231]
v_fma_f32 v54, s65, v54, v10
v_fma_f32 v55, s65, v55, v13
v_mfma_f32_16x16x32_bf16 v[228:231], a[72:75], a[192:195], v[228:231]
s_waitcnt lgkmcnt(2)
v_accvgpr_write_b32 a22, v11
v_accvgpr_write_b32 a23, v14
v_mfma_f32_16x16x32_bf16 v[228:231], a[76:79], a[196:199], v[228:231]
global_load_dwordx4 a[140:143], v3, s[20:21] offset:1024
v_fmac_f32 v54, s66, v110
v_fmac_f32 v55, s66, v111
v_mfma_f32_16x16x32_bf16 v[224:227], a[64:67], a[196:199], v[224:227]
ds_read_b128 a[184:187], v1 offset:2272
v_fma_f32 v110, s67, v110, v12
v_mfma_f32_16x16x32_bf16 v[224:227], a[60:63], a[192:195], v[224:227]
v_fma_f32 v111, s67, v111, v15
v_accvgpr_read_b32 v10, a24
v_mfma_f32_16x16x32_bf16 v[224:227], a[56:59], a[188:191], v[224:227]
v_accvgpr_read_b32 v13, a25
v_fmac_f32 v168, s60, v112
v_mfma_f32_16x16x32_bf16 v[232:235], a[56:59], a[192:195], v[232:235]
v_fmac_f32 v169, s60, v113
v_fma_f32 v11, s62, v56, v10
v_mfma_f32_16x16x32_bf16 v[232:235], a[60:63], a[196:199], v[232:235]
v_fma_f32 v14, s62, v57, v13
v_fma_f32 v12, s64, v56, v10
v_mfma_f32_16x16x32_bf16 v[232:235], a[64:67], a[200:203], v[232:235]
global_load_dwordx4 a[144:147], v3, s[20:21] offset:2048
v_fma_f32 v15, s64, v57, v13
v_mfma_f32_16x16x32_bf16 v[236:239], a[76:79], a[200:203], v[236:239]
ds_read_b128 a[188:191], v1 offset:3328
v_fmac_f32 v11, s63, v112
v_mfma_f32_16x16x32_bf16 v[236:239], a[72:75], a[196:199], v[236:239]
v_fmac_f32 v14, s63, v113
v_fma_f32 v56, s65, v56, v10
v_mfma_f32_16x16x32_bf16 v[236:239], a[68:71], a[192:195], v[236:239]
v_fma_f32 v57, s65, v57, v13
v_accvgpr_write_b32 a24, v11
v_mfma_f32_16x16x32_bf16 v[244:247], a[68:71], a[196:199], v[244:247]
v_accvgpr_write_b32 a25, v14
v_fmac_f32 v56, s66, v112
v_mfma_f32_16x16x32_bf16 v[244:247], a[72:75], a[200:203], v[244:247]
v_fmac_f32 v57, s66, v113
v_fma_f32 v112, s67, v112, v12
v_mfma_f32_16x16x32_bf16 v[244:247], a[76:79], a[204:207], v[244:247]
s_add_u32 m0, s23, 76096
v_fma_f32 v113, s67, v113, v15
v_accvgpr_read_b32 v10, a26
v_mfma_f32_16x16x32_bf16 v[240:243], a[64:67], a[204:207], v[240:243]
buffer_load_dwordx4 v4, s[8:11], s14 offen offset:2048 lds
v_mfma_f32_16x16x32_bf16 v[240:243], a[60:63], a[200:203], v[240:243]
ds_read_b128 a[192:195], v1 offset:4384
v_accvgpr_read_b32 v13, a27
v_mfma_f32_16x16x32_bf16 v[240:243], a[56:59], a[196:199], v[240:243]
v_fmac_f32 v170, s60, v114
v_fmac_f32 v171, s60, v115
v_mfma_f32_16x16x32_bf16 v[248:251], a[56:59], a[200:203], v[248:251]
global_load_dwordx4 a[148:151], v3, s[20:21] offset:3072
v_fma_f32 v11, s62, v58, v10
v_mfma_f32_16x16x32_bf16 v[248:251], a[60:63], a[204:207], v[248:251]
s_waitcnt lgkmcnt(1)
v_fma_f32 v14, s62, v59, v13
v_fma_f32 v12, s64, v58, v10
v_mfma_f32_16x16x32_bf16 v[248:251], a[64:67], a[208:211], v[248:251]
v_fma_f32 v15, s64, v59, v13
v_fmac_f32 v11, s63, v114
v_mfma_f32_16x16x32_bf16 v[252:255], a[76:79], a[208:211], v[252:255]
ds_read_b128 a[196:199], v1 offset:5440
v_fmac_f32 v14, s63, v115
v_mfma_f32_16x16x32_bf16 v[252:255], a[72:75], a[204:207], v[252:255]
v_fma_f32 v58, s65, v58, v10
v_fma_f32 v59, s65, v59, v13
v_mfma_f32_16x16x32_bf16 v[252:255], a[68:71], a[200:203], v[252:255]
s_waitcnt vmcnt(22)
v_accvgpr_write_b32 a26, v11
v_accvgpr_write_b32 a27, v14
v_mfma_f32_16x16x32_bf16 v[200:203], a[80:83], a[176:179], v[200:203]
s_waitcnt vmcnt(18)
v_fmac_f32 v58, s66, v114
v_fmac_f32 v59, s66, v115
v_mfma_f32_16x16x32_bf16 v[200:203], a[84:87], a[180:183], v[200:203]
s_add_u32 s20, s20, 8192
s_addc_u32 s21, s21, 0
v_fma_f32 v114, s67, v114, v12
v_mfma_f32_16x16x32_bf16 v[200:203], a[88:91], a[184:187], v[200:203]
global_load_dwordx4 a[56:59], v3, s[20:21] offset:-4096
v_fma_f32 v115, s67, v115, v15
v_accvgpr_read_b32 v10, a28
v_mfma_f32_16x16x32_bf16 v[204:207], a[100:103], a[184:187], v[204:207]
ds_read_b128 a[200:203], v1 offset:6496
v_accvgpr_read_b32 v13, a29
v_mfma_f32_16x16x32_bf16 v[204:207], a[96:99], a[180:183], v[204:207]
v_fmac_f32 v172, s60, v116
v_fmac_f32 v173, s60, v117
v_mfma_f32_16x16x32_bf16 v[204:207], a[92:95], a[176:179], v[204:207]
v_fma_f32 v11, s62, v60, v10
v_fma_f32 v14, s62, v61, v13
v_mfma_f32_16x16x32_bf16 v[212:215], a[92:95], a[180:183], v[212:215]
v_fma_f32 v12, s64, v60, v10
v_fma_f32 v15, s64, v61, v13
v_mfma_f32_16x16x32_bf16 v[212:215], a[96:99], a[184:187], v[212:215]
global_load_dwordx4 a[60:63], v3, s[20:21] offset:-3072
v_fmac_f32 v11, s63, v116
v_mfma_f32_16x16x32_bf16 v[212:215], a[100:103], a[188:191], v[212:215]
ds_read_b128 a[204:207], v1 offset:7552
v_fmac_f32 v14, s63, v117
v_mfma_f32_16x16x32_bf16 v[208:211], a[88:91], a[188:191], v[208:211]
ds_read_b128 a[176:179], v1 offset:192
v_fma_f32 v60, s65, v60, v10
v_mfma_f32_16x16x32_bf16 v[208:211], a[84:87], a[184:187], v[208:211]
v_fma_f32 v61, s65, v61, v13
v_accvgpr_write_b32 a28, v11
v_mfma_f32_16x16x32_bf16 v[208:211], a[80:83], a[180:183], v[208:211]
v_accvgpr_write_b32 a29, v14
v_fmac_f32 v60, s66, v116
v_mfma_f32_16x16x32_bf16 v[216:219], a[80:83], a[184:187], v[216:219]
s_waitcnt lgkmcnt(3)
v_fmac_f32 v61, s66, v117
v_fma_f32 v116, s67, v116, v12
v_mfma_f32_16x16x32_bf16 v[216:219], a[84:87], a[188:191], v[216:219]
ds_read_b128 a[208:211], v1 offset:8608
v_fma_f32 v117, s67, v117, v15
v_mfma_f32_16x16x32_bf16 v[216:219], a[88:91], a[192:195], v[216:219]
global_load_dwordx4 a[64:67], v3, s[20:21] offset:-2048
v_accvgpr_read_b32 v10, a30
v_mfma_f32_16x16x32_bf16 v[220:223], a[100:103], a[192:195], v[220:223]
ds_read_b128 a[180:183], v1 offset:1248
v_accvgpr_read_b32 v13, a31
v_mfma_f32_16x16x32_bf16 v[220:223], a[96:99], a[188:191], v[220:223]
v_fmac_f32 v174, s60, v118
v_fmac_f32 v175, s60, v119
v_mfma_f32_16x16x32_bf16 v[220:223], a[92:95], a[184:187], v[220:223]
v_fma_f32 v11, s62, v62, v10
v_fma_f32 v14, s62, v63, v13
v_mfma_f32_16x16x32_bf16 v[228:231], a[92:95], a[188:191], v[228:231]
v_fma_f32 v12, s64, v62, v10
v_fma_f32 v15, s64, v63, v13
v_mfma_f32_16x16x32_bf16 v[228:231], a[96:99], a[192:195], v[228:231]
v_fmac_f32 v11, s63, v118
v_fmac_f32 v14, s63, v119
v_mfma_f32_16x16x32_bf16 v[228:231], a[100:103], a[196:199], v[228:231]
global_load_dwordx4 a[68:71], v3, s[20:21] offset:-1024
v_fma_f32 v62, s65, v62, v10
v_mfma_f32_16x16x32_bf16 v[224:227], a[88:91], a[196:199], v[224:227]
ds_read_b128 a[184:187], v1 offset:2304
v_fma_f32 v63, s65, v63, v13
v_mfma_f32_16x16x32_bf16 v[224:227], a[84:87], a[192:195], v[224:227]
v_accvgpr_write_b32 a30, v11
v_accvgpr_write_b32 a31, v14
v_mfma_f32_16x16x32_bf16 v[224:227], a[80:83], a[188:191], v[224:227]
v_fmac_f32 v62, s66, v118
v_fmac_f32 v63, s66, v119
v_mfma_f32_16x16x32_bf16 v[232:235], a[80:83], a[192:195], v[232:235]
v_fma_f32 v118, s67, v118, v12
v_fma_f32 v119, s67, v119, v15
v_mfma_f32_16x16x32_bf16 v[232:235], a[84:87], a[196:199], v[232:235]
s_waitcnt lgkmcnt(1)
v_accvgpr_read_b32 v10, a32
v_accvgpr_read_b32 v13, a33
v_mfma_f32_16x16x32_bf16 v[232:235], a[88:91], a[200:203], v[232:235]
global_load_dwordx4 a[72:75], v3, s[20:21] offset:0
v_fmac_f32 v176, s60, v120
v_mfma_f32_16x16x32_bf16 v[236:239], a[100:103], a[200:203], v[236:239]
ds_read_b128 a[188:191], v1 offset:3360
v_fmac_f32 v177, s60, v121
v_mfma_f32_16x16x32_bf16 v[236:239], a[96:99], a[196:199], v[236:239]
v_fma_f32 v11, s62, v64, v10
v_fma_f32 v14, s62, v65, v13
v_mfma_f32_16x16x32_bf16 v[236:239], a[92:95], a[192:195], v[236:239]
v_fma_f32 v12, s64, v64, v10
v_fma_f32 v15, s64, v65, v13
v_mfma_f32_16x16x32_bf16 v[244:247], a[92:95], a[196:199], v[244:247]
v_fmac_f32 v11, s63, v120
v_fmac_f32 v14, s63, v121
v_mfma_f32_16x16x32_bf16 v[244:247], a[96:99], a[200:203], v[244:247]
v_fma_f32 v64, s65, v64, v10
v_fma_f32 v65, s65, v65, v13
v_mfma_f32_16x16x32_bf16 v[244:247], a[100:103], a[204:207], v[244:247]
global_load_dwordx4 a[76:79], v3, s[20:21] offset:1024
v_accvgpr_write_b32 a32, v11
v_mfma_f32_16x16x32_bf16 v[240:243], a[88:91], a[204:207], v[240:243]
ds_read_b128 a[192:195], v1 offset:4416
v_accvgpr_write_b32 a33, v14
v_mfma_f32_16x16x32_bf16 v[240:243], a[84:87], a[200:203], v[240:243]
v_fmac_f32 v64, s66, v120
v_fmac_f32 v65, s66, v121
v_mfma_f32_16x16x32_bf16 v[240:243], a[80:83], a[196:199], v[240:243]
v_fma_f32 v120, s67, v120, v12
v_fma_f32 v121, s67, v121, v15
v_mfma_f32_16x16x32_bf16 v[248:251], a[80:83], a[200:203], v[248:251]
v_accvgpr_read_b32 v10, a34
v_accvgpr_read_b32 v13, a35
v_mfma_f32_16x16x32_bf16 v[248:251], a[84:87], a[204:207], v[248:251]
v_fmac_f32 v178, s60, v122
v_fmac_f32 v179, s60, v123
v_mfma_f32_16x16x32_bf16 v[248:251], a[88:91], a[208:211], v[248:251]
v_fma_f32 v11, s62, v66, v10
v_fma_f32 v14, s62, v67, v13
v_mfma_f32_16x16x32_bf16 v[252:255], a[100:103], a[208:211], v[252:255]
ds_read_b128 a[196:199], v1 offset:5472
v_fma_f32 v12, s64, v66, v10
v_mfma_f32_16x16x32_bf16 v[252:255], a[96:99], a[204:207], v[252:255]
v_fma_f32 v15, s64, v67, v13
v_fmac_f32 v11, s63, v122
v_mfma_f32_16x16x32_bf16 v[252:255], a[92:95], a[200:203], v[252:255]
s_waitcnt vmcnt(15) lgkmcnt(2)
v_fmac_f32 v14, s63, v123
v_fma_f32 v66, s65, v66, v10
v_mfma_f32_16x16x32_bf16 v[200:203], a[104:107], a[176:179], v[200:203]
s_mov_b32 s36, L_h8-L_pc
v_fma_f32 v67, s65, v67, v13
v_accvgpr_write_b32 a34, v11
v_mfma_f32_16x16x32_bf16 v[200:203], a[108:111], a[180:183], v[200:203]
s_mov_b32 s30, L_h9+128-L_pc
v_accvgpr_write_b32 a35, v14
v_fmac_f32 v66, s66, v122
v_mfma_f32_16x16x32_bf16 v[200:203], a[112:115], a[184:187], v[200:203]
global_load_dwordx4 a[80:83], v3, s[20:21] offset:2048
v_fmac_f32 v67, s66, v123
v_mfma_f32_16x16x32_bf16 v[204:207], a[124:127], a[184:187], v[204:207]
ds_read_b128 a[200:203], v1 offset:6528
v_fma_f32 v122, s67, v122, v12
v_mfma_f32_16x16x32_bf16 v[204:207], a[120:123], a[180:183], v[204:207]
v_fma_f32 v123, s67, v123, v15
v_accvgpr_read_b32 v10, a36
v_mfma_f32_16x16x32_bf16 v[204:207], a[116:119], a[176:179], v[204:207]
buffer_load_dword a252, v8, s[28:31], s36 offen
v_mfma_f32_16x16x32_bf16 v[212:215], a[116:119], a[180:183], v[212:215]
v_accvgpr_read_b32 v13, a37
v_fmac_f32 v180, s60, v124
v_fmac_f32 v181, s60, v125
v_mfma_f32_16x16x32_bf16 v[212:215], a[120:123], a[184:187], v[212:215]
ds_read_b128 a[204:207], v1 offset:7584
v_fma_f32 v11, s62, v68, v10
v_fma_f32 v14, s62, v69, v13
v_mfma_f32_16x16x32_bf16 v[212:215], a[124:127], a[188:191], v[212:215]
global_load_dwordx4 a[84:87], v3, s[20:21] offset:3072
v_fma_f32 v12, s64, v68, v10
v_mfma_f32_16x16x32_bf16 v[208:211], a[112:115], a[188:191], v[208:211]
ds_read_b128 a[176:179], v1 offset:224
v_fma_f32 v15, s64, v69, v13
v_mfma_f32_16x16x32_bf16 v[208:211], a[108:111], a[184:187], v[208:211]
v_fmac_f32 v11, s63, v124
v_fmac_f32 v14, s63, v125
v_mfma_f32_16x16x32_bf16 v[208:211], a[104:107], a[180:183], v[208:211]
v_fma_f32 v68, s65, v68, v10
v_fma_f32 v69, s65, v69, v13
v_mfma_f32_16x16x32_bf16 v[216:219], a[104:107], a[184:187], v[216:219]
s_waitcnt lgkmcnt(3)
v_accvgpr_write_b32 a36, v11
v_accvgpr_write_b32 a37, v14
v_mfma_f32_16x16x32_bf16 v[216:219], a[108:111], a[188:191], v[216:219]
s_add_u32 s20, s20, 8192
s_addc_u32 s21, s21, 0
v_fmac_f32 v68, s66, v124
v_mfma_f32_16x16x32_bf16 v[216:219], a[112:115], a[192:195], v[216:219]
ds_read_b128 a[208:211], v1 offset:8640
v_fmac_f32 v69, s66, v125
v_mfma_f32_16x16x32_bf16 v[220:223], a[124:127], a[192:195], v[220:223]
global_load_dwordx4 a[88:91], v3, s[20:21] offset:-4096
v_fma_f32 v124, s67, v124, v12
v_mfma_f32_16x16x32_bf16 v[220:223], a[120:123], a[188:191], v[220:223]
ds_read_b128 a[180:183], v1 offset:1280
v_fma_f32 v125, s67, v125, v15
v_mfma_f32_16x16x32_bf16 v[220:223], a[116:119], a[184:187], v[220:223]
v_accvgpr_read_b32 v10, a38
v_accvgpr_read_b32 v13, a39
v_mfma_f32_16x16x32_bf16 v[228:231], a[116:119], a[188:191], v[228:231]
v_fmac_f32 v182, s60, v126
v_fmac_f32 v183, s60, v127
v_mfma_f32_16x16x32_bf16 v[228:231], a[120:123], a[192:195], v[228:231]
v_fma_f32 v11, s62, v70, v10
v_fma_f32 v14, s62, v71, v13
v_mfma_f32_16x16x32_bf16 v[228:231], a[124:127], a[196:199], v[228:231]
global_load_dwordx4 a[92:95], v3, s[20:21] offset:-3072
v_fma_f32 v12, s64, v70, v10
v_mfma_f32_16x16x32_bf16 v[224:227], a[112:115], a[196:199], v[224:227]
ds_read_b128 a[184:187], v1 offset:2336
v_fma_f32 v15, s64, v71, v13
v_mfma_f32_16x16x32_bf16 v[224:227], a[108:111], a[192:195], v[224:227]
v_fmac_f32 v11, s63, v126
v_fmac_f32 v14, s63, v127
v_mfma_f32_16x16x32_bf16 v[224:227], a[104:107], a[188:191], v[224:227]
v_fma_f32 v70, s65, v70, v10
v_fma_f32 v71, s65, v71, v13
v_mfma_f32_16x16x32_bf16 v[232:235], a[104:107], a[192:195], v[232:235]
v_accvgpr_write_b32 a38, v11
v_accvgpr_write_b32 a39, v14
v_mfma_f32_16x16x32_bf16 v[232:235], a[108:111], a[196:199], v[232:235]
s_waitcnt lgkmcnt(2)
v_fmac_f32 v70, s66, v126
v_fmac_f32 v71, s66, v127
v_mfma_f32_16x16x32_bf16 v[232:235], a[112:115], a[200:203], v[232:235]
global_load_dwordx4 a[96:99], v3, s[20:21] offset:-2048
v_fma_f32 v126, s67, v126, v12
v_mfma_f32_16x16x32_bf16 v[236:239], a[124:127], a[200:203], v[236:239]
ds_read_b128 a[188:191], v1 offset:3392
v_fma_f32 v127, s67, v127, v15
v_mfma_f32_16x16x32_bf16 v[236:239], a[120:123], a[196:199], v[236:239]
v_accvgpr_read_b32 v10, a40
v_accvgpr_read_b32 v13, a41
v_mfma_f32_16x16x32_bf16 v[236:239], a[116:119], a[192:195], v[236:239]
v_fmac_f32 v184, s60, v128
v_fmac_f32 v185, s60, v129
v_mfma_f32_16x16x32_bf16 v[244:247], a[116:119], a[196:199], v[244:247]
v_fma_f32 v11, s62, v72, v10
v_fma_f32 v14, s62, v73, v13
v_mfma_f32_16x16x32_bf16 v[244:247], a[120:123], a[200:203], v[244:247]
v_fma_f32 v12, s64, v72, v10
v_fma_f32 v15, s64, v73, v13
v_mfma_f32_16x16x32_bf16 v[244:247], a[124:127], a[204:207], v[244:247]
global_load_dwordx4 a[100:103], v3, s[20:21] offset:-1024
v_fmac_f32 v11, s63, v128
v_mfma_f32_16x16x32_bf16 v[240:243], a[112:115], a[204:207], v[240:243]
ds_read_b128 a[192:195], v1 offset:4448
v_fmac_f32 v14, s63, v129
v_mfma_f32_16x16x32_bf16 v[240:243], a[108:111], a[200:203], v[240:243]
v_fma_f32 v72, s65, v72, v10
v_fma_f32 v73, s65, v73, v13
v_mfma_f32_16x16x32_bf16 v[240:243], a[104:107], a[196:199], v[240:243]
v_accvgpr_write_b32 a40, v11
v_accvgpr_write_b32 a41, v14
v_mfma_f32_16x16x32_bf16 v[248:251], a[104:107], a[200:203], v[248:251]
v_fmac_f32 v72, s66, v128
v_fmac_f32 v73, s66, v129
v_mfma_f32_16x16x32_bf16 v[248:251], a[108:111], a[204:207], v[248:251]
v_fma_f32 v128, s67, v128, v12
v_fma_f32 v129, s67, v129, v15
v_mfma_f32_16x16x32_bf16 v[248:251], a[112:115], a[208:211], v[248:251]
v_accvgpr_read_b32 v10, a42
v_accvgpr_read_b32 v13, a43
v_mfma_f32_16x16x32_bf16 v[252:255], a[124:127], a[208:211], v[252:255]
ds_read_b128 a[196:199], v1 offset:5504
v_fmac_f32 v186, s60, v130
v_mfma_f32_16x16x32_bf16 v[252:255], a[120:123], a[204:207], v[252:255]
v_fmac_f32 v187, s60, v131
v_fma_f32 v11, s62, v74, v10
v_mfma_f32_16x16x32_bf16 v[252:255], a[116:119], a[200:203], v[252:255]
s_waitcnt vmcnt(13) lgkmcnt(2)
v_fma_f32 v14, s62, v75, v13
v_fma_f32 v12, s64, v74, v10
v_mfma_f32_16x16x32_bf16 v[200:203], a[128:131], a[176:179], v[200:203]
ds_read_b128 a[200:203], v1 offset:6560
v_fma_f32 v15, s64, v75, v13
v_mfma_f32_16x16x32_bf16 v[200:203], a[132:135], a[180:183], v[200:203]
global_load_dwordx4 a[104:107], v3, s[20:21] offset:0
v_fmac_f32 v11, s63, v130
v_mfma_f32_16x16x32_bf16 v[200:203], a[136:139], a[184:187], v[200:203]
ds_read_b128 a[204:207], v1 offset:7616
v_fmac_f32 v14, s63, v131
v_mfma_f32_16x16x32_bf16 v[204:207], a[148:151], a[184:187], v[204:207]
v_fma_f32 v74, s65, v74, v10
v_fma_f32 v75, s65, v75, v13
v_mfma_f32_16x16x32_bf16 v[204:207], a[144:147], a[180:183], v[204:207]
ds_read_b128 a[208:211], v1 offset:8672
v_accvgpr_write_b32 a42, v11
v_mfma_f32_16x16x32_bf16 v[204:207], a[140:143], a[176:179], v[204:207]
v_accvgpr_write_b32 a43, v14
v_fmac_f32 v74, s66, v130
v_mfma_f32_16x16x32_bf16 v[212:215], a[140:143], a[180:183], v[212:215]
v_fmac_f32 v75, s66, v131
v_fma_f32 v130, s67, v130, v12
v_mfma_f32_16x16x32_bf16 v[212:215], a[144:147], a[184:187], v[212:215]
global_load_dwordx4 a[108:111], v3, s[20:21] offset:1024
v_fma_f32 v131, s67, v131, v15
v_mfma_f32_16x16x32_bf16 v[212:215], a[148:151], a[188:191], v[212:215]
v_accvgpr_read_b32 v10, a44
v_accvgpr_read_b32 v13, a45
v_mfma_f32_16x16x32_bf16 v[208:211], a[136:139], a[188:191], v[208:211]
v_fmac_f32 v188, s60, v132
v_fmac_f32 v189, s60, v133
v_mfma_f32_16x16x32_bf16 v[208:211], a[132:135], a[184:187], v[208:211]
v_fma_f32 v11, s62, v76, v10
v_fma_f32 v14, s62, v77, v13
v_mfma_f32_16x16x32_bf16 v[208:211], a[128:131], a[180:183], v[208:211]
v_fma_f32 v12, s64, v76, v10
v_fma_f32 v15, s64, v77, v13
v_mfma_f32_16x16x32_bf16 v[216:219], a[128:131], a[184:187], v[216:219]
s_waitcnt lgkmcnt(1)
v_fmac_f32 v11, s63, v132
v_fmac_f32 v14, s63, v133
v_mfma_f32_16x16x32_bf16 v[216:219], a[132:135], a[188:191], v[216:219]
global_load_dwordx4 a[112:115], v3, s[20:21] offset:2048
v_fma_f32 v76, s65, v76, v10
v_mfma_f32_16x16x32_bf16 v[216:219], a[136:139], a[192:195], v[216:219]
v_fma_f32 v77, s65, v77, v13
v_accvgpr_write_b32 a44, v11
v_mfma_f32_16x16x32_bf16 v[220:223], a[148:151], a[192:195], v[220:223]
s_nop 0
v_accvgpr_write_b32 a45, v14
v_fmac_f32 v76, s66, v132
v_fmac_f32 v77, s66, v133
v_fma_f32 v132, s67, v132, v12
v_fma_f32 v133, s67, v133, v15
v_accvgpr_read_b32 v10, a46
v_accvgpr_read_b32 v13, a47
v_fmac_f32 v190, s60, v134
s_waitcnt lgkmcnt(0)
s_barrier
v_mfma_f32_16x16x32_bf16 v[220:223], a[144:147], a[188:191], v[220:223]
ds_read_b128 a[176:179], v2 offset:0
v_fmac_f32 v191, s60, v135
v_mfma_f32_16x16x32_bf16 v[220:223], a[140:143], a[184:187], v[220:223]
v_fma_f32 v11, s62, v78, v10
v_fma_f32 v14, s62, v79, v13
v_mfma_f32_16x16x32_bf16 v[228:231], a[140:143], a[188:191], v[228:231]
s_add_u32 s8, s8, 3280896
s_addc_u32 s9, s9, 0
v_fma_f32 v12, s64, v78, v10
v_mfma_f32_16x16x32_bf16 v[228:231], a[144:147], a[192:195], v[228:231]
s_add_u32 m0, s23, 0
v_fma_f32 v15, s64, v79, v13
v_fmac_f32 v11, s63, v134
v_mfma_f32_16x16x32_bf16 v[228:231], a[148:151], a[196:199], v[228:231]
buffer_load_dwordx4 v4, s[8:11], 0 offen offset:0 lds
v_fmac_f32 v14, s63, v135
v_mfma_f32_16x16x32_bf16 v[224:227], a[136:139], a[196:199], v[224:227]
ds_read_b128 a[180:183], v2 offset:1056
v_fma_f32 v78, s65, v78, v10
v_mfma_f32_16x16x32_bf16 v[224:227], a[132:135], a[192:195], v[224:227]
ds_read_b128 a[184:187], v2 offset:2112
v_fma_f32 v79, s65, v79, v13
v_mfma_f32_16x16x32_bf16 v[224:227], a[128:131], a[188:191], v[224:227]
global_load_dwordx4 a[116:119], v3, s[20:21] offset:3072
v_accvgpr_write_b32 a46, v11
v_mfma_f32_16x16x32_bf16 v[232:235], a[128:131], a[192:195], v[232:235]
v_accvgpr_write_b32 a47, v14
v_fmac_f32 v78, s66, v134
v_mfma_f32_16x16x32_bf16 v[232:235], a[132:135], a[196:199], v[232:235]
v_fmac_f32 v79, s66, v135
v_fma_f32 v134, s67, v134, v12
v_mfma_f32_16x16x32_bf16 v[232:235], a[136:139], a[200:203], v[232:235]
s_add_u32 s20, s20, 8192
s_addc_u32 s21, s21, 0
v_fma_f32 v135, s67, v135, v15
v_mfma_f32_16x16x32_bf16 v[236:239], a[148:151], a[200:203], v[236:239]
global_load_dwordx4 a[120:123], v3, s[20:21] offset:-4096
v_accvgpr_read_b32 v10, a48
v_mfma_f32_16x16x32_bf16 v[236:239], a[144:147], a[196:199], v[236:239]
ds_read_b128 a[188:191], v2 offset:3168
v_accvgpr_read_b32 v13, a49
v_mfma_f32_16x16x32_bf16 v[236:239], a[140:143], a[192:195], v[236:239]
v_fmac_f32 v192, s60, v136
v_fmac_f32 v193, s60, v137
v_mfma_f32_16x16x32_bf16 v[244:247], a[140:143], a[196:199], v[244:247]
v_fma_f32 v11, s62, v80, v10
v_fma_f32 v14, s62, v81, v13
v_mfma_f32_16x16x32_bf16 v[244:247], a[144:147], a[200:203], v[244:247]
v_fma_f32 v12, s64, v80, v10
v_fma_f32 v15, s64, v81, v13
v_mfma_f32_16x16x32_bf16 v[244:247], a[148:151], a[204:207], v[244:247]
global_load_dwordx4 a[124:127], v3, s[20:21] offset:-3072
v_fmac_f32 v11, s63, v136
v_mfma_f32_16x16x32_bf16 v[240:243], a[136:139], a[204:207], v[240:243]
ds_read_b128 a[192:195], v2 offset:4224
v_fmac_f32 v14, s63, v137
v_mfma_f32_16x16x32_bf16 v[240:243], a[132:135], a[200:203], v[240:243]
s_add_u32 m0, s23, 32
v_fma_f32 v80, s65, v80, v10
v_fma_f32 v81, s65, v81, v13
v_mfma_f32_16x16x32_bf16 v[240:243], a[128:131], a[196:199], v[240:243]
buffer_load_dwordx4 v4, s[8:11], 0 offen offset:1024 lds
v_accvgpr_write_b32 a48, v11
v_mfma_f32_16x16x32_bf16 v[248:251], a[128:131], a[200:203], v[248:251]
v_accvgpr_write_b32 a49, v14
v_fmac_f32 v80, s66, v136
v_mfma_f32_16x16x32_bf16 v[248:251], a[132:135], a[204:207], v[248:251]
v_fmac_f32 v81, s66, v137
v_fma_f32 v136, s67, v136, v12
v_mfma_f32_16x16x32_bf16 v[248:251], a[136:139], a[208:211], v[248:251]
v_fma_f32 v137, s67, v137, v15
v_accvgpr_read_b32 v10, a50
v_mfma_f32_16x16x32_bf16 v[252:255], a[148:151], a[208:211], v[252:255]
ds_read_b128 a[196:199], v2 offset:5280
v_accvgpr_read_b32 v13, a51
v_mfma_f32_16x16x32_bf16 v[252:255], a[144:147], a[204:207], v[252:255]
v_fmac_f32 v194, s60, v138
v_fmac_f32 v195, s60, v139
v_mfma_f32_16x16x32_bf16 v[252:255], a[140:143], a[200:203], v[252:255]
s_waitcnt vmcnt(18) lgkmcnt(2)
v_fma_f32 v11, s62, v82, v10
v_fma_f32 v14, s62, v83, v13
L_h7:
v_mfma_f32_16x16x32_bf16 v[144:147], a[56:59], a[176:179], v[144:147]
s_waitcnt vmcnt(15)
v_fma_f32 v12, s64, v82, v10
v_fma_f32 v15, s64, v83, v13
v_mfma_f32_16x16x32_bf16 v[144:147], a[60:63], a[180:183], v[144:147]
global_load_dwordx4 a[128:131], v3, s[20:21] offset:-2048
v_fmac_f32 v11, s63, v138
v_mfma_f32_16x16x32_bf16 v[144:147], a[64:67], a[184:187], v[144:147]
ds_read_b128 a[200:203], v2 offset:6336
v_fmac_f32 v14, s63, v139
v_mfma_f32_16x16x32_bf16 v[148:151], a[76:79], a[184:187], v[148:151]
v_fma_f32 v82, s65, v82, v10
v_fma_f32 v83, s65, v83, v13
v_mfma_f32_16x16x32_bf16 v[148:151], a[72:75], a[180:183], v[148:151]
v_accvgpr_write_b32 a50, v11
v_accvgpr_write_b32 a51, v14
v_mfma_f32_16x16x32_bf16 v[148:151], a[68:71], a[176:179], v[148:151]
v_fmac_f32 v82, s66, v138
v_fmac_f32 v83, s66, v139
v_mfma_f32_16x16x32_bf16 v[156:159], a[68:71], a[180:183], v[156:159]
v_fma_f32 v138, s67, v138, v12
v_fma_f32 v139, s67, v139, v15
v_mfma_f32_16x16x32_bf16 v[156:159], a[72:75], a[184:187], v[156:159]
global_load_dwordx4 a[132:135], v3, s[20:21] offset:-1024
v_accvgpr_read_b32 v10, a52
v_mfma_f32_16x16x32_bf16 v[156:159], a[76:79], a[188:191], v[156:159]
s_add_u32 m0, s23, 64
v_accvgpr_read_b32 v13, a53
v_fmac_f32 v196, s60, v140
v_mfma_f32_16x16x32_bf16 v[152:155], a[64:67], a[188:191], v[152:155]
ds_read_b128 a[204:207], v2 offset:7392
v_fmac_f32 v197, s60, v141
v_mfma_f32_16x16x32_bf16 v[152:155], a[60:63], a[184:187], v[152:155]
buffer_load_dwordx4 v4, s[8:11], 0 offen offset:2048 lds
v_fma_f32 v11, s62, v84, v10
v_mfma_f32_16x16x32_bf16 v[152:155], a[56:59], a[180:183], v[152:155]
ds_read_b128 a[176:179], v2 offset:32
v_fma_f32 v14, s62, v85, v13
v_mfma_f32_16x16x32_bf16 v[160:163], a[56:59], a[184:187], v[160:163]
s_waitcnt lgkmcnt(2)
v_fma_f32 v12, s64, v84, v10
v_fma_f32 v15, s64, v85, v13
v_mfma_f32_16x16x32_bf16 v[160:163], a[60:63], a[188:191], v[160:163]
ds_read_b128 a[208:211], v2 offset:8448
v_fmac_f32 v11, s63, v140
v_mfma_f32_16x16x32_bf16 v[160:163], a[64:67], a[192:195], v[160:163]
global_load_dwordx4 a[136:139], v3, s[20:21] offset:0
v_fmac_f32 v14, s63, v141
v_mfma_f32_16x16x32_bf16 v[164:167], a[76:79], a[192:195], v[164:167]
ds_read_b128 a[180:183], v2 offset:1088
v_fma_f32 v84, s65, v84, v10
v_mfma_f32_16x16x32_bf16 v[164:167], a[72:75], a[188:191], v[164:167]
v_fma_f32 v85, s65, v85, v13
v_accvgpr_write_b32 a52, v11
v_mfma_f32_16x16x32_bf16 v[164:167], a[68:71], a[184:187], v[164:167]
v_accvgpr_write_b32 a53, v14
v_fmac_f32 v84, s66, v140
v_mfma_f32_16x16x32_bf16 v[172:175], a[68:71], a[188:191], v[172:175]
v_fmac_f32 v85, s66, v141
v_fma_f32 v140, s67, v140, v12
v_mfma_f32_16x16x32_bf16 v[172:175], a[72:75], a[192:195], v[172:175]
v_fma_f32 v141, s67, v141, v15
v_accvgpr_read_b32 v10, a54
v_mfma_f32_16x16x32_bf16 v[172:175], a[76:79], a[196:199], v[172:175]
L_stub8:
s_cmp_eq_u32 s37, 1
s_cbranch_scc1 L_wret0
global_load_dwordx4 a[140:143], v3, s[20:21] offset:1024
v_accvgpr_read_b32 v13, a55
v_mfma_f32_16x16x32_bf16 v[168:171], a[64:67], a[196:199], v[168:171]
ds_read_b128 a[184:187], v2 offset:2144
v_fmac_f32 v198, s60, v142
v_mfma_f32_16x16x32_bf16 v[168:171], a[60:63], a[192:195], v[168:171]
v_fmac_f32 v199, s60, v143
v_fma_f32 v11, s62, v86, v10
v_mfma_f32_16x16x32_bf16 v[168:171], a[56:59], a[188:191], v[168:171]
v_fma_f32 v14, s62, v87, v13
v_fma_f32 v12, s64, v86, v10
v_mfma_f32_16x16x32_bf16 v[176:179], a[56:59], a[192:195], v[176:179]
s_add_u32 m0, s23, 96
v_fma_f32 v15, s64, v87, v13
v_fmac_f32 v11, s63, v142
v_mfma_f32_16x16x32_bf16 v[176:179], a[60:63], a[196:199], v[176:179]
buffer_load_dwordx4 v4, s[8:11], 0 offen offset:3072 lds
v_fmac_f32 v14, s63, v143
v_mfma_f32_16x16x32_bf16 v[176:179], a[64:67], a[200:203], v[176:179]
v_fma_f32 v86, s65, v86, v10
v_fma_f32 v87, s65, v87, v13
v_mfma_f32_16x16x32_bf16 v[180:183], a[76:79], a[200:203], v[180:183]
ds_read_b128 a[188:191], v2 offset:3200
v_accvgpr_write_b32 a54, v11
v_mfma_f32_16x16x32_bf16 v[180:183], a[72:75], a[196:199], v[180:183]
global_load_dwordx4 a[144:147], v3, s[20:21] offset:2048
v_accvgpr_write_b32 a55, v14
v_mfma_f32_16x16x32_bf16 v[180:183], a[68:71], a[192:195], v[180:183]
v_fmac_f32 v86, s66, v142
v_fmac_f32 v87, s66, v143
v_mfma_f32_16x16x32_bf16 v[188:191], a[68:71], a[196:199], v[188:191]
v_fma_f32 v142, s67, v142, v12
v_fma_f32 v143, s67, v143, v15
v_mfma_f32_16x16x32_bf16 v[188:191], a[72:75], a[200:203], v[188:191]
s_waitcnt lgkmcnt(1)
v_accvgpr_read_b32 v16, a0
v_accvgpr_read_b32 v17, a1
v_mfma_f32_16x16x32_bf16 v[188:191], a[76:79], a[204:207], v[188:191]
global_load_dwordx4 a[148:151], v3, s[20:21] offset:3072
v_accvgpr_read_b32 v18, a2
v_mfma_f32_16x16x32_bf16 v[184:187], a[64:67], a[204:207], v[184:187]
ds_read_b128 a[192:195], v2 offset:4256
v_accvgpr_read_b32 v19, a3
v_mfma_f32_16x16x32_bf16 v[184:187], a[60:63], a[200:203], v[184:187]
v_accvgpr_read_b32 v20, a4
v_accvgpr_read_b32 v21, a5
v_mfma_f32_16x16x32_bf16 v[184:187], a[56:59], a[196:199], v[184:187]
v_accvgpr_read_b32 v22, a6
v_accvgpr_read_b32 v23, a7
v_mfma_f32_16x16x32_bf16 v[192:195], a[56:59], a[200:203], v[192:195]
v_sub_f32 v16, v16, v200
v_sub_f32 v17, v17, v201
v_mfma_f32_16x16x32_bf16 v[192:195], a[60:63], a[204:207], v[192:195]
v_sub_f32 v18, v18, v202
v_sub_f32 v19, v19, v203
v_mfma_f32_16x16x32_bf16 v[192:195], a[64:67], a[208:211], v[192:195]
v_sub_f32 v20, v20, v204
v_sub_f32 v21, v21, v205
v_mfma_f32_16x16x32_bf16 v[196:199], a[76:79], a[208:211], v[196:199]
ds_read_b128 a[196:199], v2 offset:5312
v_sub_f32 v22, v22, v206
v_mfma_f32_16x16x32_bf16 v[196:199], a[72:75], a[204:207], v[196:199]
s_add_u32 m0, s23, 4224
v_sub_f32 v23, v23, v207
v_med3_f32 v16, v16, -s22, s22
v_mfma_f32_16x16x32_bf16 v[196:199], a[68:71], a[200:203], v[196:199]
s_waitcnt vmcnt(19)
buffer_load_dwordx4 v4, s[8:11], s12 offen offset:0 lds
v_mfma_f32_16x16x32_bf16 v[144:147], a[80:83], a[176:179], v[144:147]
v_med3_f32 v17, v17, -s22, s22
v_med3_f32 v18, v18, -s22, s22
v_mfma_f32_16x16x32_bf16 v[144:147], a[84:87], a[180:183], v[144:147]
s_add_u32 s20, s20, 8192
s_addc_u32 s21, s21, 0
v_med3_f32 v19, v19, -s22, s22
v_mfma_f32_16x16x32_bf16 v[144:147], a[88:91], a[184:187], v[144:147]
s_waitcnt vmcnt(17)
global_load_dwordx4 a[56:59], v3, s[20:21] offset:-4096
v_mfma_f32_16x16x32_bf16 v[148:151], a[100:103], a[184:187], v[148:151]
ds_read_b128 a[200:203], v2 offset:6368
v_exp_f32 v20, v20
v_mfma_f32_16x16x32_bf16 v[148:151], a[96:99], a[180:183], v[148:151]
v_exp_f32 v21, v21
v_mfma_f32_16x16x32_bf16 v[148:151], a[92:95], a[176:179], v[148:151]
v_exp_f32 v22, v22
v_mfma_f32_16x16x32_bf16 v[156:159], a[92:95], a[180:183], v[156:159]
v_exp_f32 v23, v23
v_mfma_f32_16x16x32_bf16 v[156:159], a[96:99], a[184:187], v[156:159]
s_waitcnt lgkmcnt(1)
global_load_dwordx4 a[60:63], v3, s[20:21] offset:-3072
v_mfma_f32_16x16x32_bf16 v[156:159], a[100:103], a[188:191], v[156:159]
ds_read_b128 a[204:207], v2 offset:7424
v_exp_f32 v16, v16
v_mfma_f32_16x16x32_bf16 v[152:155], a[88:91], a[188:191], v[152:155]
ds_read_b128 a[176:179], v2 offset:64
v_mfma_f32_16x16x32_bf16 v[152:155], a[84:87], a[184:187], v[152:155]
v_exp_f32 v17, v17
v_mfma_f32_16x16x32_bf16 v[152:155], a[80:83], a[180:183], v[152:155]
v_exp_f32 v18, v18
v_mfma_f32_16x16x32_bf16 v[160:163], a[80:83], a[184:187], v[160:163]
v_exp_f32 v19, v19
v_add_f32 v20, 1.0, v20
v_mfma_f32_16x16x32_bf16 v[160:163], a[84:87], a[188:191], v[160:163]
ds_read_b128 a[208:211], v2 offset:8480
v_add_f32 v21, 1.0, v21
v_add_f32 v22, 1.0, v22
v_mfma_f32_16x16x32_bf16 v[160:163], a[88:91], a[192:195], v[160:163]
s_add_u32 m0, s23, 4256
v_add_f32 v23, 1.0, v23
v_fmac_f32 v20, v16, v20
v_fmac_f32 v21, v17, v21
v_mfma_f32_16x16x32_bf16 v[164:167], a[100:103], a[192:195], v[164:167]
global_load_dwordx4 a[64:67], v3, s[20:21] offset:-2048
v_fmac_f32 v22, v18, v22
v_mfma_f32_16x16x32_bf16 v[164:167], a[96:99], a[188:191], v[164:167]
ds_read_b128 a[180:183], v2 offset:1120
v_fmac_f32 v23, v19, v23
v_mfma_f32_16x16x32_bf16 v[164:167], a[92:95], a[184:187], v[164:167]
v_rcp_f32 v20, v20
v_mfma_f32_16x16x32_bf16 v[172:175], a[92:95], a[188:191], v[172:175]
buffer_load_dwordx4 v4, s[8:11], s12 offen offset:1024 lds
v_mfma_f32_16x16x32_bf16 v[172:175], a[96:99], a[192:195], v[172:175]
v_rcp_f32 v21, v21
v_mfma_f32_16x16x32_bf16 v[172:175], a[100:103], a[196:199], v[172:175]
v_rcp_f32 v22, v22
v_mfma_f32_16x16x32_bf16 v[168:171], a[88:91], a[196:199], v[168:171]
global_load_dwordx4 a[68:71], v3, s[20:21] offset:-1024
v_rcp_f32 v23, v23
v_mfma_f32_16x16x32_bf16 v[168:171], a[84:87], a[192:195], v[168:171]
ds_read_b128 a[184:187], v2 offset:2176
v_fma_f32 v16, v16, v20, -v20
v_mfma_f32_16x16x32_bf16 v[168:171], a[80:83], a[188:191], v[168:171]
v_fma_f32 v17, v17, v21, -v21
v_fma_f32 v18, v18, v22, -v22
v_mfma_f32_16x16x32_bf16 v[176:179], a[80:83], a[192:195], v[176:179]
v_fma_f32 v19, v19, v23, -v23
v_cvt_pk_bf16_f32 v16, v16, v17
v_mfma_f32_16x16x32_bf16 v[176:179], a[84:87], a[196:199], v[176:179]
s_waitcnt lgkmcnt(2)
v_cvt_pk_bf16_f32 v17, v18, v19
v_accvgpr_read_b32 v24, a8
v_mfma_f32_16x16x32_bf16 v[176:179], a[88:91], a[200:203], v[176:179]
ds_write_b64 v5, v[16:17] offset:0
v_mfma_f32_16x16x32_bf16 v[180:183], a[100:103], a[200:203], v[180:183]
global_load_dwordx4 a[72:75], v3, s[20:21] offset:0
v_accvgpr_read_b32 v25, a9
v_accvgpr_read_b32 v26, a10
v_mfma_f32_16x16x32_bf16 v[180:183], a[96:99], a[196:199], v[180:183]
ds_read_b128 a[188:191], v2 offset:3232
v_accvgpr_read_b32 v27, a11
v_mfma_f32_16x16x32_bf16 v[180:183], a[92:95], a[192:195], v[180:183]
v_accvgpr_read_b32 v28, a12
v_accvgpr_read_b32 v29, a13
v_mfma_f32_16x16x32_bf16 v[188:191], a[92:95], a[196:199], v[188:191]
s_add_u32 m0, s23, 4288
v_accvgpr_read_b32 v30, a14
v_accvgpr_read_b32 v31, a15
v_mfma_f32_16x16x32_bf16 v[188:191], a[96:99], a[200:203], v[188:191]
buffer_load_dwordx4 v4, s[8:11], s12 offen offset:2048 lds
v_mfma_f32_16x16x32_bf16 v[188:191], a[100:103], a[204:207], v[188:191]
v_sub_f32 v24, v24, v208
v_sub_f32 v25, v25, v209
v_sub_f32 v26, v26, v210
v_mfma_f32_16x16x32_bf16 v[184:187], a[88:91], a[204:207], v[184:187]
ds_read_b128 a[192:195], v2 offset:4288
v_sub_f32 v27, v27, v211
v_sub_f32 v28, v28, v212
v_mfma_f32_16x16x32_bf16 v[184:187], a[84:87], a[200:203], v[184:187]
global_load_dwordx4 a[76:79], v3, s[20:21] offset:1024
v_sub_f32 v29, v29, v213
v_mfma_f32_16x16x32_bf16 v[184:187], a[80:83], a[196:199], v[184:187]
v_sub_f32 v30, v30, v214
v_sub_f32 v31, v31, v215
v_mfma_f32_16x16x32_bf16 v[192:195], a[80:83], a[200:203], v[192:195]
v_med3_f32 v24, v24, -s22, s22
v_med3_f32 v25, v25, -s22, s22
v_mfma_f32_16x16x32_bf16 v[192:195], a[84:87], a[204:207], v[192:195]
v_med3_f32 v26, v26, -s22, s22
v_med3_f32 v27, v27, -s22, s22
v_mfma_f32_16x16x32_bf16 v[192:195], a[88:91], a[208:211], v[192:195]
v_exp_f32 v28, v28
v_mfma_f32_16x16x32_bf16 v[196:199], a[100:103], a[208:211], v[196:199]
ds_read_b128 a[196:199], v2 offset:5344
v_exp_f32 v29, v29
v_mfma_f32_16x16x32_bf16 v[196:199], a[96:99], a[204:207], v[196:199]
v_exp_f32 v30, v30
v_mfma_f32_16x16x32_bf16 v[196:199], a[92:95], a[200:203], v[196:199]
s_waitcnt vmcnt(22)
v_exp_f32 v31, v31
v_mfma_f32_16x16x32_bf16 v[144:147], a[104:107], a[176:179], v[144:147]
s_waitcnt lgkmcnt(2)
v_exp_f32 v24, v24
v_mfma_f32_16x16x32_bf16 v[144:147], a[108:111], a[180:183], v[144:147]
s_waitcnt vmcnt(18)
global_load_dwordx4 a[80:83], v3, s[20:21] offset:2048
v_mfma_f32_16x16x32_bf16 v[144:147], a[112:115], a[184:187], v[144:147]
ds_read_b128 a[200:203], v2 offset:6400
v_exp_f32 v25, v25
v_mfma_f32_16x16x32_bf16 v[148:151], a[124:127], a[184:187], v[148:151]
v_exp_f32 v26, v26
v_mfma_f32_16x16x32_bf16 v[148:151], a[120:123], a[180:183], v[148:151]
s_add_u32 m0, s23, 4320
v_exp_f32 v27, v27
v_add_f32 v28, 1.0, v28
v_mfma_f32_16x16x32_bf16 v[148:151], a[116:119], a[176:179], v[148:151]
buffer_load_dwordx4 v4, s[8:11], s12 offen offset:3072 lds
v_mfma_f32_16x16x32_bf16 v[156:159], a[116:119], a[180:183], v[156:159]
v_add_f32 v29, 1.0, v29
v_add_f32 v30, 1.0, v30
v_add_f32 v31, 1.0, v31
v_mfma_f32_16x16x32_bf16 v[156:159], a[120:123], a[184:187], v[156:159]
ds_read_b128 a[204:207], v2 offset:7456
v_fmac_f32 v28, v24, v28
v_mfma_f32_16x16x32_bf16 v[156:159], a[124:127], a[188:191], v[156:159]
global_load_dwordx4 a[84:87], v3, s[20:21] offset:3072
v_fmac_f32 v29, v25, v29
v_mfma_f32_16x16x32_bf16 v[152:155], a[112:115], a[188:191], v[152:155]
ds_read_b128 a[176:179], v2 offset:96
v_fmac_f32 v30, v26, v30
v_fmac_f32 v31, v27, v31
v_mfma_f32_16x16x32_bf16 v[152:155], a[108:111], a[184:187], v[152:155]
v_rcp_f32 v28, v28
v_mfma_f32_16x16x32_bf16 v[152:155], a[104:107], a[180:183], v[152:155]
v_rcp_f32 v29, v29
v_mfma_f32_16x16x32_bf16 v[160:163], a[104:107], a[184:187], v[160:163]
v_rcp_f32 v30, v30
v_mfma_f32_16x16x32_bf16 v[160:163], a[108:111], a[188:191], v[160:163]
s_waitcnt lgkmcnt(2)
s_add_u32 s20, s20, 8192
s_addc_u32 s21, s21, 0
v_mfma_f32_16x16x32_bf16 v[160:163], a[112:115], a[192:195], v[160:163]
ds_read_b128 a[208:211], v2 offset:8512
v_rcp_f32 v31, v31
v_mfma_f32_16x16x32_bf16 v[164:167], a[124:127], a[192:195], v[164:167]
global_load_dwordx4 a[88:91], v3, s[20:21] offset:-4096
v_fma_f32 v24, v24, v28, -v28
v_fma_f32 v25, v25, v29, -v29
v_mfma_f32_16x16x32_bf16 v[164:167], a[120:123], a[188:191], v[164:167]
ds_read_b128 a[180:183], v2 offset:1152
v_fma_f32 v26, v26, v30, -v30
v_mfma_f32_16x16x32_bf16 v[164:167], a[116:119], a[184:187], v[164:167]
v_fma_f32 v27, v27, v31, -v31
v_cvt_pk_bf16_f32 v24, v24, v25
v_mfma_f32_16x16x32_bf16 v[172:175], a[116:119], a[188:191], v[172:175]
v_cvt_pk_bf16_f32 v25, v26, v27
v_accvgpr_read_b32 v16, a16
v_mfma_f32_16x16x32_bf16 v[172:175], a[120:123], a[192:195], v[172:175]
ds_write_b64 v5, v[24:25] offset:2304
v_mfma_f32_16x16x32_bf16 v[172:175], a[124:127], a[196:199], v[172:175]
s_add_u32 m0, s23, 8448
v_accvgpr_read_b32 v17, a17
v_accvgpr_read_b32 v18, a18
v_accvgpr_read_b32 v19, a19
v_mfma_f32_16x16x32_bf16 v[168:171], a[112:115], a[196:199], v[168:171]
global_load_dwordx4 a[92:95], v3, s[20:21] offset:-3072
v_accvgpr_read_b32 v20, a20
v_accvgpr_read_b32 v21, a21
v_mfma_f32_16x16x32_bf16 v[168:171], a[108:111], a[192:195], v[168:171]
ds_read_b128 a[184:187], v2 offset:2208
v_accvgpr_read_b32 v22, a22
v_mfma_f32_16x16x32_bf16 v[168:171], a[104:107], a[188:191], v[168:171]
v_accvgpr_read_b32 v23, a23
v_sub_f32 v16, v16, v216
v_mfma_f32_16x16x32_bf16 v[176:179], a[104:107], a[192:195], v[176:179]
buffer_load_dwordx4 v4, s[8:11], s13 offen offset:0 lds
v_mfma_f32_16x16x32_bf16 v[176:179], a[108:111], a[196:199], v[176:179]
v_sub_f32 v17, v17, v217
v_sub_f32 v18, v18, v218
v_mfma_f32_16x16x32_bf16 v[176:179], a[112:115], a[200:203], v[176:179]
v_sub_f32 v19, v19, v219
v_sub_f32 v20, v20, v220
v_sub_f32 v21, v21, v221
v_mfma_f32_16x16x32_bf16 v[180:183], a[124:127], a[200:203], v[180:183]
global_load_dwordx4 a[96:99], v3, s[20:21] offset:-2048
v_sub_f32 v22, v22, v222
v_mfma_f32_16x16x32_bf16 v[180:183], a[120:123], a[196:199], v[180:183]
ds_read_b128 a[188:191], v2 offset:3264
v_sub_f32 v23, v23, v223
v_mfma_f32_16x16x32_bf16 v[180:183], a[116:119], a[192:195], v[180:183]
v_med3_f32 v16, v16, -s22, s22
v_med3_f32 v17, v17, -s22, s22
v_mfma_f32_16x16x32_bf16 v[188:191], a[116:119], a[196:199], v[188:191]
v_med3_f32 v18, v18, -s22, s22
v_med3_f32 v19, v19, -s22, s22
v_mfma_f32_16x16x32_bf16 v[188:191], a[120:123], a[200:203], v[188:191]
s_waitcnt lgkmcnt(2)
v_exp_f32 v20, v20
v_mfma_f32_16x16x32_bf16 v[188:191], a[124:127], a[204:207], v[188:191]
global_load_dwordx4 a[100:103], v3, s[20:21] offset:-1024
v_exp_f32 v21, v21
v_mfma_f32_16x16x32_bf16 v[184:187], a[112:115], a[204:207], v[184:187]
ds_read_b128 a[192:195], v2 offset:4320
v_exp_f32 v22, v22
v_mfma_f32_16x16x32_bf16 v[184:187], a[108:111], a[200:203], v[184:187]
v_exp_f32 v23, v23
v_mfma_f32_16x16x32_bf16 v[184:187], a[104:107], a[196:199], v[184:187]
v_exp_f32 v16, v16
v_mfma_f32_16x16x32_bf16 v[192:195], a[104:107], a[200:203], v[192:195]
s_add_u32 m0, s23, 8480
v_exp_f32 v17, v17
v_mfma_f32_16x16x32_bf16 v[192:195], a[108:111], a[204:207], v[192:195]
buffer_load_dwordx4 v4, s[8:11], s13 offen offset:1024 lds
v_mfma_f32_16x16x32_bf16 v[192:195], a[112:115], a[208:211], v[192:195]
v_exp_f32 v18, v18
v_mfma_f32_16x16x32_bf16 v[196:199], a[124:127], a[208:211], v[196:199]
ds_read_b128 a[196:199], v2 offset:5376
v_exp_f32 v19, v19
v_mfma_f32_16x16x32_bf16 v[196:199], a[120:123], a[204:207], v[196:199]
v_add_f32 v20, 1.0, v20
v_add_f32 v21, 1.0, v21
v_mfma_f32_16x16x32_bf16 v[196:199], a[116:119], a[200:203], v[196:199]
s_waitcnt vmcnt(22)
v_add_f32 v22, 1.0, v22
v_add_f32 v23, 1.0, v23
v_mfma_f32_16x16x32_bf16 v[144:147], a[128:131], a[176:179], v[144:147]
s_waitcnt lgkmcnt(2)
v_fmac_f32 v20, v16, v20
v_fmac_f32 v21, v17, v21
v_mfma_f32_16x16x32_bf16 v[144:147], a[132:135], a[180:183], v[144:147]
global_load_dwordx4 a[104:107], v3, s[20:21] offset:0
v_fmac_f32 v22, v18, v22
v_fmac_f32 v23, v19, v23
v_mfma_f32_16x16x32_bf16 v[144:147], a[136:139], a[184:187], v[144:147]
s_waitcnt vmcnt(19)
ds_read_b128 a[200:203], v2 offset:6432
v_mfma_f32_16x16x32_bf16 v[148:151], a[148:151], a[184:187], v[148:151]
v_rcp_f32 v20, v20
v_mfma_f32_16x16x32_bf16 v[148:151], a[144:147], a[180:183], v[148:151]
v_rcp_f32 v21, v21
v_mfma_f32_16x16x32_bf16 v[148:151], a[140:143], a[176:179], v[148:151]
v_rcp_f32 v22, v22
v_mfma_f32_16x16x32_bf16 v[156:159], a[140:143], a[180:183], v[156:159]
v_rcp_f32 v23, v23
v_fma_f32 v16, v16, v20, -v20
v_mfma_f32_16x16x32_bf16 v[156:159], a[144:147], a[184:187], v[156:159]
global_load_dwordx4 a[108:111], v3, s[20:21] offset:1024
v_fma_f32 v17, v17, v21, -v21
v_fma_f32 v18, v18, v22, -v22
v_mfma_f32_16x16x32_bf16 v[156:159], a[148:151], a[188:191], v[156:159]
ds_read_b128 a[204:207], v2 offset:7488
v_fma_f32 v19, v19, v23, -v23
v_mfma_f32_16x16x32_bf16 v[152:155], a[136:139], a[188:191], v[152:155]
ds_read_b128 a[176:179], v2 offset:128
v_cvt_pk_bf16_f32 v16, v16, v17
v_mfma_f32_16x16x32_bf16 v[152:155], a[132:135], a[184:187], v[152:155]
s_add_u32 m0, s23, 8512
v_cvt_pk_bf16_f32 v17, v18, v19
v_accvgpr_read_b32 v24, a24
v_mfma_f32_16x16x32_bf16 v[152:155], a[128:131], a[180:183], v[152:155]
ds_write_b64 v5, v[16:17] offset:4608
v_mfma_f32_16x16x32_bf16 v[160:163], a[128:131], a[184:187], v[160:163]
s_waitcnt lgkmcnt(3)
buffer_load_dwordx4 v4, s[8:11], s13 offen offset:2048 lds
v_mfma_f32_16x16x32_bf16 v[160:163], a[132:135], a[188:191], v[160:163]
ds_read_b128 a[208:211], v2 offset:8544
v_accvgpr_read_b32 v25, a25
v_accvgpr_read_b32 v26, a26
v_mfma_f32_16x16x32_bf16 v[160:163], a[136:139], a[192:195], v[160:163]
v_accvgpr_read_b32 v27, a27
v_accvgpr_read_b32 v28, a28
v_accvgpr_read_b32 v29, a29
v_mfma_f32_16x16x32_bf16 v[164:167], a[148:151], a[192:195], v[164:167]
global_load_dwordx4 a[112:115], v3, s[20:21] offset:2048
v_accvgpr_read_b32 v30, a30
v_mfma_f32_16x16x32_bf16 v[164:167], a[144:147], a[188:191], v[164:167]
ds_read_b128 a[180:183], v2 offset:1184
v_accvgpr_read_b32 v31, a31
v_mfma_f32_16x16x32_bf16 v[164:167], a[140:143], a[184:187], v[164:167]
v_sub_f32 v24, v24, v224
v_sub_f32 v25, v25, v225
v_mfma_f32_16x16x32_bf16 v[172:175], a[140:143], a[188:191], v[172:175]
v_sub_f32 v26, v26, v226
v_sub_f32 v27, v27, v227
v_mfma_f32_16x16x32_bf16 v[172:175], a[144:147], a[192:195], v[172:175]
v_sub_f32 v28, v28, v228
v_sub_f32 v29, v29, v229
v_mfma_f32_16x16x32_bf16 v[172:175], a[148:151], a[196:199], v[172:175]
global_load_dwordx4 a[116:119], v3, s[20:21] offset:3072
v_sub_f32 v30, v30, v230
v_sub_f32 v31, v31, v231
v_mfma_f32_16x16x32_bf16 v[168:171], a[136:139], a[196:199], v[168:171]
ds_read_b128 a[184:187], v2 offset:2240
v_med3_f32 v24, v24, -s22, s22
v_med3_f32 v25, v25, -s22, s22
v_mfma_f32_16x16x32_bf16 v[168:171], a[132:135], a[192:195], v[168:171]
v_med3_f32 v26, v26, -s22, s22
v_med3_f32 v27, v27, -s22, s22
v_mfma_f32_16x16x32_bf16 v[168:171], a[128:131], a[188:191], v[168:171]
v_exp_f32 v28, v28
v_mfma_f32_16x16x32_bf16 v[176:179], a[128:131], a[192:195], v[176:179]
v_exp_f32 v29, v29
v_mfma_f32_16x16x32_bf16 v[176:179], a[132:135], a[196:199], v[176:179]
v_exp_f32 v30, v30
v_mfma_f32_16x16x32_bf16 v[176:179], a[136:139], a[200:203], v[176:179]
s_add_u32 m0, s23, 8544
v_exp_f32 v31, v31
v_mfma_f32_16x16x32_bf16 v[180:183], a[148:151], a[200:203], v[180:183]
s_add_u32 s20, s20, 8192
s_addc_u32 s21, s21, 0
v_exp_f32 v24, v24
v_mfma_f32_16x16x32_bf16 v[180:183], a[144:147], a[196:199], v[180:183]
buffer_load_dwordx4 v4, s[8:11], s13 offen offset:3072 lds
v_mfma_f32_16x16x32_bf16 v[180:183], a[140:143], a[192:195], v[180:183]
ds_read_b128 a[188:191], v2 offset:3296
v_exp_f32 v25, v25
v_mfma_f32_16x16x32_bf16 v[188:191], a[140:143], a[196:199], v[188:191]
v_exp_f32 v26, v26
v_mfma_f32_16x16x32_bf16 v[188:191], a[144:147], a[200:203], v[188:191]
s_waitcnt lgkmcnt(1)
global_load_dwordx4 a[120:123], v3, s[20:21] offset:-4096
v_mfma_f32_16x16x32_bf16 v[188:191], a[148:151], a[204:207], v[188:191]
v_exp_f32 v27, v27
v_add_f32 v28, 1.0, v28
v_mfma_f32_16x16x32_bf16 v[184:187], a[136:139], a[204:207], v[184:187]
ds_read_b128 a[192:195], v2 offset:4352
v_add_f32 v29, 1.0, v29
v_add_f32 v30, 1.0, v30
v_mfma_f32_16x16x32_bf16 v[184:187], a[132:135], a[200:203], v[184:187]
global_load_dwordx4 a[124:127], v3, s[20:21] offset:-3072
v_add_f32 v31, 1.0, v31
v_mfma_f32_16x16x32_bf16 v[184:187], a[128:131], a[196:199], v[184:187]
v_fmac_f32 v28, v24, v28
v_fmac_f32 v29, v25, v29
v_mfma_f32_16x16x32_bf16 v[192:195], a[128:131], a[200:203], v[192:195]
v_fmac_f32 v30, v26, v30
v_fmac_f32 v31, v27, v31
v_mfma_f32_16x16x32_bf16 v[192:195], a[132:135], a[204:207], v[192:195]
v_rcp_f32 v28, v28
v_mfma_f32_16x16x32_bf16 v[192:195], a[136:139], a[208:211], v[192:195]
v_rcp_f32 v29, v29
v_mfma_f32_16x16x32_bf16 v[196:199], a[148:151], a[208:211], v[196:199]
ds_read_b128 a[196:199], v2 offset:5408
v_mfma_f32_16x16x32_bf16 v[196:199], a[144:147], a[204:207], v[196:199]
v_rcp_f32 v30, v30
v_mfma_f32_16x16x32_bf16 v[196:199], a[140:143], a[200:203], v[196:199]
s_waitcnt vmcnt(22)
v_rcp_f32 v31, v31
v_fma_f32 v24, v24, v28, -v28
v_mfma_f32_16x16x32_bf16 v[144:147], a[56:59], a[176:179], v[144:147]
s_add_u32 m0, s23, 12672
v_fma_f32 v25, v25, v29, -v29
v_fma_f32 v26, v26, v30, -v30
v_fma_f32 v27, v27, v31, -v31
v_mfma_f32_16x16x32_bf16 v[144:147], a[60:63], a[180:183], v[144:147]
s_waitcnt vmcnt(17)
buffer_load_dwordx4 v4, s[8:11], s14 offen offset:0 lds
v_mfma_f32_16x16x32_bf16 v[144:147], a[64:67], a[184:187], v[144:147]
ds_read_b128 a[200:203], v2 offset:6464
v_cvt_pk_bf16_f32 v24, v24, v25
v_cvt_pk_bf16_f32 v25, v26, v27
v_mfma_f32_16x16x32_bf16 v[148:151], a[76:79], a[184:187], v[148:151]
ds_write_b64 v5, v[24:25] offset:6912
v_mfma_f32_16x16x32_bf16 v[148:151], a[72:75], a[180:183], v[148:151]
global_load_dwordx4 a[128:131], v3, s[20:21] offset:-2048
v_accvgpr_read_b32 v16, a32
v_mfma_f32_16x16x32_bf16 v[148:151], a[68:71], a[176:179], v[148:151]
v_accvgpr_read_b32 v17, a33
v_accvgpr_read_b32 v18, a34
v_mfma_f32_16x16x32_bf16 v[156:159], a[68:71], a[180:183], v[156:159]
s_waitcnt lgkmcnt(3)
v_accvgpr_read_b32 v19, a35
v_accvgpr_read_b32 v20, a36
v_mfma_f32_16x16x32_bf16 v[156:159], a[72:75], a[184:187], v[156:159]
global_load_dwordx4 a[132:135], v3, s[20:21] offset:-1024
v_accvgpr_read_b32 v21, a37
v_accvgpr_read_b32 v22, a38
v_mfma_f32_16x16x32_bf16 v[156:159], a[76:79], a[188:191], v[156:159]
ds_read_b128 a[204:207], v2 offset:7520
v_accvgpr_read_b32 v23, a39
v_mfma_f32_16x16x32_bf16 v[152:155], a[64:67], a[188:191], v[152:155]
ds_read_b128 a[176:179], v2 offset:160
v_sub_f32 v16, v16, v232
v_mfma_f32_16x16x32_bf16 v[152:155], a[60:63], a[184:187], v[152:155]
v_sub_f32 v17, v17, v233
v_sub_f32 v18, v18, v234
v_mfma_f32_16x16x32_bf16 v[152:155], a[56:59], a[180:183], v[152:155]
v_sub_f32 v19, v19, v235
v_sub_f32 v20, v20, v236
v_sub_f32 v21, v21, v237
v_mfma_f32_16x16x32_bf16 v[160:163], a[56:59], a[184:187], v[160:163]
v_sub_f32 v22, v22, v238
v_sub_f32 v23, v23, v239
v_mfma_f32_16x16x32_bf16 v[160:163], a[60:63], a[188:191], v[160:163]
ds_read_b128 a[208:211], v2 offset:8576
v_med3_f32 v16, v16, -s22, s22
v_mfma_f32_16x16x32_bf16 v[160:163], a[64:67], a[192:195], v[160:163]
global_load_dwordx4 a[136:139], v3, s[20:21] offset:0
v_med3_f32 v17, v17, -s22, s22
v_mfma_f32_16x16x32_bf16 v[164:167], a[76:79], a[192:195], v[164:167]
ds_read_b128 a[180:183], v2 offset:1216
v_med3_f32 v18, v18, -s22, s22
v_med3_f32 v19, v19, -s22, s22
v_mfma_f32_16x16x32_bf16 v[164:167], a[72:75], a[188:191], v[164:167]
s_add_u32 m0, s23, 12704
v_exp_f32 v20, v20
v_mfma_f32_16x16x32_bf16 v[164:167], a[68:71], a[184:187], v[164:167]
buffer_load_dwordx4 v4, s[8:11], s14 offen offset:1024 lds
v_mfma_f32_16x16x32_bf16 v[172:175], a[68:71], a[188:191], v[172:175]
v_exp_f32 v21, v21
v_mfma_f32_16x16x32_bf16 v[172:175], a[72:75], a[192:195], v[172:175]
s_waitcnt lgkmcnt(2)
v_exp_f32 v22, v22
v_mfma_f32_16x16x32_bf16 v[172:175], a[76:79], a[196:199], v[172:175]
global_load_dwordx4 a[140:143], v3, s[20:21] offset:1024
v_exp_f32 v23, v23
v_mfma_f32_16x16x32_bf16 v[168:171], a[64:67], a[196:199], v[168:171]
ds_read_b128 a[184:187], v2 offset:2272
v_mfma_f32_16x16x32_bf16 v[168:171], a[60:63], a[192:195], v[168:171]
v_exp_f32 v16, v16
v_mfma_f32_16x16x32_bf16 v[168:171], a[56:59], a[188:191], v[168:171]
v_exp_f32 v17, v17
v_mfma_f32_16x16x32_bf16 v[176:179], a[56:59], a[192:195], v[176:179]
v_exp_f32 v18, v18
v_mfma_f32_16x16x32_bf16 v[176:179], a[60:63], a[196:199], v[176:179]
v_exp_f32 v19, v19
v_add_f32 v20, 1.0, v20
v_mfma_f32_16x16x32_bf16 v[176:179], a[64:67], a[200:203], v[176:179]
global_load_dwordx4 a[144:147], v3, s[20:21] offset:2048
v_add_f32 v21, 1.0, v21
v_add_f32 v22, 1.0, v22
v_mfma_f32_16x16x32_bf16 v[180:183], a[76:79], a[200:203], v[180:183]
ds_read_b128 a[188:191], v2 offset:3328
v_add_f32 v23, 1.0, v23
v_mfma_f32_16x16x32_bf16 v[180:183], a[72:75], a[196:199], v[180:183]
v_fmac_f32 v20, v16, v20
v_fmac_f32 v21, v17, v21
v_mfma_f32_16x16x32_bf16 v[180:183], a[68:71], a[192:195], v[180:183]
v_fmac_f32 v22, v18, v22
v_fmac_f32 v23, v19, v23
v_mfma_f32_16x16x32_bf16 v[188:191], a[68:71], a[196:199], v[188:191]
v_rcp_f32 v20, v20
v_mfma_f32_16x16x32_bf16 v[188:191], a[72:75], a[200:203], v[188:191]
v_rcp_f32 v21, v21
v_mfma_f32_16x16x32_bf16 v[188:191], a[76:79], a[204:207], v[188:191]
s_add_u32 m0, s23, 12736
v_rcp_f32 v22, v22
v_mfma_f32_16x16x32_bf16 v[184:187], a[64:67], a[204:207], v[184:187]
buffer_load_dwordx4 v4, s[8:11], s14 offen offset:2048 lds
v_mfma_f32_16x16x32_bf16 v[184:187], a[60:63], a[200:203], v[184:187]
ds_read_b128 a[192:195], v2 offset:4384
v_rcp_f32 v23, v23
v_mfma_f32_16x16x32_bf16 v[184:187], a[56:59], a[196:199], v[184:187]
v_fma_f32 v16, v16, v20, -v20
v_fma_f32 v17, v17, v21, -v21
v_fma_f32 v18, v18, v22, -v22
v_mfma_f32_16x16x32_bf16 v[192:195], a[56:59], a[200:203], v[192:195]
global_load_dwordx4 a[148:151], v3, s[20:21] offset:3072
v_fma_f32 v19, v19, v23, -v23
v_mfma_f32_16x16x32_bf16 v[192:195], a[60:63], a[204:207], v[192:195]
s_waitcnt lgkmcnt(1)
v_cvt_pk_bf16_f32 v16, v16, v17
v_cvt_pk_bf16_f32 v17, v18, v19
v_mfma_f32_16x16x32_bf16 v[192:195], a[64:67], a[208:211], v[192:195]
ds_write_b64 v5, v[16:17] offset:9216
v_mfma_f32_16x16x32_bf16 v[196:199], a[76:79], a[208:211], v[196:199]
ds_read_b128 a[196:199], v2 offset:5440
v_accvgpr_read_b32 v24, a40
v_accvgpr_read_b32 v25, a41
v_mfma_f32_16x16x32_bf16 v[196:199], a[72:75], a[204:207], v[196:199]
v_accvgpr_read_b32 v26, a42
v_accvgpr_read_b32 v27, a43
v_mfma_f32_16x16x32_bf16 v[196:199], a[68:71], a[200:203], v[196:199]
s_waitcnt vmcnt(22)
v_accvgpr_read_b32 v28, a44
v_accvgpr_read_b32 v29, a45
v_mfma_f32_16x16x32_bf16 v[144:147], a[80:83], a[176:179], v[144:147]
s_waitcnt vmcnt(18)
v_accvgpr_read_b32 v30, a46
v_accvgpr_read_b32 v31, a47
v_mfma_f32_16x16x32_bf16 v[144:147], a[84:87], a[180:183], v[144:147]
s_add_u32 s20, s20, 8192
s_addc_u32 s21, s21, 0
v_sub_f32 v24, v24, v240
v_sub_f32 v25, v25, v241
v_mfma_f32_16x16x32_bf16 v[144:147], a[88:91], a[184:187], v[144:147]
global_load_dwordx4 a[56:59], v3, s[20:21] offset:-4096
v_sub_f32 v26, v26, v242
v_sub_f32 v27, v27, v243
v_mfma_f32_16x16x32_bf16 v[148:151], a[100:103], a[184:187], v[148:151]
ds_read_b128 a[200:203], v2 offset:6496
v_sub_f32 v28, v28, v244
v_sub_f32 v29, v29, v245
v_mfma_f32_16x16x32_bf16 v[148:151], a[96:99], a[180:183], v[148:151]
v_sub_f32 v30, v30, v246
v_sub_f32 v31, v31, v247
v_mfma_f32_16x16x32_bf16 v[148:151], a[92:95], a[176:179], v[148:151]
v_med3_f32 v24, v24, -s22, s22
v_med3_f32 v25, v25, -s22, s22
v_mfma_f32_16x16x32_bf16 v[156:159], a[92:95], a[180:183], v[156:159]
v_med3_f32 v26, v26, -s22, s22
v_med3_f32 v27, v27, -s22, s22
v_mfma_f32_16x16x32_bf16 v[156:159], a[96:99], a[184:187], v[156:159]
global_load_dwordx4 a[60:63], v3, s[20:21] offset:-3072
v_mfma_f32_16x16x32_bf16 v[156:159], a[100:103], a[188:191], v[156:159]
ds_read_b128 a[204:207], v2 offset:7552
v_exp_f32 v28, v28
v_mfma_f32_16x16x32_bf16 v[152:155], a[88:91], a[188:191], v[152:155]
ds_read_b128 a[176:179], v2 offset:192
v_mfma_f32_16x16x32_bf16 v[152:155], a[84:87], a[184:187], v[152:155]
v_exp_f32 v29, v29
v_mfma_f32_16x16x32_bf16 v[152:155], a[80:83], a[180:183], v[152:155]
L_stub9:
s_cmp_eq_u32 s37, 1
s_cbranch_scc1 L_wret0
v_exp_f32 v30, v30
v_mfma_f32_16x16x32_bf16 v[160:163], a[80:83], a[184:187], v[160:163]
s_waitcnt lgkmcnt(3)
v_exp_f32 v31, v31
v_mfma_f32_16x16x32_bf16 v[160:163], a[84:87], a[188:191], v[160:163]
ds_read_b128 a[208:211], v2 offset:8608
v_exp_f32 v24, v24
v_mfma_f32_16x16x32_bf16 v[160:163], a[88:91], a[192:195], v[160:163]
global_load_dwordx4 a[64:67], v3, s[20:21] offset:-2048
v_mfma_f32_16x16x32_bf16 v[164:167], a[100:103], a[192:195], v[164:167]
ds_read_b128 a[180:183], v2 offset:1248
v_exp_f32 v25, v25
v_mfma_f32_16x16x32_bf16 v[164:167], a[96:99], a[188:191], v[164:167]
v_exp_f32 v26, v26
v_mfma_f32_16x16x32_bf16 v[164:167], a[92:95], a[184:187], v[164:167]
v_exp_f32 v27, v27
v_mfma_f32_16x16x32_bf16 v[172:175], a[92:95], a[188:191], v[172:175]
v_add_f32 v28, 1.0, v28
v_add_f32 v29, 1.0, v29
v_mfma_f32_16x16x32_bf16 v[172:175], a[96:99], a[192:195], v[172:175]
v_add_f32 v30, 1.0, v30
v_add_f32 v31, 1.0, v31
v_mfma_f32_16x16x32_bf16 v[172:175], a[100:103], a[196:199], v[172:175]
global_load_dwordx4 a[68:71], v3, s[20:21] offset:-1024
v_fmac_f32 v28, v24, v28
v_fmac_f32 v29, v25, v29
v_mfma_f32_16x16x32_bf16 v[168:171], a[88:91], a[196:199], v[168:171]
ds_read_b128 a[184:187], v2 offset:2304
v_fmac_f32 v30, v26, v30
v_fmac_f32 v31, v27, v31
v_mfma_f32_16x16x32_bf16 v[168:171], a[84:87], a[192:195], v[168:171]
v_rcp_f32 v28, v28
v_mfma_f32_16x16x32_bf16 v[168:171], a[80:83], a[188:191], v[168:171]
v_rcp_f32 v29, v29
v_mfma_f32_16x16x32_bf16 v[176:179], a[80:83], a[192:195], v[176:179]
v_rcp_f32 v30, v30
v_mfma_f32_16x16x32_bf16 v[176:179], a[84:87], a[196:199], v[176:179]
s_waitcnt lgkmcnt(1)
v_rcp_f32 v31, v31
v_mfma_f32_16x16x32_bf16 v[176:179], a[88:91], a[200:203], v[176:179]
global_load_dwordx4 a[72:75], v3, s[20:21] offset:0
v_fma_f32 v24, v24, v28, -v28
v_mfma_f32_16x16x32_bf16 v[180:183], a[100:103], a[200:203], v[180:183]
ds_read_b128 a[188:191], v2 offset:3360
v_fma_f32 v25, v25, v29, -v29
v_mfma_f32_16x16x32_bf16 v[180:183], a[96:99], a[196:199], v[180:183]
v_fma_f32 v26, v26, v30, -v30
v_fma_f32 v27, v27, v31, -v31
v_mfma_f32_16x16x32_bf16 v[180:183], a[92:95], a[192:195], v[180:183]
v_cvt_pk_bf16_f32 v24, v24, v25
v_cvt_pk_bf16_f32 v25, v26, v27
v_mfma_f32_16x16x32_bf16 v[188:191], a[92:95], a[196:199], v[188:191]
ds_write_b64 v5, v[24:25] offset:11520
v_mfma_f32_16x16x32_bf16 v[188:191], a[96:99], a[200:203], v[188:191]
v_accvgpr_read_b32 v16, a48
v_accvgpr_read_b32 v17, a49
v_mfma_f32_16x16x32_bf16 v[188:191], a[100:103], a[204:207], v[188:191]
global_load_dwordx4 a[76:79], v3, s[20:21] offset:1024
v_accvgpr_read_b32 v18, a50
v_accvgpr_read_b32 v19, a51
v_mfma_f32_16x16x32_bf16 v[184:187], a[88:91], a[204:207], v[184:187]
ds_read_b128 a[192:195], v2 offset:4416
v_accvgpr_read_b32 v20, a52
v_mfma_f32_16x16x32_bf16 v[184:187], a[84:87], a[200:203], v[184:187]
v_accvgpr_read_b32 v21, a53
v_accvgpr_read_b32 v22, a54
v_mfma_f32_16x16x32_bf16 v[184:187], a[80:83], a[196:199], v[184:187]
v_accvgpr_read_b32 v23, a55
v_sub_f32 v16, v16, v248
v_mfma_f32_16x16x32_bf16 v[192:195], a[80:83], a[200:203], v[192:195]
v_sub_f32 v17, v17, v249
v_sub_f32 v18, v18, v250
v_mfma_f32_16x16x32_bf16 v[192:195], a[84:87], a[204:207], v[192:195]
v_sub_f32 v19, v19, v251
v_sub_f32 v20, v20, v252
v_sub_f32 v21, v21, v253
v_mfma_f32_16x16x32_bf16 v[192:195], a[88:91], a[208:211], v[192:195]
v_sub_f32 v22, v22, v254
v_sub_f32 v23, v23, v255
v_mfma_f32_16x16x32_bf16 v[196:199], a[100:103], a[208:211], v[196:199]
ds_read_b128 a[196:199], v2 offset:5472
v_med3_f32 v16, v16, -s22, s22
v_med3_f32 v17, v17, -s22, s22
v_mfma_f32_16x16x32_bf16 v[196:199], a[96:99], a[204:207], v[196:199]
v_med3_f32 v18, v18, -s22, s22
v_med3_f32 v19, v19, -s22, s22
v_mfma_f32_16x16x32_bf16 v[196:199], a[92:95], a[200:203], v[196:199]
s_waitcnt vmcnt(15) lgkmcnt(2)
v_exp_f32 v20, v20
v_mfma_f32_16x16x32_bf16 v[144:147], a[104:107], a[176:179], v[144:147]
s_mov_b32 s36, L_h9-L_pc
v_exp_f32 v21, v21
v_mfma_f32_16x16x32_bf16 v[144:147], a[108:111], a[180:183], v[144:147]
s_mov_b32 s30, L_end-L_pc
v_exp_f32 v22, v22
v_mfma_f32_16x16x32_bf16 v[144:147], a[112:115], a[184:187], v[144:147]
global_load_dwordx4 a[80:83], v3, s[20:21] offset:2048
v_exp_f32 v23, v23
v_mfma_f32_16x16x32_bf16 v[148:151], a[124:127], a[184:187], v[148:151]
ds_read_b128 a[200:203], v2 offset:6528
v_mfma_f32_16x16x32_bf16 v[148:151], a[120:123], a[180:183], v[148:151]
v_exp_f32 v16, v16
v_mfma_f32_16x16x32_bf16 v[148:151], a[116:119], a[176:179], v[148:151]
buffer_load_dword a252, v8, s[28:31], s36 offen
v_mfma_f32_16x16x32_bf16 v[156:159], a[116:119], a[180:183], v[156:159]
v_exp_f32 v17, v17
v_mfma_f32_16x16x32_bf16 v[156:159], a[120:123], a[184:187], v[156:159]
ds_read_b128 a[204:207], v2 offset:7584
v_exp_f32 v18, v18
v_mfma_f32_16x16x32_bf16 v[156:159], a[124:127], a[188:191], v[156:159]
global_load_dwordx4 a[84:87], v3, s[20:21] offset:3072
v_exp_f32 v19, v19
v_mfma_f32_16x16x32_bf16 v[152:155], a[112:115], a[188:191], v[152:155]
ds_read_b128 a[176:179], v2 offset:224
v_add_f32 v20, 1.0, v20
v_add_f32 v21, 1.0, v21
v_mfma_f32_16x16x32_bf16 v[152:155], a[108:111], a[184:187], v[152:155]
v_add_f32 v22, 1.0, v22
v_add_f32 v23, 1.0, v23
v_mfma_f32_16x16x32_bf16 v[152:155], a[104:107], a[180:183], v[152:155]
v_fmac_f32 v20, v16, v20
v_fmac_f32 v21, v17, v21
v_mfma_f32_16x16x32_bf16 v[160:163], a[104:107], a[184:187], v[160:163]
s_waitcnt lgkmcnt(3)
v_fmac_f32 v22, v18, v22
v_fmac_f32 v23, v19, v23
v_mfma_f32_16x16x32_bf16 v[160:163], a[108:111], a[188:191], v[160:163]
s_add_u32 s20, s20, 8192
s_addc_u32 s21, s21, 0
v_rcp_f32 v20, v20
v_mfma_f32_16x16x32_bf16 v[160:163], a[112:115], a[192:195], v[160:163]
ds_read_b128 a[208:211], v2 offset:8640
v_rcp_f32 v21, v21
v_mfma_f32_16x16x32_bf16 v[164:167], a[124:127], a[192:195], v[164:167]
global_load_dwordx4 a[88:91], v3, s[20:21] offset:-4096
v_mfma_f32_16x16x32_bf16 v[164:167], a[120:123], a[188:191], v[164:167]
ds_read_b128 a[180:183], v2 offset:1280
v_rcp_f32 v22, v22
v_mfma_f32_16x16x32_bf16 v[164:167], a[116:119], a[184:187], v[164:167]
v_rcp_f32 v23, v23
v_mfma_f32_16x16x32_bf16 v[172:175], a[116:119], a[188:191], v[172:175]
v_fma_f32 v16, v16, v20, -v20
v_fma_f32 v17, v17, v21, -v21
v_mfma_f32_16x16x32_bf16 v[172:175], a[120:123], a[192:195], v[172:175]
v_fma_f32 v18, v18, v22, -v22
v_fma_f32 v19, v19, v23, -v23
v_mfma_f32_16x16x32_bf16 v[172:175], a[124:127], a[196:199], v[172:175]
global_load_dwordx4 a[92:95], v3, s[20:21] offset:-3072
v_cvt_pk_bf16_f32 v16, v16, v17
v_cvt_pk_bf16_f32 v17, v18, v19
v_mfma_f32_16x16x32_bf16 v[168:171], a[112:115], a[196:199], v[168:171]
ds_write_b64 v5, v[16:17] offset:13824
v_mfma_f32_16x16x32_bf16 v[168:171], a[108:111], a[192:195], v[168:171]
ds_read_b128 a[184:187], v2 offset:2336
v_med3_f32 v200, v200, -s22, s22
v_med3_f32 v201, v201, -s22, s22
v_mfma_f32_16x16x32_bf16 v[168:171], a[104:107], a[188:191], v[168:171]
v_med3_f32 v202, v202, -s22, s22
v_med3_f32 v203, v203, -s22, s22
v_mfma_f32_16x16x32_bf16 v[176:179], a[104:107], a[192:195], v[176:179]
v_exp_f32 v204, v204
v_mfma_f32_16x16x32_bf16 v[176:179], a[108:111], a[196:199], v[176:179]
s_waitcnt lgkmcnt(3)
v_exp_f32 v205, v205
v_mfma_f32_16x16x32_bf16 v[176:179], a[112:115], a[200:203], v[176:179]
v_exp_f32 v206, v206
v_mfma_f32_16x16x32_bf16 v[180:183], a[124:127], a[200:203], v[180:183]
v_exp_f32 v207, v207
v_mfma_f32_16x16x32_bf16 v[180:183], a[120:123], a[196:199], v[180:183]
s_waitcnt lgkmcnt(0)
s_barrier
v_mfma_f32_16x16x32_bf16 v[180:183], a[116:119], a[192:195], v[180:183]
ds_read_b128 a[152:155], v6 offset:0
v_exp_f32 v200, v200
v_mfma_f32_16x16x32_bf16 v[188:191], a[116:119], a[196:199], v[188:191]
ds_read_b128 a[156:159], v6 offset:4608
v_exp_f32 v201, v201
v_mfma_f32_16x16x32_bf16 v[188:191], a[120:123], a[200:203], v[188:191]
ds_read_b128 a[160:163], v6 offset:9216
v_mfma_f32_16x16x32_bf16 v[188:191], a[124:127], a[204:207], v[188:191]
global_load_dwordx4 a[96:99], v3, s[20:21] offset:-2048
v_exp_f32 v202, v202
v_mfma_f32_16x16x32_bf16 v[184:187], a[112:115], a[204:207], v[184:187]
ds_read_b128 a[164:167], v6 offset:13824
v_exp_f32 v203, v203
v_mfma_f32_16x16x32_bf16 v[184:187], a[108:111], a[200:203], v[184:187]
ds_read_b128 a[188:191], v2 offset:3392
v_add_f32 v204, 1.0, v204
v_mfma_f32_16x16x32_bf16 v[184:187], a[104:107], a[196:199], v[184:187]
global_load_dwordx4 a[100:103], v3, s[20:21] offset:-1024
v_add_f32 v205, 1.0, v205
v_mfma_f32_16x16x32_bf16 v[192:195], a[104:107], a[200:203], v[192:195]
ds_read_b128 a[192:195], v2 offset:4448
v_add_f32 v206, 1.0, v206
v_mfma_f32_16x16x32_bf16 v[192:195], a[108:111], a[204:207], v[192:195]
v_add_f32 v207, 1.0, v207
v_fmac_f32 v204, v200, v204
v_mfma_f32_16x16x32_bf16 v[192:195], a[112:115], a[208:211], v[192:195]
s_waitcnt lgkmcnt(5)
v_fmac_f32 v205, v201, v205
v_fmac_f32 v206, v202, v206
v_mfma_f32_16x16x32_bf16 v[196:199], a[124:127], a[208:211], v[196:199]
ds_read_b128 a[196:199], v2 offset:5504
v_fmac_f32 v207, v203, v207
v_add_u32 v0, 3072, v7
v_mfma_f32_16x16x32_bf16 v[196:199], a[120:123], a[204:207], v[196:199]
buffer_store_dwordx4 a[152:155], v0, s[16:19], 0 offen nt
v_mfma_f32_16x16x32_bf16 v[196:199], a[116:119], a[200:203], v[196:199]
s_waitcnt vmcnt(19)
v_rcp_f32 v204, v204
v_mfma_f32_16x16x32_bf16 v[144:147], a[128:131], a[176:179], v[144:147]
ds_read_b128 a[200:203], v2 offset:6560
v_mfma_f32_16x16x32_bf16 v[144:147], a[132:135], a[180:183], v[144:147]
global_load_dwordx4 a[104:107], v3, s[20:21] offset:0
v_rcp_f32 v205, v205
v_mfma_f32_16x16x32_bf16 v[144:147], a[136:139], a[184:187], v[144:147]
s_waitcnt vmcnt(15)
ds_read_b128 a[204:207], v2 offset:7616
v_mfma_f32_16x16x32_bf16 v[148:151], a[148:151], a[184:187], v[148:151]
v_rcp_f32 v206, v206
v_mfma_f32_16x16x32_bf16 v[148:151], a[144:147], a[180:183], v[148:151]
ds_read_b128 a[208:211], v2 offset:8672
v_rcp_f32 v207, v207
v_mfma_f32_16x16x32_bf16 v[148:151], a[140:143], a[176:179], v[148:151]
v_fma_f32 v200, v200, v204, -v204
v_fma_f32 v201, v201, v205, -v205
v_mfma_f32_16x16x32_bf16 v[156:159], a[140:143], a[180:183], v[156:159]
s_waitcnt lgkmcnt(4)
v_fma_f32 v202, v202, v206, -v206
v_fma_f32 v203, v203, v207, -v207
v_mfma_f32_16x16x32_bf16 v[156:159], a[144:147], a[184:187], v[156:159]
global_load_dwordx4 a[108:111], v3, s[20:21] offset:1024
v_cvt_pk_bf16_f32 v200, v200, v201
v_cvt_pk_bf16_f32 v201, v202, v203
v_mfma_f32_16x16x32_bf16 v[156:159], a[148:151], a[188:191], v[156:159]
ds_write_b64 v5, v[200:201] offset:16128
v_mfma_f32_16x16x32_bf16 v[152:155], a[136:139], a[188:191], v[152:155]
v_med3_f32 v208, v208, -s22, s22
v_add_u32 v0, 13312, v7
v_med3_f32 v209, v209, -s22, s22
v_mfma_f32_16x16x32_bf16 v[152:155], a[132:135], a[184:187], v[152:155]
buffer_store_dwordx4 a[156:159], v0, s[16:19], 0 offen nt
v_mfma_f32_16x16x32_bf16 v[152:155], a[128:131], a[180:183], v[152:155]
v_med3_f32 v210, v210, -s22, s22
v_med3_f32 v211, v211, -s22, s22
v_mfma_f32_16x16x32_bf16 v[160:163], a[128:131], a[184:187], v[160:163]
v_exp_f32 v212, v212
v_mfma_f32_16x16x32_bf16 v[160:163], a[132:135], a[188:191], v[160:163]
global_load_dwordx4 a[112:115], v3, s[20:21] offset:2048
v_exp_f32 v213, v213
v_mfma_f32_16x16x32_bf16 v[160:163], a[136:139], a[192:195], v[160:163]
v_exp_f32 v214, v214
v_mfma_f32_16x16x32_bf16 v[164:167], a[148:151], a[192:195], v[164:167]
s_nop 0
v_exp_f32 v215, v215
v_exp_f32 v208, v208
v_exp_f32 v209, v209
v_exp_f32 v210, v210
s_waitcnt lgkmcnt(0)
s_barrier
v_mfma_f32_16x16x32_bf16 v[164:167], a[144:147], a[188:191], v[164:167]
ds_read_b128 a[176:179], v1 offset:0
v_mfma_f32_16x16x32_bf16 v[164:167], a[140:143], a[184:187], v[164:167]
v_exp_f32 v211, v211
v_mfma_f32_16x16x32_bf16 v[172:175], a[140:143], a[188:191], v[172:175]
s_add_u32 s8, s8, 3280896
s_addc_u32 s9, s9, 0
v_add_f32 v212, 1.0, v212
v_mfma_f32_16x16x32_bf16 v[172:175], a[144:147], a[192:195], v[172:175]
s_add_u32 m0, s23, 63360
v_add_u32 v0, 23552, v7
v_mfma_f32_16x16x32_bf16 v[172:175], a[148:151], a[196:199], v[172:175]
buffer_load_dwordx4 v4, s[8:11], 0 offen offset:0 lds
v_add_f32 v213, 1.0, v213
v_mfma_f32_16x16x32_bf16 v[168:171], a[136:139], a[196:199], v[168:171]
ds_read_b128 a[180:183], v1 offset:1056
v_add_f32 v214, 1.0, v214
v_mfma_f32_16x16x32_bf16 v[168:171], a[132:135], a[192:195], v[168:171]
ds_read_b128 a[184:187], v1 offset:2112
v_add_f32 v215, 1.0, v215
v_mfma_f32_16x16x32_bf16 v[168:171], a[128:131], a[188:191], v[168:171]
buffer_store_dwordx4 a[160:163], v0, s[16:19], 0 offen nt
v_mfma_f32_16x16x32_bf16 v[176:179], a[128:131], a[192:195], v[176:179]
v_fmac_f32 v212, v208, v212
v_fmac_f32 v213, v209, v213
v_mfma_f32_16x16x32_bf16 v[176:179], a[132:135], a[196:199], v[176:179]
v_fmac_f32 v214, v210, v214
v_fmac_f32 v215, v211, v215
v_mfma_f32_16x16x32_bf16 v[176:179], a[136:139], a[200:203], v[176:179]
global_load_dwordx4 a[116:119], v3, s[20:21] offset:3072
v_mfma_f32_16x16x32_bf16 v[180:183], a[148:151], a[200:203], v[180:183]
s_add_u32 s20, s20, 8192
s_addc_u32 s21, s21, 0
v_mfma_f32_16x16x32_bf16 v[180:183], a[144:147], a[196:199], v[180:183]
ds_read_b128 a[188:191], v1 offset:3168
v_rcp_f32 v212, v212
v_mfma_f32_16x16x32_bf16 v[180:183], a[140:143], a[192:195], v[180:183]
global_load_dwordx4 a[120:123], v3, s[20:21] offset:-4096
v_rcp_f32 v213, v213
v_mfma_f32_16x16x32_bf16 v[188:191], a[140:143], a[196:199], v[188:191]
v_rcp_f32 v214, v214
v_mfma_f32_16x16x32_bf16 v[188:191], a[144:147], a[200:203], v[188:191]
v_rcp_f32 v215, v215
v_mfma_f32_16x16x32_bf16 v[188:191], a[148:151], a[204:207], v[188:191]
global_load_dwordx4 a[124:127], v3, s[20:21] offset:-3072
v_fma_f32 v208, v208, v212, -v212
v_mfma_f32_16x16x32_bf16 v[184:187], a[136:139], a[204:207], v[184:187]
ds_read_b128 a[192:195], v1 offset:4224
v_add_u32 v0, 33792, v9
v_mfma_f32_16x16x32_bf16 v[184:187], a[132:135], a[200:203], v[184:187]
s_add_u32 m0, s23, 63392
v_fma_f32 v209, v209, v213, -v213
v_fma_f32 v210, v210, v214, -v214
v_mfma_f32_16x16x32_bf16 v[184:187], a[128:131], a[196:199], v[184:187]
buffer_store_dwordx4 a[164:167], v0, s[16:19], 0 offen nt
v_mfma_f32_16x16x32_bf16 v[192:195], a[128:131], a[200:203], v[192:195]
v_fma_f32 v211, v211, v215, -v215
v_cvt_pk_bf16_f32 v208, v208, v209
v_mfma_f32_16x16x32_bf16 v[192:195], a[132:135], a[204:207], v[192:195]
v_cvt_pk_bf16_f32 v209, v210, v211
v_med3_f32 v216, v216, -s22, s22
v_mfma_f32_16x16x32_bf16 v[192:195], a[136:139], a[208:211], v[192:195]
buffer_load_dwordx4 v4, s[8:11], 0 offen offset:1024 lds
v_med3_f32 v217, v217, -s22, s22
v_mfma_f32_16x16x32_bf16 v[196:199], a[148:151], a[208:211], v[196:199]
ds_write_b64 v5, v[208:209] offset:18432
v_mfma_f32_16x16x32_bf16 v[196:199], a[144:147], a[204:207], v[196:199]
ds_read_b128 a[196:199], v1 offset:5280
v_med3_f32 v218, v218, -s22, s22
v_med3_f32 v219, v219, -s22, s22
v_mfma_f32_16x16x32_bf16 v[196:199], a[140:143], a[200:203], v[196:199]
s_waitcnt vmcnt(22) lgkmcnt(3)
v_exp_f32 v220, v220
L_h8:
v_mfma_f32_16x16x32_bf16 v[32:35], a[56:59], a[176:179], v[32:35]
s_waitcnt vmcnt(19)
v_exp_f32 v221, v221
v_mfma_f32_16x16x32_bf16 v[32:35], a[60:63], a[180:183], v[32:35]
global_load_dwordx4 a[128:131], v3, s[20:21] offset:-2048
v_exp_f32 v222, v222
v_mfma_f32_16x16x32_bf16 v[32:35], a[64:67], a[184:187], v[32:35]
ds_read_b128 a[200:203], v1 offset:6336
v_exp_f32 v223, v223
v_mfma_f32_16x16x32_bf16 v[36:39], a[76:79], a[184:187], v[36:39]
v_exp_f32 v216, v216
v_mfma_f32_16x16x32_bf16 v[36:39], a[72:75], a[180:183], v[36:39]
v_exp_f32 v217, v217
v_mfma_f32_16x16x32_bf16 v[36:39], a[68:71], a[176:179], v[36:39]
v_exp_f32 v218, v218
v_mfma_f32_16x16x32_bf16 v[44:47], a[68:71], a[180:183], v[44:47]
v_exp_f32 v219, v219
v_mfma_f32_16x16x32_bf16 v[44:47], a[72:75], a[184:187], v[44:47]
global_load_dwordx4 a[132:135], v3, s[20:21] offset:-1024
v_add_f32 v220, 1.0, v220
v_mfma_f32_16x16x32_bf16 v[44:47], a[76:79], a[188:191], v[44:47]
s_add_u32 m0, s23, 63424
v_add_f32 v221, 1.0, v221
v_add_f32 v222, 1.0, v222
v_add_f32 v223, 1.0, v223
v_mfma_f32_16x16x32_bf16 v[40:43], a[64:67], a[188:191], v[40:43]
ds_read_b128 a[204:207], v1 offset:7392
v_fmac_f32 v220, v216, v220
v_mfma_f32_16x16x32_bf16 v[40:43], a[60:63], a[184:187], v[40:43]
buffer_load_dwordx4 v4, s[8:11], 0 offen offset:2048 lds
v_fmac_f32 v221, v217, v221
v_mfma_f32_16x16x32_bf16 v[40:43], a[56:59], a[180:183], v[40:43]
ds_read_b128 a[176:179], v1 offset:32
v_fmac_f32 v222, v218, v222
v_mfma_f32_16x16x32_bf16 v[48:51], a[56:59], a[184:187], v[48:51]
s_waitcnt lgkmcnt(2)
v_fmac_f32 v223, v219, v223
v_mfma_f32_16x16x32_bf16 v[48:51], a[60:63], a[188:191], v[48:51]
ds_read_b128 a[208:211], v1 offset:8448
v_rcp_f32 v220, v220
v_mfma_f32_16x16x32_bf16 v[48:51], a[64:67], a[192:195], v[48:51]
global_load_dwordx4 a[136:139], v3, s[20:21] offset:0
v_rcp_f32 v221, v221
v_mfma_f32_16x16x32_bf16 v[52:55], a[76:79], a[192:195], v[52:55]
ds_read_b128 a[180:183], v1 offset:1088
v_rcp_f32 v222, v222
v_mfma_f32_16x16x32_bf16 v[52:55], a[72:75], a[188:191], v[52:55]
v_rcp_f32 v223, v223
v_sub_f32 v32, v32, v144
v_mfma_f32_16x16x32_bf16 v[52:55], a[68:71], a[184:187], v[52:55]
v_sub_f32 v33, v33, v145
v_fma_f32 v216, v216, v220, -v220
v_sub_f32 v34, v34, v146
v_mfma_f32_16x16x32_bf16 v[60:63], a[68:71], a[188:191], v[60:63]
v_fma_f32 v217, v217, v221, -v221
v_fma_f32 v218, v218, v222, -v222
v_sub_f32 v35, v35, v147
v_mfma_f32_16x16x32_bf16 v[60:63], a[72:75], a[192:195], v[60:63]
v_sub_f32 v36, v36, v148
v_fma_f32 v219, v219, v223, -v223
v_cvt_pk_bf16_f32 v216, v216, v217
v_mfma_f32_16x16x32_bf16 v[60:63], a[76:79], a[196:199], v[60:63]
global_load_dwordx4 a[140:143], v3, s[20:21] offset:1024
v_sub_f32 v37, v37, v149
v_cvt_pk_bf16_f32 v217, v218, v219
v_mfma_f32_16x16x32_bf16 v[56:59], a[64:67], a[196:199], v[56:59]
ds_write_b64 v5, v[216:217] offset:20736
v_mfma_f32_16x16x32_bf16 v[56:59], a[60:63], a[192:195], v[56:59]
ds_read_b128 a[184:187], v1 offset:2144
v_sub_f32 v38, v38, v150
v_sub_f32 v39, v39, v151
v_mfma_f32_16x16x32_bf16 v[56:59], a[56:59], a[188:191], v[56:59]
v_med3_f32 v224, v224, -s22, s22
v_sub_f32 v40, v40, v152
v_med3_f32 v225, v225, -s22, s22
v_mfma_f32_16x16x32_bf16 v[64:67], a[56:59], a[192:195], v[64:67]
s_add_u32 m0, s23, 63456
v_med3_f32 v226, v226, -s22, s22
v_sub_f32 v41, v41, v153
v_med3_f32 v227, v227, -s22, s22
v_mfma_f32_16x16x32_bf16 v[64:67], a[60:63], a[196:199], v[64:67]
buffer_load_dwordx4 v4, s[8:11], 0 offen offset:3072 lds
v_sub_f32 v42, v42, v154
v_mfma_f32_16x16x32_bf16 v[64:67], a[64:67], a[200:203], v[64:67]
v_exp_f32 v228, v228
v_sub_f32 v43, v43, v155
v_mfma_f32_16x16x32_bf16 v[68:71], a[76:79], a[200:203], v[68:71]
ds_read_b128 a[188:191], v1 offset:3200
v_sub_f32 v44, v44, v156
v_mfma_f32_16x16x32_bf16 v[68:71], a[72:75], a[196:199], v[68:71]
global_load_dwordx4 a[144:147], v3, s[20:21] offset:2048
v_exp_f32 v229, v229
v_mfma_f32_16x16x32_bf16 v[68:71], a[68:71], a[192:195], v[68:71]
v_sub_f32 v45, v45, v157
v_exp_f32 v230, v230
v_mfma_f32_16x16x32_bf16 v[76:79], a[68:71], a[196:199], v[76:79]
v_sub_f32 v46, v46, v158
v_sub_f32 v47, v47, v159
v_mfma_f32_16x16x32_bf16 v[76:79], a[72:75], a[200:203], v[76:79]
s_waitcnt lgkmcnt(2)
v_exp_f32 v231, v231
v_sub_f32 v48, v48, v160
v_mfma_f32_16x16x32_bf16 v[76:79], a[76:79], a[204:207], v[76:79]
v_exp_f32 v224, v224
v_sub_f32 v49, v49, v161
v_mfma_f32_16x16x32_bf16 v[72:75], a[64:67], a[204:207], v[72:75]
v_exp_f32 v225, v225
v_sub_f32 v50, v50, v162
v_mfma_f32_16x16x32_bf16 v[72:75], a[60:63], a[200:203], v[72:75]
v_sub_f32 v51, v51, v163
v_sub_f32 v52, v52, v164
v_mfma_f32_16x16x32_bf16 v[72:75], a[56:59], a[196:199], v[72:75]
global_load_dwordx4 a[148:151], v3, s[20:21] offset:3072
v_exp_f32 v226, v226
v_mfma_f32_16x16x32_bf16 v[80:83], a[56:59], a[200:203], v[80:83]
ds_read_b128 a[192:195], v1 offset:4256
v_sub_f32 v53, v53, v165
v_mfma_f32_16x16x32_bf16 v[80:83], a[60:63], a[204:207], v[80:83]
v_exp_f32 v227, v227
v_sub_f32 v54, v54, v166
v_mfma_f32_16x16x32_bf16 v[80:83], a[64:67], a[208:211], v[80:83]
v_add_f32 v228, 1.0, v228
v_sub_f32 v55, v55, v167
v_add_f32 v229, 1.0, v229
v_mfma_f32_16x16x32_bf16 v[84:87], a[76:79], a[208:211], v[84:87]
v_sub_f32 v56, v56, v168
v_add_f32 v230, 1.0, v230
v_add_f32 v231, 1.0, v231
v_mfma_f32_16x16x32_bf16 v[84:87], a[72:75], a[204:207], v[84:87]
v_sub_f32 v57, v57, v169
v_fmac_f32 v228, v224, v228
v_sub_f32 v58, v58, v170
v_fmac_f32 v229, v225, v229
v_mfma_f32_16x16x32_bf16 v[84:87], a[68:71], a[200:203], v[84:87]
s_waitcnt vmcnt(23) lgkmcnt(1)
v_sub_f32 v59, v59, v171
v_fmac_f32 v230, v226, v230
v_sub_f32 v60, v60, v172
v_mfma_f32_16x16x32_bf16 v[32:35], a[80:83], a[176:179], v[32:35]
s_add_u32 m0, s23, 67584
v_fmac_f32 v231, v227, v231
v_rcp_f32 v228, v228
v_mfma_f32_16x16x32_bf16 v[32:35], a[84:87], a[180:183], v[32:35]
ds_read_b128 a[196:199], v1 offset:5312
v_sub_f32 v61, v61, v173
v_sub_f32 v62, v62, v174
v_mfma_f32_16x16x32_bf16 v[32:35], a[88:91], a[184:187], v[32:35]
s_waitcnt vmcnt(20)
buffer_load_dwordx4 v4, s[8:11], s12 offen offset:0 lds
v_rcp_f32 v229, v229
v_mfma_f32_16x16x32_bf16 v[36:39], a[100:103], a[184:187], v[36:39]
v_sub_f32 v63, v63, v175
v_rcp_f32 v230, v230
v_sub_f32 v64, v64, v176
v_mfma_f32_16x16x32_bf16 v[36:39], a[96:99], a[180:183], v[36:39]
s_add_u32 s20, s20, 8192
s_addc_u32 s21, s21, 0
v_rcp_f32 v231, v231
v_sub_f32 v65, v65, v177
v_mfma_f32_16x16x32_bf16 v[36:39], a[92:95], a[176:179], v[36:39]
global_load_dwordx4 a[56:59], v3, s[20:21] offset:-4096
v_sub_f32 v66, v66, v178
v_fma_f32 v224, v224, v228, -v228
v_fma_f32 v225, v225, v229, -v229
v_mfma_f32_16x16x32_bf16 v[44:47], a[92:95], a[180:183], v[44:47]
ds_read_b128 a[200:203], v1 offset:6368
v_sub_f32 v67, v67, v179
v_sub_f32 v68, v68, v180
v_fma_f32 v226, v226, v230, -v230
v_mfma_f32_16x16x32_bf16 v[44:47], a[96:99], a[184:187], v[44:47]
v_fma_f32 v227, v227, v231, -v231
v_sub_f32 v69, v69, v181
v_cvt_pk_bf16_f32 v224, v224, v225
v_sub_f32 v70, v70, v182
v_mfma_f32_16x16x32_bf16 v[44:47], a[100:103], a[188:191], v[44:47]
v_cvt_pk_bf16_f32 v225, v226, v227
v_sub_f32 v71, v71, v183
v_sub_f32 v72, v72, v184
v_med3_f32 v232, v232, -s22, s22
v_mfma_f32_16x16x32_bf16 v[40:43], a[88:91], a[188:191], v[40:43]
ds_write_b64 v5, v[224:225] offset:23040
v_sub_f32 v73, v73, v185
v_mfma_f32_16x16x32_bf16 v[40:43], a[84:87], a[184:187], v[40:43]
global_load_dwordx4 a[60:63], v3, s[20:21] offset:-3072
v_med3_f32 v233, v233, -s22, s22
v_sub_f32 v74, v74, v186
v_med3_f32 v234, v234, -s22, s22
v_mfma_f32_16x16x32_bf16 v[40:43], a[80:83], a[180:183], v[40:43]
ds_read_b128 a[204:207], v1 offset:7424
v_sub_f32 v75, v75, v187
v_med3_f32 v235, v235, -s22, s22
v_mfma_f32_16x16x32_bf16 v[48:51], a[80:83], a[184:187], v[48:51]
ds_read_b128 a[176:179], v1 offset:64
v_exp_f32 v236, v236
v_mfma_f32_16x16x32_bf16 v[48:51], a[84:87], a[188:191], v[48:51]
s_waitcnt lgkmcnt(4)
v_sub_f32 v76, v76, v188
v_sub_f32 v77, v77, v189
v_mfma_f32_16x16x32_bf16 v[48:51], a[88:91], a[192:195], v[48:51]
v_exp_f32 v237, v237
v_sub_f32 v78, v78, v190
v_mfma_f32_16x16x32_bf16 v[52:55], a[100:103], a[192:195], v[52:55]
v_exp_f32 v238, v238
v_sub_f32 v79, v79, v191
v_mfma_f32_16x16x32_bf16 v[52:55], a[96:99], a[188:191], v[52:55]
ds_read_b128 a[208:211], v1 offset:8480
v_exp_f32 v239, v239
v_mfma_f32_16x16x32_bf16 v[52:55], a[92:95], a[184:187], v[52:55]
s_add_u32 m0, s23, 67616
v_sub_f32 v80, v80, v192
v_sub_f32 v81, v81, v193
v_mfma_f32_16x16x32_bf16 v[60:63], a[92:95], a[188:191], v[60:63]
global_load_dwordx4 a[64:67], v3, s[20:21] offset:-2048
v_exp_f32 v232, v232
v_mfma_f32_16x16x32_bf16 v[60:63], a[96:99], a[192:195], v[60:63]
ds_read_b128 a[180:183], v1 offset:1120
v_sub_f32 v82, v82, v194
v_sub_f32 v83, v83, v195
v_mfma_f32_16x16x32_bf16 v[60:63], a[100:103], a[196:199], v[60:63]
v_exp_f32 v233, v233
v_sub_f32 v84, v84, v196
v_mfma_f32_16x16x32_bf16 v[56:59], a[88:91], a[196:199], v[56:59]
buffer_load_dwordx4 v4, s[8:11], s12 offen offset:1024 lds
v_sub_f32 v85, v85, v197
v_mfma_f32_16x16x32_bf16 v[56:59], a[84:87], a[192:195], v[56:59]
v_exp_f32 v234, v234
v_sub_f32 v86, v86, v198
v_mfma_f32_16x16x32_bf16 v[56:59], a[80:83], a[188:191], v[56:59]
ds_read_b128 a[184:187], v1 offset:2176
v_exp_f32 v235, v235
v_mfma_f32_16x16x32_bf16 v[64:67], a[80:83], a[192:195], v[64:67]
global_load_dwordx4 a[68:71], v3, s[20:21] offset:-1024
v_sub_f32 v87, v87, v199
v_add_f32 v236, 1.0, v236
v_mfma_f32_16x16x32_bf16 v[64:67], a[84:87], a[196:199], v[64:67]
s_waitcnt lgkmcnt(3)
v_add_f32 v237, 1.0, v237
v_add_f32 v238, 1.0, v238
v_add_f32 v239, 1.0, v239
v_mfma_f32_16x16x32_bf16 v[64:67], a[88:91], a[200:203], v[64:67]
v_fmac_f32 v236, v232, v236
v_fmac_f32 v237, v233, v237
v_fmac_f32 v238, v234, v238
v_mfma_f32_16x16x32_bf16 v[68:71], a[100:103], a[200:203], v[68:71]
global_load_dwordx4 a[72:75], v3, s[20:21] offset:0
v_fmac_f32 v239, v235, v239
v_mfma_f32_16x16x32_bf16 v[68:71], a[96:99], a[196:199], v[68:71]
ds_read_b128 a[188:191], v1 offset:3232
v_rcp_f32 v236, v236
v_mfma_f32_16x16x32_bf16 v[68:71], a[92:95], a[192:195], v[68:71]
v_rcp_f32 v237, v237
v_mfma_f32_16x16x32_bf16 v[76:79], a[92:95], a[196:199], v[76:79]
s_add_u32 m0, s23, 67648
v_rcp_f32 v238, v238
v_mfma_f32_16x16x32_bf16 v[76:79], a[96:99], a[200:203], v[76:79]
buffer_load_dwordx4 v4, s[8:11], s12 offen offset:2048 lds
v_mfma_f32_16x16x32_bf16 v[76:79], a[100:103], a[204:207], v[76:79]
v_rcp_f32 v239, v239
v_fma_f32 v232, v232, v236, -v236
v_mfma_f32_16x16x32_bf16 v[72:75], a[88:91], a[204:207], v[72:75]
ds_read_b128 a[192:195], v1 offset:4288
v_fma_f32 v233, v233, v237, -v237
v_fma_f32 v234, v234, v238, -v238
v_mfma_f32_16x16x32_bf16 v[72:75], a[84:87], a[200:203], v[72:75]
global_load_dwordx4 a[76:79], v3, s[20:21] offset:1024
v_fma_f32 v235, v235, v239, -v239
v_cvt_pk_bf16_f32 v232, v232, v233
v_mfma_f32_16x16x32_bf16 v[72:75], a[80:83], a[196:199], v[72:75]
v_cvt_pk_bf16_f32 v233, v234, v235
v_med3_f32 v240, v240, -s22, s22
v_med3_f32 v241, v241, -s22, s22
v_mfma_f32_16x16x32_bf16 v[80:83], a[80:83], a[200:203], v[80:83]
ds_write_b64 v5, v[232:233] offset:25344
v_mfma_f32_16x16x32_bf16 v[80:83], a[84:87], a[204:207], v[80:83]
s_waitcnt lgkmcnt(3)
v_med3_f32 v242, v242, -s22, s22
v_med3_f32 v243, v243, -s22, s22
v_mfma_f32_16x16x32_bf16 v[80:83], a[88:91], a[208:211], v[80:83]
v_exp_f32 v244, v244
v_mfma_f32_16x16x32_bf16 v[84:87], a[100:103], a[208:211], v[84:87]
ds_read_b128 a[196:199], v1 offset:5344
v_exp_f32 v245, v245
v_mfma_f32_16x16x32_bf16 v[84:87], a[96:99], a[204:207], v[84:87]
v_exp_f32 v246, v246
v_mfma_f32_16x16x32_bf16 v[84:87], a[92:95], a[200:203], v[84:87]
s_waitcnt vmcnt(24)
v_exp_f32 v247, v247
v_mfma_f32_16x16x32_bf16 v[32:35], a[104:107], a[176:179], v[32:35]
s_waitcnt vmcnt(19)
v_exp_f32 v240, v240
v_mfma_f32_16x16x32_bf16 v[32:35], a[108:111], a[180:183], v[32:35]
global_load_dwordx4 a[80:83], v3, s[20:21] offset:2048
v_exp_f32 v241, v241
v_mfma_f32_16x16x32_bf16 v[32:35], a[112:115], a[184:187], v[32:35]
ds_read_b128 a[200:203], v1 offset:6400
v_exp_f32 v242, v242
v_mfma_f32_16x16x32_bf16 v[36:39], a[124:127], a[184:187], v[36:39]
L_stub10:
s_cmp_eq_u32 s37, 1
s_cbranch_scc1 L_wret0
v_exp_f32 v243, v243
v_add_f32 v244, 1.0, v244
v_mfma_f32_16x16x32_bf16 v[36:39], a[120:123], a[180:183], v[36:39]
s_add_u32 m0, s23, 67680
v_add_f32 v245, 1.0, v245
v_add_f32 v246, 1.0, v246
v_add_f32 v247, 1.0, v247
v_mfma_f32_16x16x32_bf16 v[36:39], a[116:119], a[176:179], v[36:39]
buffer_load_dwordx4 v4, s[8:11], s12 offen offset:3072 lds
v_fmac_f32 v244, v240, v244
v_mfma_f32_16x16x32_bf16 v[44:47], a[116:119], a[180:183], v[44:47]
s_waitcnt lgkmcnt(2)
v_fmac_f32 v245, v241, v245
v_fmac_f32 v246, v242, v246
v_fmac_f32 v247, v243, v247
v_mfma_f32_16x16x32_bf16 v[44:47], a[120:123], a[184:187], v[44:47]
ds_read_b128 a[204:207], v1 offset:7456
v_rcp_f32 v244, v244
v_mfma_f32_16x16x32_bf16 v[44:47], a[124:127], a[188:191], v[44:47]
global_load_dwordx4 a[84:87], v3, s[20:21] offset:3072
v_rcp_f32 v245, v245
v_mfma_f32_16x16x32_bf16 v[40:43], a[112:115], a[188:191], v[40:43]
ds_read_b128 a[176:179], v1 offset:96
v_rcp_f32 v246, v246
v_mfma_f32_16x16x32_bf16 v[40:43], a[108:111], a[184:187], v[40:43]
v_rcp_f32 v247, v247
v_fma_f32 v240, v240, v244, -v244
v_mfma_f32_16x16x32_bf16 v[40:43], a[104:107], a[180:183], v[40:43]
v_fma_f32 v241, v241, v245, -v245
v_fma_f32 v242, v242, v246, -v246
v_mfma_f32_16x16x32_bf16 v[48:51], a[104:107], a[184:187], v[48:51]
v_fma_f32 v243, v243, v247, -v247
v_cvt_pk_bf16_f32 v240, v240, v241
v_cvt_pk_bf16_f32 v241, v242, v243
v_mfma_f32_16x16x32_bf16 v[48:51], a[108:111], a[188:191], v[48:51]
s_add_u32 s20, s20, 8192
s_addc_u32 s21, s21, 0
v_med3_f32 v248, v248, -s22, s22
v_mfma_f32_16x16x32_bf16 v[48:51], a[112:115], a[192:195], v[48:51]
ds_write_b64 v5, v[240:241] offset:27648
v_mfma_f32_16x16x32_bf16 v[52:55], a[124:127], a[192:195], v[52:55]
ds_read_b128 a[208:211], v1 offset:8512
v_med3_f32 v249, v249, -s22, s22
v_med3_f32 v250, v250, -s22, s22
v_mfma_f32_16x16x32_bf16 v[52:55], a[120:123], a[188:191], v[52:55]
global_load_dwordx4 a[88:91], v3, s[20:21] offset:-4096
v_med3_f32 v251, v251, -s22, s22
v_mfma_f32_16x16x32_bf16 v[52:55], a[116:119], a[184:187], v[52:55]
ds_read_b128 a[180:183], v1 offset:1152
v_exp_f32 v252, v252
v_mfma_f32_16x16x32_bf16 v[60:63], a[116:119], a[188:191], v[60:63]
v_exp_f32 v253, v253
v_mfma_f32_16x16x32_bf16 v[60:63], a[120:123], a[192:195], v[60:63]
s_waitcnt lgkmcnt(3)
v_exp_f32 v254, v254
v_mfma_f32_16x16x32_bf16 v[60:63], a[124:127], a[196:199], v[60:63]
s_add_u32 m0, s23, 71808
v_exp_f32 v255, v255
v_mfma_f32_16x16x32_bf16 v[56:59], a[112:115], a[196:199], v[56:59]
global_load_dwordx4 a[92:95], v3, s[20:21] offset:-3072
v_exp_f32 v248, v248
v_mfma_f32_16x16x32_bf16 v[56:59], a[108:111], a[192:195], v[56:59]
ds_read_b128 a[184:187], v1 offset:2208
v_mfma_f32_16x16x32_bf16 v[56:59], a[104:107], a[188:191], v[56:59]
v_exp_f32 v249, v249
v_mfma_f32_16x16x32_bf16 v[64:67], a[104:107], a[192:195], v[64:67]
buffer_load_dwordx4 v4, s[8:11], s13 offen offset:0 lds
v_mfma_f32_16x16x32_bf16 v[64:67], a[108:111], a[196:199], v[64:67]
v_exp_f32 v250, v250
v_mfma_f32_16x16x32_bf16 v[64:67], a[112:115], a[200:203], v[64:67]
v_exp_f32 v251, v251
v_add_f32 v252, 1.0, v252
v_mfma_f32_16x16x32_bf16 v[68:71], a[124:127], a[200:203], v[68:71]
global_load_dwordx4 a[96:99], v3, s[20:21] offset:-2048
v_add_f32 v253, 1.0, v253
v_add_f32 v254, 1.0, v254
v_mfma_f32_16x16x32_bf16 v[68:71], a[120:123], a[196:199], v[68:71]
ds_read_b128 a[188:191], v1 offset:3264
v_add_f32 v255, 1.0, v255
v_mfma_f32_16x16x32_bf16 v[68:71], a[116:119], a[192:195], v[68:71]
v_fmac_f32 v252, v248, v252
v_fmac_f32 v253, v249, v253
v_mfma_f32_16x16x32_bf16 v[76:79], a[116:119], a[196:199], v[76:79]
v_fmac_f32 v254, v250, v254
v_fmac_f32 v255, v251, v255
v_mfma_f32_16x16x32_bf16 v[76:79], a[120:123], a[200:203], v[76:79]
v_rcp_f32 v252, v252
v_mfma_f32_16x16x32_bf16 v[76:79], a[124:127], a[204:207], v[76:79]
global_load_dwordx4 a[100:103], v3, s[20:21] offset:-1024
v_rcp_f32 v253, v253
v_mfma_f32_16x16x32_bf16 v[72:75], a[112:115], a[204:207], v[72:75]
ds_read_b128 a[192:195], v1 offset:4320
v_mfma_f32_16x16x32_bf16 v[72:75], a[108:111], a[200:203], v[72:75]
v_rcp_f32 v254, v254
v_mfma_f32_16x16x32_bf16 v[72:75], a[104:107], a[196:199], v[72:75]
v_rcp_f32 v255, v255
v_mfma_f32_16x16x32_bf16 v[80:83], a[104:107], a[200:203], v[80:83]
s_add_u32 m0, s23, 71840
v_fma_f32 v248, v248, v252, -v252
v_fma_f32 v249, v249, v253, -v253
v_fma_f32 v250, v250, v254, -v254
v_mfma_f32_16x16x32_bf16 v[80:83], a[108:111], a[204:207], v[80:83]
s_waitcnt lgkmcnt(2)
buffer_load_dwordx4 v4, s[8:11], s13 offen offset:1024 lds
v_mfma_f32_16x16x32_bf16 v[80:83], a[112:115], a[208:211], v[80:83]
v_fma_f32 v251, v251, v255, -v255
v_cvt_pk_bf16_f32 v248, v248, v249
v_cvt_pk_bf16_f32 v249, v250, v251
v_mfma_f32_16x16x32_bf16 v[84:87], a[124:127], a[208:211], v[84:87]
ds_write_b64 v5, v[248:249] offset:29952
v_mfma_f32_16x16x32_bf16 v[84:87], a[120:123], a[204:207], v[84:87]
ds_read_b128 a[196:199], v1 offset:5376
v_sub_f32 v88, v88, v144
v_mfma_f32_16x16x32_bf16 v[84:87], a[116:119], a[200:203], v[84:87]
s_waitcnt vmcnt(22)
v_sub_f32 v89, v89, v145
v_sub_f32 v90, v90, v146
v_mfma_f32_16x16x32_bf16 v[32:35], a[128:131], a[176:179], v[32:35]
v_sub_f32 v91, v91, v147
v_sub_f32 v92, v92, v148
v_mfma_f32_16x16x32_bf16 v[32:35], a[132:135], a[180:183], v[32:35]
v_sub_f32 v93, v93, v149
v_sub_f32 v94, v94, v150
v_mfma_f32_16x16x32_bf16 v[32:35], a[136:139], a[184:187], v[32:35]
s_waitcnt vmcnt(18)
v_sub_f32 v95, v95, v151
v_mfma_f32_16x16x32_bf16 v[36:39], a[148:151], a[184:187], v[36:39]
s_waitcnt lgkmcnt(0)
s_barrier
v_sub_f32 v96, v96, v152
v_sub_f32 v97, v97, v153
v_mfma_f32_16x16x32_bf16 v[36:39], a[144:147], a[180:183], v[36:39]
ds_read_b128 a[152:155], v6 offset:16128
v_sub_f32 v98, v98, v154
v_sub_f32 v99, v99, v155
v_mfma_f32_16x16x32_bf16 v[36:39], a[140:143], a[176:179], v[36:39]
ds_read_b128 a[156:159], v6 offset:20736
v_sub_f32 v100, v100, v156
v_mfma_f32_16x16x32_bf16 v[44:47], a[140:143], a[180:183], v[44:47]
ds_read_b128 a[160:163], v6 offset:25344
v_sub_f32 v101, v101, v157
v_mfma_f32_16x16x32_bf16 v[44:47], a[144:147], a[184:187], v[44:47]
ds_read_b128 a[164:167], v6 offset:29952
v_sub_f32 v102, v102, v158
v_mfma_f32_16x16x32_bf16 v[44:47], a[148:151], a[188:191], v[44:47]
global_load_dwordx4 a[104:107], v3, s[20:21] offset:0
v_sub_f32 v103, v103, v159
v_mfma_f32_16x16x32_bf16 v[40:43], a[136:139], a[188:191], v[40:43]
ds_read_b128 a[200:203], v1 offset:6432
v_sub_f32 v104, v104, v160
v_sub_f32 v105, v105, v161
v_mfma_f32_16x16x32_bf16 v[40:43], a[132:135], a[184:187], v[40:43]
s_add_u32 m0, s23, 71872
v_sub_f32 v106, v106, v162
v_sub_f32 v107, v107, v163
v_mfma_f32_16x16x32_bf16 v[40:43], a[128:131], a[180:183], v[40:43]
global_load_dwordx4 a[108:111], v3, s[20:21] offset:1024
v_add_u32 v0, 1024, v7
v_mfma_f32_16x16x32_bf16 v[48:51], a[128:131], a[184:187], v[48:51]
ds_read_b128 a[204:207], v1 offset:7488
v_sub_f32 v108, v108, v164
v_mfma_f32_16x16x32_bf16 v[48:51], a[132:135], a[188:191], v[48:51]
ds_read_b128 a[176:179], v1 offset:128
v_sub_f32 v109, v109, v165
v_mfma_f32_16x16x32_bf16 v[48:51], a[136:139], a[192:195], v[48:51]
s_waitcnt lgkmcnt(6)
buffer_store_dwordx4 a[152:155], v0, s[16:19], 0 offen nt
v_mfma_f32_16x16x32_bf16 v[52:55], a[148:151], a[192:195], v[52:55]
ds_read_b128 a[208:211], v1 offset:8544
v_sub_f32 v110, v110, v166
v_mfma_f32_16x16x32_bf16 v[52:55], a[144:147], a[188:191], v[52:55]
ds_read_b128 a[180:183], v1 offset:1184
v_sub_f32 v111, v111, v167
v_mfma_f32_16x16x32_bf16 v[52:55], a[140:143], a[184:187], v[52:55]
buffer_load_dwordx4 v4, s[8:11], s13 offen offset:2048 lds
v_mfma_f32_16x16x32_bf16 v[60:63], a[140:143], a[188:191], v[60:63]
v_sub_f32 v112, v112, v168
v_sub_f32 v113, v113, v169
v_mfma_f32_16x16x32_bf16 v[60:63], a[144:147], a[192:195], v[60:63]
v_sub_f32 v114, v114, v170
v_sub_f32 v115, v115, v171
v_mfma_f32_16x16x32_bf16 v[60:63], a[148:151], a[196:199], v[60:63]
global_load_dwordx4 a[112:115], v3, s[20:21] offset:2048
v_sub_f32 v116, v116, v172
v_sub_f32 v117, v117, v173
v_mfma_f32_16x16x32_bf16 v[56:59], a[136:139], a[196:199], v[56:59]
ds_read_b128 a[184:187], v1 offset:2240
v_sub_f32 v118, v118, v174
v_mfma_f32_16x16x32_bf16 v[56:59], a[132:135], a[192:195], v[56:59]
s_waitcnt lgkmcnt(4)
v_sub_f32 v119, v119, v175
v_add_u32 v0, 11264, v7
v_mfma_f32_16x16x32_bf16 v[56:59], a[128:131], a[188:191], v[56:59]
buffer_store_dwordx4 a[156:159], v0, s[16:19], 0 offen nt
v_mfma_f32_16x16x32_bf16 v[64:67], a[128:131], a[192:195], v[64:67]
v_sub_f32 v120, v120, v176
v_sub_f32 v121, v121, v177
v_mfma_f32_16x16x32_bf16 v[64:67], a[132:135], a[196:199], v[64:67]
v_sub_f32 v122, v122, v178
v_sub_f32 v123, v123, v179
v_mfma_f32_16x16x32_bf16 v[64:67], a[136:139], a[200:203], v[64:67]
s_add_u32 m0, s23, 71904
v_sub_f32 v124, v124, v180
v_sub_f32 v125, v125, v181
v_mfma_f32_16x16x32_bf16 v[68:71], a[148:151], a[200:203], v[68:71]
global_load_dwordx4 a[116:119], v3, s[20:21] offset:3072
v_sub_f32 v126, v126, v182
v_mfma_f32_16x16x32_bf16 v[68:71], a[144:147], a[196:199], v[68:71]
s_add_u32 s20, s20, 8192
s_addc_u32 s21, s21, 0
v_sub_f32 v127, v127, v183
v_mfma_f32_16x16x32_bf16 v[68:71], a[140:143], a[192:195], v[68:71]
ds_read_b128 a[188:191], v1 offset:3296
v_sub_f32 v128, v128, v184
v_mfma_f32_16x16x32_bf16 v[76:79], a[140:143], a[196:199], v[76:79]
buffer_load_dwordx4 v4, s[8:11], s13 offen offset:3072 lds
v_mfma_f32_16x16x32_bf16 v[76:79], a[144:147], a[200:203], v[76:79]
v_sub_f32 v129, v129, v185
v_sub_f32 v130, v130, v186
v_sub_f32 v131, v131, v187
v_mfma_f32_16x16x32_bf16 v[76:79], a[148:151], a[204:207], v[76:79]
v_add_u32 v0, 21504, v7
v_sub_f32 v132, v132, v188
v_sub_f32 v133, v133, v189
v_mfma_f32_16x16x32_bf16 v[72:75], a[136:139], a[204:207], v[72:75]
global_load_dwordx4 a[120:123], v3, s[20:21] offset:-4096
v_sub_f32 v134, v134, v190
v_mfma_f32_16x16x32_bf16 v[72:75], a[132:135], a[200:203], v[72:75]
ds_read_b128 a[192:195], v1 offset:4352
v_sub_f32 v135, v135, v191
v_mfma_f32_16x16x32_bf16 v[72:75], a[128:131], a[196:199], v[72:75]
v_sub_f32 v136, v136, v192
v_sub_f32 v137, v137, v193
v_mfma_f32_16x16x32_bf16 v[80:83], a[128:131], a[200:203], v[80:83]
buffer_store_dwordx4 a[160:163], v0, s[16:19], 0 offen nt
v_mfma_f32_16x16x32_bf16 v[80:83], a[132:135], a[204:207], v[80:83]
s_waitcnt lgkmcnt(2)
v_sub_f32 v138, v138, v194
v_sub_f32 v139, v139, v195
v_mfma_f32_16x16x32_bf16 v[80:83], a[136:139], a[208:211], v[80:83]
v_sub_f32 v140, v140, v196
v_sub_f32 v141, v141, v197
v_mfma_f32_16x16x32_bf16 v[84:87], a[148:151], a[208:211], v[84:87]
global_load_dwordx4 a[124:127], v3, s[20:21] offset:-3072
v_sub_f32 v142, v142, v198
v_mfma_f32_16x16x32_bf16 v[84:87], a[144:147], a[204:207], v[84:87]
ds_read_b128 a[196:199], v1 offset:5408
v_sub_f32 v143, v143, v199
v_mfma_f32_16x16x32_bf16 v[84:87], a[140:143], a[200:203], v[84:87]
s_waitcnt vmcnt(20)
v_add_u32 v0, 31744, v9
v_med3_f32 v144, v144, -s22, s22
v_mfma_f32_16x16x32_bf16 v[32:35], a[56:59], a[176:179], v[32:35]
s_add_u32 m0, s23, 76032
v_med3_f32 v145, v145, -s22, s22
v_med3_f32 v146, v146, -s22, s22
v_mfma_f32_16x16x32_bf16 v[32:35], a[60:63], a[180:183], v[32:35]
buffer_store_dwordx4 a[164:167], v0, s[16:19], 0 offen nt
v_mfma_f32_16x16x32_bf16 v[32:35], a[64:67], a[184:187], v[32:35]
ds_read_b128 a[200:203], v1 offset:6464
v_med3_f32 v147, v147, -s22, s22
v_mfma_f32_16x16x32_bf16 v[36:39], a[76:79], a[184:187], v[36:39]
v_exp_f32 v148, v148
v_mfma_f32_16x16x32_bf16 v[36:39], a[72:75], a[180:183], v[36:39]
buffer_load_dwordx4 v4, s[8:11], s14 offen offset:0 lds
v_mfma_f32_16x16x32_bf16 v[36:39], a[68:71], a[176:179], v[36:39]
v_exp_f32 v149, v149
v_mfma_f32_16x16x32_bf16 v[44:47], a[68:71], a[180:183], v[44:47]
s_waitcnt lgkmcnt(2)
v_exp_f32 v150, v150
v_mfma_f32_16x16x32_bf16 v[44:47], a[72:75], a[184:187], v[44:47]
global_load_dwordx4 a[128:131], v3, s[20:21] offset:-2048
v_exp_f32 v151, v151
v_mfma_f32_16x16x32_bf16 v[44:47], a[76:79], a[188:191], v[44:47]
ds_read_b128 a[204:207], v1 offset:7520
v_mfma_f32_16x16x32_bf16 v[40:43], a[64:67], a[188:191], v[40:43]
ds_read_b128 a[176:179], v1 offset:160
v_mfma_f32_16x16x32_bf16 v[40:43], a[60:63], a[184:187], v[40:43]
global_load_dwordx4 a[132:135], v3, s[20:21] offset:-1024
v_exp_f32 v144, v144
v_mfma_f32_16x16x32_bf16 v[40:43], a[56:59], a[180:183], v[40:43]
v_exp_f32 v145, v145
v_mfma_f32_16x16x32_bf16 v[48:51], a[56:59], a[184:187], v[48:51]
v_exp_f32 v146, v146
v_mfma_f32_16x16x32_bf16 v[48:51], a[60:63], a[188:191], v[48:51]
ds_read_b128 a[208:211], v1 offset:8576
v_exp_f32 v147, v147
v_mfma_f32_16x16x32_bf16 v[48:51], a[64:67], a[192:195], v[48:51]
global_load_dwordx4 a[136:139], v3, s[20:21] offset:0
v_add_f32 v148, 1.0, v148
v_mfma_f32_16x16x32_bf16 v[52:55], a[76:79], a[192:195], v[52:55]
ds_read_b128 a[180:183], v1 offset:1216
v_add_f32 v149, 1.0, v149
v_mfma_f32_16x16x32_bf16 v[52:55], a[72:75], a[188:191], v[52:55]
s_add_u32 m0, s23, 76064
v_add_f32 v150, 1.0, v150
v_add_f32 v151, 1.0, v151
v_fmac_f32 v148, v144, v148
v_mfma_f32_16x16x32_bf16 v[52:55], a[68:71], a[184:187], v[52:55]
buffer_load_dwordx4 v4, s[8:11], s14 offen offset:1024 lds
v_mfma_f32_16x16x32_bf16 v[60:63], a[68:71], a[188:191], v[60:63]
v_fmac_f32 v149, v145, v149
v_fmac_f32 v150, v146, v150
v_mfma_f32_16x16x32_bf16 v[60:63], a[72:75], a[192:195], v[60:63]
s_waitcnt lgkmcnt(2)
v_fmac_f32 v151, v147, v151
v_mfma_f32_16x16x32_bf16 v[60:63], a[76:79], a[196:199], v[60:63]
global_load_dwordx4 a[140:143], v3, s[20:21] offset:1024
v_rcp_f32 v148, v148
v_mfma_f32_16x16x32_bf16 v[56:59], a[64:67], a[196:199], v[56:59]
ds_read_b128 a[184:187], v1 offset:2272
v_mfma_f32_16x16x32_bf16 v[56:59], a[60:63], a[192:195], v[56:59]
v_rcp_f32 v149, v149
v_mfma_f32_16x16x32_bf16 v[56:59], a[56:59], a[188:191], v[56:59]
v_rcp_f32 v150, v150
v_mfma_f32_16x16x32_bf16 v[64:67], a[56:59], a[192:195], v[64:67]
v_rcp_f32 v151, v151
v_mfma_f32_16x16x32_bf16 v[64:67], a[60:63], a[196:199], v[64:67]
v_fma_f32 v144, v144, v148, -v148
v_fma_f32 v145, v145, v149, -v149
v_mfma_f32_16x16x32_bf16 v[64:67], a[64:67], a[200:203], v[64:67]
global_load_dwordx4 a[144:147], v3, s[20:21] offset:2048
v_fma_f32 v146, v146, v150, -v150
v_fma_f32 v147, v147, v151, -v151
v_mfma_f32_16x16x32_bf16 v[68:71], a[76:79], a[200:203], v[68:71]
ds_read_b128 a[188:191], v1 offset:3328
v_cvt_pk_bf16_f32 v144, v144, v145
v_cvt_pk_bf16_f32 v145, v146, v147
v_mfma_f32_16x16x32_bf16 v[68:71], a[72:75], a[196:199], v[68:71]
ds_write_b64 v5, v[144:145] offset:0
v_mfma_f32_16x16x32_bf16 v[68:71], a[68:71], a[192:195], v[68:71]
v_med3_f32 v152, v152, -s22, s22
v_med3_f32 v153, v153, -s22, s22
v_mfma_f32_16x16x32_bf16 v[76:79], a[68:71], a[196:199], v[76:79]
v_med3_f32 v154, v154, -s22, s22
v_med3_f32 v155, v155, -s22, s22
v_mfma_f32_16x16x32_bf16 v[76:79], a[72:75], a[200:203], v[76:79]
v_exp_f32 v156, v156
v_mfma_f32_16x16x32_bf16 v[76:79], a[76:79], a[204:207], v[76:79]
s_add_u32 m0, s23, 76096
v_exp_f32 v157, v157
v_mfma_f32_16x16x32_bf16 v[72:75], a[64:67], a[204:207], v[72:75]
buffer_load_dwordx4 v4, s[8:11], s14 offen offset:2048 lds
v_mfma_f32_16x16x32_bf16 v[72:75], a[60:63], a[200:203], v[72:75]
ds_read_b128 a[192:195], v1 offset:4384
v_mfma_f32_16x16x32_bf16 v[72:75], a[56:59], a[196:199], v[72:75]
v_exp_f32 v158, v158
v_mfma_f32_16x16x32_bf16 v[80:83], a[56:59], a[200:203], v[80:83]
global_load_dwordx4 a[148:151], v3, s[20:21] offset:3072
v_exp_f32 v159, v159
v_mfma_f32_16x16x32_bf16 v[80:83], a[60:63], a[204:207], v[80:83]
s_waitcnt lgkmcnt(2)
v_exp_f32 v152, v152
v_mfma_f32_16x16x32_bf16 v[80:83], a[64:67], a[208:211], v[80:83]
v_exp_f32 v153, v153
v_mfma_f32_16x16x32_bf16 v[84:87], a[76:79], a[208:211], v[84:87]
ds_read_b128 a[196:199], v1 offset:5440
v_mfma_f32_16x16x32_bf16 v[84:87], a[72:75], a[204:207], v[84:87]
v_exp_f32 v154, v154
v_mfma_f32_16x16x32_bf16 v[84:87], a[68:71], a[200:203], v[84:87]
s_waitcnt vmcnt(27)
v_exp_f32 v155, v155
v_mfma_f32_16x16x32_bf16 v[32:35], a[80:83], a[176:179], v[32:35]
s_waitcnt vmcnt(22)
v_add_f32 v156, 1.0, v156
v_add_f32 v157, 1.0, v157
v_mfma_f32_16x16x32_bf16 v[32:35], a[84:87], a[180:183], v[32:35]
s_add_u32 s20, s20, 8192
s_addc_u32 s21, s21, 0
v_add_f32 v158, 1.0, v158
v_add_f32 v159, 1.0, v159
v_mfma_f32_16x16x32_bf16 v[32:35], a[88:91], a[184:187], v[32:35]
global_load_dwordx4 a[56:59], v3, s[20:21] offset:-4096
v_fmac_f32 v156, v152, v156
v_fmac_f32 v157, v153, v157
v_mfma_f32_16x16x32_bf16 v[36:39], a[100:103], a[184:187], v[36:39]
ds_read_b128 a[200:203], v1 offset:6496
v_fmac_f32 v158, v154, v158
v_fmac_f32 v159, v155, v159
v_mfma_f32_16x16x32_bf16 v[36:39], a[96:99], a[180:183], v[36:39]
v_rcp_f32 v156, v156
v_mfma_f32_16x16x32_bf16 v[36:39], a[92:95], a[176:179], v[36:39]
v_rcp_f32 v157, v157
v_mfma_f32_16x16x32_bf16 v[44:47], a[92:95], a[180:183], v[44:47]
v_rcp_f32 v158, v158
v_mfma_f32_16x16x32_bf16 v[44:47], a[96:99], a[184:187], v[44:47]
global_load_dwordx4 a[60:63], v3, s[20:21] offset:-3072
v_mfma_f32_16x16x32_bf16 v[44:47], a[100:103], a[188:191], v[44:47]
ds_read_b128 a[204:207], v1 offset:7552
v_rcp_f32 v159, v159
v_mfma_f32_16x16x32_bf16 v[40:43], a[88:91], a[188:191], v[40:43]
ds_read_b128 a[176:179], v1 offset:192
v_fma_f32 v152, v152, v156, -v156
v_mfma_f32_16x16x32_bf16 v[40:43], a[84:87], a[184:187], v[40:43]
v_fma_f32 v153, v153, v157, -v157
v_fma_f32 v154, v154, v158, -v158
v_mfma_f32_16x16x32_bf16 v[40:43], a[80:83], a[180:183], v[40:43]
v_fma_f32 v155, v155, v159, -v159
v_cvt_pk_bf16_f32 v152, v152, v153
v_mfma_f32_16x16x32_bf16 v[48:51], a[80:83], a[184:187], v[48:51]
s_waitcnt lgkmcnt(3)
v_cvt_pk_bf16_f32 v153, v154, v155
v_med3_f32 v160, v160, -s22, s22
v_mfma_f32_16x16x32_bf16 v[48:51], a[84:87], a[188:191], v[48:51]
ds_write_b64 v5, v[152:153] offset:2304
v_mfma_f32_16x16x32_bf16 v[48:51], a[88:91], a[192:195], v[48:51]
ds_read_b128 a[208:211], v1 offset:8608
v_med3_f32 v161, v161, -s22, s22
v_mfma_f32_16x16x32_bf16 v[52:55], a[100:103], a[192:195], v[52:55]
global_load_dwordx4 a[64:67], v3, s[20:21] offset:-2048
v_med3_f32 v162, v162, -s22, s22
v_mfma_f32_16x16x32_bf16 v[52:55], a[96:99], a[188:191], v[52:55]
ds_read_b128 a[180:183], v1 offset:1248
v_med3_f32 v163, v163, -s22, s22
v_mfma_f32_16x16x32_bf16 v[52:55], a[92:95], a[184:187], v[52:55]
v_exp_f32 v164, v164
v_mfma_f32_16x16x32_bf16 v[60:63], a[92:95], a[188:191], v[60:63]
v_exp_f32 v165, v165
v_mfma_f32_16x16x32_bf16 v[60:63], a[96:99], a[192:195], v[60:63]
v_exp_f32 v166, v166
v_mfma_f32_16x16x32_bf16 v[60:63], a[100:103], a[196:199], v[60:63]
global_load_dwordx4 a[68:71], v3, s[20:21] offset:-1024
v_mfma_f32_16x16x32_bf16 v[56:59], a[88:91], a[196:199], v[56:59]
ds_read_b128 a[184:187], v1 offset:2304
v_exp_f32 v167, v167
v_mfma_f32_16x16x32_bf16 v[56:59], a[84:87], a[192:195], v[56:59]
v_exp_f32 v160, v160
v_mfma_f32_16x16x32_bf16 v[56:59], a[80:83], a[188:191], v[56:59]
v_exp_f32 v161, v161
v_mfma_f32_16x16x32_bf16 v[64:67], a[80:83], a[192:195], v[64:67]
v_exp_f32 v162, v162
v_mfma_f32_16x16x32_bf16 v[64:67], a[84:87], a[196:199], v[64:67]
s_waitcnt lgkmcnt(2)
v_exp_f32 v163, v163
v_mfma_f32_16x16x32_bf16 v[64:67], a[88:91], a[200:203], v[64:67]
global_load_dwordx4 a[72:75], v3, s[20:21] offset:0
v_add_f32 v164, 1.0, v164
v_mfma_f32_16x16x32_bf16 v[68:71], a[100:103], a[200:203], v[68:71]
ds_read_b128 a[188:191], v1 offset:3360
v_add_f32 v165, 1.0, v165
v_mfma_f32_16x16x32_bf16 v[68:71], a[96:99], a[196:199], v[68:71]
v_add_f32 v166, 1.0, v166
v_add_f32 v167, 1.0, v167
v_mfma_f32_16x16x32_bf16 v[68:71], a[92:95], a[192:195], v[68:71]
v_fmac_f32 v164, v160, v164
v_fmac_f32 v165, v161, v165
v_mfma_f32_16x16x32_bf16 v[76:79], a[92:95], a[196:199], v[76:79]
v_fmac_f32 v166, v162, v166
v_fmac_f32 v167, v163, v167
v_mfma_f32_16x16x32_bf16 v[76:79], a[96:99], a[200:203], v[76:79]
v_rcp_f32 v164, v164
v_mfma_f32_16x16x32_bf16 v[76:79], a[100:103], a[204:207], v[76:79]
global_load_dwordx4 a[76:79], v3, s[20:21] offset:1024
v_mfma_f32_16x16x32_bf16 v[72:75], a[88:91], a[204:207], v[72:75]
ds_read_b128 a[192:195], v1 offset:4416
v_mfma_f32_16x16x32_bf16 v[72:75], a[84:87], a[200:203], v[72:75]
v_rcp_f32 v165, v165
v_mfma_f32_16x16x32_bf16 v[72:75], a[80:83], a[196:199], v[72:75]
v_rcp_f32 v166, v166
v_mfma_f32_16x16x32_bf16 v[80:83], a[80:83], a[200:203], v[80:83]
v_rcp_f32 v167, v167
v_fma_f32 v160, v160, v164, -v164
v_mfma_f32_16x16x32_bf16 v[80:83], a[84:87], a[204:207], v[80:83]
v_fma_f32 v161, v161, v165, -v165
v_fma_f32 v162, v162, v166, -v166
v_mfma_f32_16x16x32_bf16 v[80:83], a[88:91], a[208:211], v[80:83]
v_fma_f32 v163, v163, v167, -v167
v_cvt_pk_bf16_f32 v160, v160, v161
v_cvt_pk_bf16_f32 v161, v162, v163
v_mfma_f32_16x16x32_bf16 v[84:87], a[100:103], a[208:211], v[84:87]
ds_write_b64 v5, v[160:161] offset:4608
v_mfma_f32_16x16x32_bf16 v[84:87], a[96:99], a[204:207], v[84:87]
ds_read_b128 a[196:199], v1 offset:5472
v_med3_f32 v168, v168, -s22, s22
v_mfma_f32_16x16x32_bf16 v[84:87], a[92:95], a[200:203], v[84:87]
s_waitcnt vmcnt(24)
v_med3_f32 v169, v169, -s22, s22
v_med3_f32 v170, v170, -s22, s22
v_mfma_f32_16x16x32_bf16 v[32:35], a[104:107], a[176:179], v[32:35]
s_waitcnt lgkmcnt(3)
v_med3_f32 v171, v171, -s22, s22
v_mfma_f32_16x16x32_bf16 v[32:35], a[108:111], a[180:183], v[32:35]
s_waitcnt vmcnt(16)
global_load_dwordx4 a[80:83], v3, s[20:21] offset:2048
v_mfma_f32_16x16x32_bf16 v[32:35], a[112:115], a[184:187], v[32:35]
ds_read_b128 a[200:203], v1 offset:6528
v_exp_f32 v172, v172
v_mfma_f32_16x16x32_bf16 v[36:39], a[124:127], a[184:187], v[36:39]
v_exp_f32 v173, v173
v_mfma_f32_16x16x32_bf16 v[36:39], a[120:123], a[180:183], v[36:39]
v_exp_f32 v174, v174
v_mfma_f32_16x16x32_bf16 v[36:39], a[116:119], a[176:179], v[36:39]
v_exp_f32 v175, v175
v_mfma_f32_16x16x32_bf16 v[44:47], a[116:119], a[180:183], v[44:47]
v_exp_f32 v168, v168
v_mfma_f32_16x16x32_bf16 v[44:47], a[120:123], a[184:187], v[44:47]
global_load_dwordx4 a[84:87], v3, s[20:21] offset:3072
v_mfma_f32_16x16x32_bf16 v[44:47], a[124:127], a[188:191], v[44:47]
ds_read_b128 a[204:207], v1 offset:7584
v_exp_f32 v169, v169
v_mfma_f32_16x16x32_bf16 v[40:43], a[112:115], a[188:191], v[40:43]
ds_read_b128 a[176:179], v1 offset:224
v_mfma_f32_16x16x32_bf16 v[40:43], a[108:111], a[184:187], v[40:43]
v_exp_f32 v170, v170
v_mfma_f32_16x16x32_bf16 v[40:43], a[104:107], a[180:183], v[40:43]
v_exp_f32 v171, v171
v_add_f32 v172, 1.0, v172
v_mfma_f32_16x16x32_bf16 v[48:51], a[104:107], a[184:187], v[48:51]
s_waitcnt lgkmcnt(2)
v_add_f32 v173, 1.0, v173
v_add_f32 v174, 1.0, v174
v_add_f32 v175, 1.0, v175
v_mfma_f32_16x16x32_bf16 v[48:51], a[108:111], a[188:191], v[48:51]
s_add_u32 s20, s20, 8192
s_addc_u32 s21, s21, 0
v_fmac_f32 v172, v168, v172
v_mfma_f32_16x16x32_bf16 v[48:51], a[112:115], a[192:195], v[48:51]
ds_read_b128 a[208:211], v1 offset:8640
v_fmac_f32 v173, v169, v173
v_fmac_f32 v174, v170, v174
v_mfma_f32_16x16x32_bf16 v[52:55], a[124:127], a[192:195], v[52:55]
global_load_dwordx4 a[88:91], v3, s[20:21] offset:-4096
v_fmac_f32 v175, v171, v175
v_mfma_f32_16x16x32_bf16 v[52:55], a[120:123], a[188:191], v[52:55]
ds_read_b128 a[180:183], v1 offset:1280
v_mfma_f32_16x16x32_bf16 v[52:55], a[116:119], a[184:187], v[52:55]
v_rcp_f32 v172, v172
v_mfma_f32_16x16x32_bf16 v[60:63], a[116:119], a[188:191], v[60:63]
v_rcp_f32 v173, v173
v_mfma_f32_16x16x32_bf16 v[60:63], a[120:123], a[192:195], v[60:63]
v_rcp_f32 v174, v174
v_mfma_f32_16x16x32_bf16 v[60:63], a[124:127], a[196:199], v[60:63]
global_load_dwordx4 a[92:95], v3, s[20:21] offset:-3072
v_rcp_f32 v175, v175
v_mfma_f32_16x16x32_bf16 v[56:59], a[112:115], a[196:199], v[56:59]
ds_read_b128 a[184:187], v1 offset:2336
v_fma_f32 v168, v168, v172, -v172
v_mfma_f32_16x16x32_bf16 v[56:59], a[108:111], a[192:195], v[56:59]
v_fma_f32 v169, v169, v173, -v173
v_fma_f32 v170, v170, v174, -v174
v_mfma_f32_16x16x32_bf16 v[56:59], a[104:107], a[188:191], v[56:59]
v_fma_f32 v171, v171, v175, -v175
v_cvt_pk_bf16_f32 v168, v168, v169
v_mfma_f32_16x16x32_bf16 v[64:67], a[104:107], a[192:195], v[64:67]
v_cvt_pk_bf16_f32 v169, v170, v171
v_med3_f32 v176, v176, -s22, s22
v_mfma_f32_16x16x32_bf16 v[64:67], a[108:111], a[196:199], v[64:67]
ds_write_b64 v5, v[168:169] offset:6912
v_mfma_f32_16x16x32_bf16 v[64:67], a[112:115], a[200:203], v[64:67]
global_load_dwordx4 a[96:99], v3, s[20:21] offset:-2048
v_med3_f32 v177, v177, -s22, s22
v_mfma_f32_16x16x32_bf16 v[68:71], a[124:127], a[200:203], v[68:71]
ds_read_b128 a[188:191], v1 offset:3392
v_med3_f32 v178, v178, -s22, s22
v_mfma_f32_16x16x32_bf16 v[68:71], a[120:123], a[196:199], v[68:71]
v_med3_f32 v179, v179, -s22, s22
v_mfma_f32_16x16x32_bf16 v[68:71], a[116:119], a[192:195], v[68:71]
v_exp_f32 v180, v180
v_mfma_f32_16x16x32_bf16 v[76:79], a[116:119], a[196:199], v[76:79]
v_exp_f32 v181, v181
v_mfma_f32_16x16x32_bf16 v[76:79], a[120:123], a[200:203], v[76:79]
s_waitcnt lgkmcnt(2)
v_exp_f32 v182, v182
v_mfma_f32_16x16x32_bf16 v[76:79], a[124:127], a[204:207], v[76:79]
global_load_dwordx4 a[100:103], v3, s[20:21] offset:-1024
v_exp_f32 v183, v183
v_mfma_f32_16x16x32_bf16 v[72:75], a[112:115], a[204:207], v[72:75]
ds_read_b128 a[192:195], v1 offset:4448
v_mfma_f32_16x16x32_bf16 v[72:75], a[108:111], a[200:203], v[72:75]
v_exp_f32 v176, v176
v_mfma_f32_16x16x32_bf16 v[72:75], a[104:107], a[196:199], v[72:75]
v_exp_f32 v177, v177
v_mfma_f32_16x16x32_bf16 v[80:83], a[104:107], a[200:203], v[80:83]
v_exp_f32 v178, v178
v_mfma_f32_16x16x32_bf16 v[80:83], a[108:111], a[204:207], v[80:83]
v_exp_f32 v179, v179
v_mfma_f32_16x16x32_bf16 v[80:83], a[112:115], a[208:211], v[80:83]
v_add_f32 v180, 1.0, v180
v_add_f32 v181, 1.0, v181
v_mfma_f32_16x16x32_bf16 v[84:87], a[124:127], a[208:211], v[84:87]
ds_read_b128 a[196:199], v1 offset:5504
v_add_f32 v182, 1.0, v182
v_add_f32 v183, 1.0, v183
v_mfma_f32_16x16x32_bf16 v[84:87], a[120:123], a[204:207], v[84:87]
v_fmac_f32 v180, v176, v180
v_fmac_f32 v181, v177, v181
v_mfma_f32_16x16x32_bf16 v[84:87], a[116:119], a[200:203], v[84:87]
s_waitcnt vmcnt(17)
v_fmac_f32 v182, v178, v182
v_fmac_f32 v183, v179, v183
v_mfma_f32_16x16x32_bf16 v[32:35], a[128:131], a[176:179], v[32:35]
ds_read_b128 a[200:203], v1 offset:6560
v_mfma_f32_16x16x32_bf16 v[32:35], a[132:135], a[180:183], v[32:35]
global_load_dwordx4 a[104:107], v3, s[20:21] offset:0
v_rcp_f32 v180, v180
v_mfma_f32_16x16x32_bf16 v[32:35], a[136:139], a[184:187], v[32:35]
s_waitcnt vmcnt(13)
ds_read_b128 a[204:207], v1 offset:7616
v_mfma_f32_16x16x32_bf16 v[36:39], a[148:151], a[184:187], v[36:39]
v_rcp_f32 v181, v181
v_mfma_f32_16x16x32_bf16 v[36:39], a[144:147], a[180:183], v[36:39]
ds_read_b128 a[208:211], v1 offset:8672
v_mfma_f32_16x16x32_bf16 v[36:39], a[140:143], a[176:179], v[36:39]
v_rcp_f32 v182, v182
v_mfma_f32_16x16x32_bf16 v[44:47], a[140:143], a[180:183], v[44:47]
s_waitcnt lgkmcnt(4)
v_rcp_f32 v183, v183
v_fma_f32 v176, v176, v180, -v180
v_mfma_f32_16x16x32_bf16 v[44:47], a[144:147], a[184:187], v[44:47]
global_load_dwordx4 a[108:111], v3, s[20:21] offset:1024
v_fma_f32 v177, v177, v181, -v181
v_fma_f32 v178, v178, v182, -v182
v_mfma_f32_16x16x32_bf16 v[44:47], a[148:151], a[188:191], v[44:47]
v_fma_f32 v179, v179, v183, -v183
v_cvt_pk_bf16_f32 v176, v176, v177
v_cvt_pk_bf16_f32 v177, v178, v179
v_mfma_f32_16x16x32_bf16 v[40:43], a[136:139], a[188:191], v[40:43]
ds_write_b64 v5, v[176:177] offset:9216
v_mfma_f32_16x16x32_bf16 v[40:43], a[132:135], a[184:187], v[40:43]
v_med3_f32 v184, v184, -s22, s22
v_med3_f32 v185, v185, -s22, s22
v_mfma_f32_16x16x32_bf16 v[40:43], a[128:131], a[180:183], v[40:43]
L_stub11:
s_cmp_eq_u32 s37, 1
s_cbranch_scc1 L_wret0
v_med3_f32 v186, v186, -s22, s22
v_med3_f32 v187, v187, -s22, s22
v_mfma_f32_16x16x32_bf16 v[48:51], a[128:131], a[184:187], v[48:51]
v_exp_f32 v188, v188
v_mfma_f32_16x16x32_bf16 v[48:51], a[132:135], a[188:191], v[48:51]
global_load_dwordx4 a[112:115], v3, s[20:21] offset:2048
v_mfma_f32_16x16x32_bf16 v[48:51], a[136:139], a[192:195], v[48:51]
v_exp_f32 v189, v189
v_mfma_f32_16x16x32_bf16 v[52:55], a[148:151], a[192:195], v[52:55]
s_nop 0
v_exp_f32 v190, v190
v_exp_f32 v191, v191
v_exp_f32 v184, v184
v_exp_f32 v185, v185
s_waitcnt lgkmcnt(0)
s_barrier
v_mfma_f32_16x16x32_bf16 v[52:55], a[144:147], a[188:191], v[52:55]
ds_read_b128 a[176:179], v2 offset:0
v_mfma_f32_16x16x32_bf16 v[52:55], a[140:143], a[184:187], v[52:55]
v_exp_f32 v186, v186
v_mfma_f32_16x16x32_bf16 v[60:63], a[140:143], a[188:191], v[60:63]
ds_read_b128 a[180:183], v2 offset:1056
v_mfma_f32_16x16x32_bf16 v[60:63], a[144:147], a[192:195], v[60:63]
v_exp_f32 v187, v187
v_mfma_f32_16x16x32_bf16 v[60:63], a[148:151], a[196:199], v[60:63]
global_load_dwordx4 a[116:119], v3, s[20:21] offset:3072
v_add_f32 v188, 1.0, v188
v_mfma_f32_16x16x32_bf16 v[56:59], a[136:139], a[196:199], v[56:59]
ds_read_b128 a[184:187], v2 offset:2112
v_add_f32 v189, 1.0, v189
v_mfma_f32_16x16x32_bf16 v[56:59], a[132:135], a[192:195], v[56:59]
v_add_f32 v190, 1.0, v190
v_add_f32 v191, 1.0, v191
v_mfma_f32_16x16x32_bf16 v[56:59], a[128:131], a[188:191], v[56:59]
v_fmac_f32 v188, v184, v188
v_fmac_f32 v189, v185, v189
v_mfma_f32_16x16x32_bf16 v[64:67], a[128:131], a[192:195], v[64:67]
v_fmac_f32 v190, v186, v190
v_fmac_f32 v191, v187, v191
v_mfma_f32_16x16x32_bf16 v[64:67], a[132:135], a[196:199], v[64:67]
v_rcp_f32 v188, v188
v_mfma_f32_16x16x32_bf16 v[64:67], a[136:139], a[200:203], v[64:67]
s_add_u32 s20, s20, 8192
s_addc_u32 s21, s21, 0
v_mfma_f32_16x16x32_bf16 v[68:71], a[148:151], a[200:203], v[68:71]
global_load_dwordx4 a[120:123], v3, s[20:21] offset:-4096
v_mfma_f32_16x16x32_bf16 v[68:71], a[144:147], a[196:199], v[68:71]
ds_read_b128 a[188:191], v2 offset:3168
v_mfma_f32_16x16x32_bf16 v[68:71], a[140:143], a[192:195], v[68:71]
v_rcp_f32 v189, v189
v_mfma_f32_16x16x32_bf16 v[76:79], a[140:143], a[196:199], v[76:79]
v_rcp_f32 v190, v190
v_mfma_f32_16x16x32_bf16 v[76:79], a[144:147], a[200:203], v[76:79]
v_rcp_f32 v191, v191
v_mfma_f32_16x16x32_bf16 v[76:79], a[148:151], a[204:207], v[76:79]
global_load_dwordx4 a[124:127], v3, s[20:21] offset:-3072
v_fma_f32 v184, v184, v188, -v188
v_mfma_f32_16x16x32_bf16 v[72:75], a[136:139], a[204:207], v[72:75]
ds_read_b128 a[192:195], v2 offset:4224
v_fma_f32 v185, v185, v189, -v189
v_mfma_f32_16x16x32_bf16 v[72:75], a[132:135], a[200:203], v[72:75]
v_fma_f32 v186, v186, v190, -v190
v_fma_f32 v187, v187, v191, -v191
v_mfma_f32_16x16x32_bf16 v[72:75], a[128:131], a[196:199], v[72:75]
v_cvt_pk_bf16_f32 v184, v184, v185
v_cvt_pk_bf16_f32 v185, v186, v187
v_mfma_f32_16x16x32_bf16 v[80:83], a[128:131], a[200:203], v[80:83]
ds_write_b64 v5, v[184:185] offset:11520
v_mfma_f32_16x16x32_bf16 v[80:83], a[132:135], a[204:207], v[80:83]
v_med3_f32 v192, v192, -s22, s22
v_med3_f32 v193, v193, -s22, s22
v_mfma_f32_16x16x32_bf16 v[80:83], a[136:139], a[208:211], v[80:83]
v_med3_f32 v194, v194, -s22, s22
v_med3_f32 v195, v195, -s22, s22
v_mfma_f32_16x16x32_bf16 v[84:87], a[148:151], a[208:211], v[84:87]
ds_read_b128 a[196:199], v2 offset:5280
v_mfma_f32_16x16x32_bf16 v[84:87], a[144:147], a[204:207], v[84:87]
v_exp_f32 v196, v196
v_mfma_f32_16x16x32_bf16 v[84:87], a[140:143], a[200:203], v[84:87]
s_waitcnt vmcnt(15) lgkmcnt(3)
v_exp_f32 v197, v197
L_h9:
v_mfma_f32_16x16x32_bf16 v[88:91], a[56:59], a[176:179], v[88:91]
v_exp_f32 v198, v198
v_mfma_f32_16x16x32_bf16 v[88:91], a[60:63], a[180:183], v[88:91]
global_load_dwordx4 a[128:131], v3, s[20:21] offset:-2048
v_exp_f32 v199, v199
v_mfma_f32_16x16x32_bf16 v[88:91], a[64:67], a[184:187], v[88:91]
s_waitcnt vmcnt(13)
ds_read_b128 a[200:203], v2 offset:6336
v_mfma_f32_16x16x32_bf16 v[92:95], a[76:79], a[184:187], v[92:95]
v_exp_f32 v192, v192
v_mfma_f32_16x16x32_bf16 v[92:95], a[72:75], a[180:183], v[92:95]
v_exp_f32 v193, v193
v_mfma_f32_16x16x32_bf16 v[92:95], a[68:71], a[176:179], v[92:95]
v_exp_f32 v194, v194
v_mfma_f32_16x16x32_bf16 v[100:103], a[68:71], a[180:183], v[100:103]
v_exp_f32 v195, v195
v_mfma_f32_16x16x32_bf16 v[100:103], a[72:75], a[184:187], v[100:103]
global_load_dwordx4 a[132:135], v3, s[20:21] offset:-1024
v_add_f32 v196, 1.0, v196
v_add_f32 v197, 1.0, v197
v_mfma_f32_16x16x32_bf16 v[100:103], a[76:79], a[188:191], v[100:103]
ds_read_b128 a[204:207], v2 offset:7392
v_add_f32 v198, 1.0, v198
v_add_f32 v199, 1.0, v199
v_mfma_f32_16x16x32_bf16 v[96:99], a[64:67], a[188:191], v[96:99]
ds_read_b128 a[176:179], v2 offset:32
v_fmac_f32 v196, v192, v196
v_mfma_f32_16x16x32_bf16 v[96:99], a[60:63], a[184:187], v[96:99]
v_fmac_f32 v197, v193, v197
v_fmac_f32 v198, v194, v198
v_mfma_f32_16x16x32_bf16 v[96:99], a[56:59], a[180:183], v[96:99]
v_fmac_f32 v199, v195, v199
v_mfma_f32_16x16x32_bf16 v[104:107], a[56:59], a[184:187], v[104:107]
v_rcp_f32 v196, v196
v_mfma_f32_16x16x32_bf16 v[104:107], a[60:63], a[188:191], v[104:107]
s_waitcnt lgkmcnt(2)
ds_read_b128 a[208:211], v2 offset:8448
v_mfma_f32_16x16x32_bf16 v[104:107], a[64:67], a[192:195], v[104:107]
global_load_dwordx4 a[136:139], v3, s[20:21] offset:0
v_rcp_f32 v197, v197
v_mfma_f32_16x16x32_bf16 v[108:111], a[76:79], a[192:195], v[108:111]
ds_read_b128 a[180:183], v2 offset:1088
v_mfma_f32_16x16x32_bf16 v[108:111], a[72:75], a[188:191], v[108:111]
v_rcp_f32 v198, v198
v_mfma_f32_16x16x32_bf16 v[108:111], a[68:71], a[184:187], v[108:111]
v_rcp_f32 v199, v199
v_mfma_f32_16x16x32_bf16 v[116:119], a[68:71], a[188:191], v[116:119]
v_fma_f32 v192, v192, v196, -v196
v_fma_f32 v193, v193, v197, -v197
v_mfma_f32_16x16x32_bf16 v[116:119], a[72:75], a[192:195], v[116:119]
v_fma_f32 v194, v194, v198, -v198
v_fma_f32 v195, v195, v199, -v199
v_mfma_f32_16x16x32_bf16 v[116:119], a[76:79], a[196:199], v[116:119]
global_load_dwordx4 a[140:143], v3, s[20:21] offset:1024
v_cvt_pk_bf16_f32 v192, v192, v193
v_cvt_pk_bf16_f32 v193, v194, v195
v_mfma_f32_16x16x32_bf16 v[112:115], a[64:67], a[196:199], v[112:115]
ds_write_b64 v5, v[192:193] offset:13824
v_mfma_f32_16x16x32_bf16 v[112:115], a[60:63], a[192:195], v[112:115]
ds_read_b128 a[184:187], v2 offset:2144
v_med3_f32 v32, v32, -s22, s22
v_med3_f32 v33, v33, -s22, s22
v_mfma_f32_16x16x32_bf16 v[112:115], a[56:59], a[188:191], v[112:115]
v_med3_f32 v34, v34, -s22, s22
v_med3_f32 v35, v35, -s22, s22
v_mfma_f32_16x16x32_bf16 v[120:123], a[56:59], a[192:195], v[120:123]
v_exp_f32 v36, v36
v_mfma_f32_16x16x32_bf16 v[120:123], a[60:63], a[196:199], v[120:123]
v_exp_f32 v37, v37
v_mfma_f32_16x16x32_bf16 v[120:123], a[64:67], a[200:203], v[120:123]
v_exp_f32 v38, v38
v_mfma_f32_16x16x32_bf16 v[124:127], a[76:79], a[200:203], v[124:127]
v_exp_f32 v39, v39
v_mfma_f32_16x16x32_bf16 v[124:127], a[72:75], a[196:199], v[124:127]
s_waitcnt lgkmcnt(0)
s_barrier
v_mfma_f32_16x16x32_bf16 v[124:127], a[68:71], a[192:195], v[124:127]
ds_read_b128 a[152:155], v6 offset:0
v_mfma_f32_16x16x32_bf16 v[132:135], a[68:71], a[196:199], v[132:135]
ds_read_b128 a[156:159], v6 offset:4608
v_exp_f32 v32, v32
v_mfma_f32_16x16x32_bf16 v[132:135], a[72:75], a[200:203], v[132:135]
ds_read_b128 a[160:163], v6 offset:9216
v_mfma_f32_16x16x32_bf16 v[132:135], a[76:79], a[204:207], v[132:135]
global_load_dwordx4 a[144:147], v3, s[20:21] offset:2048
v_exp_f32 v33, v33
v_mfma_f32_16x16x32_bf16 v[128:131], a[64:67], a[204:207], v[128:131]
ds_read_b128 a[164:167], v6 offset:13824
v_exp_f32 v34, v34
v_mfma_f32_16x16x32_bf16 v[128:131], a[60:63], a[200:203], v[128:131]
ds_read_b128 a[188:191], v2 offset:3200
v_mfma_f32_16x16x32_bf16 v[128:131], a[56:59], a[196:199], v[128:131]
global_load_dwordx4 a[148:151], v3, s[20:21] offset:3072
v_mfma_f32_16x16x32_bf16 v[136:139], a[56:59], a[200:203], v[136:139]
ds_read_b128 a[192:195], v2 offset:4256
v_exp_f32 v35, v35
v_mfma_f32_16x16x32_bf16 v[136:139], a[60:63], a[204:207], v[136:139]
v_add_f32 v36, 1.0, v36
v_add_f32 v37, 1.0, v37
v_add_f32 v38, 1.0, v38
v_mfma_f32_16x16x32_bf16 v[136:139], a[64:67], a[208:211], v[136:139]
v_add_f32 v39, 1.0, v39
v_fmac_f32 v36, v32, v36
v_mfma_f32_16x16x32_bf16 v[140:143], a[76:79], a[208:211], v[140:143]
ds_read_b128 a[196:199], v2 offset:5312
v_fmac_f32 v37, v33, v37
v_mfma_f32_16x16x32_bf16 v[140:143], a[72:75], a[204:207], v[140:143]
v_fmac_f32 v38, v34, v38
v_fmac_f32 v39, v35, v39
v_mfma_f32_16x16x32_bf16 v[140:143], a[68:71], a[200:203], v[140:143]
s_waitcnt vmcnt(12) lgkmcnt(4)
v_add_u32 v0, 2048, v7
v_mfma_f32_16x16x32_bf16 v[88:91], a[80:83], a[176:179], v[88:91]
buffer_store_dwordx4 a[152:155], v0, s[16:19], 0 offen nt
v_mfma_f32_16x16x32_bf16 v[88:91], a[84:87], a[180:183], v[88:91]
s_add_u32 s20, s20, 8192
s_addc_u32 s21, s21, 0
v_rcp_f32 v36, v36
v_mfma_f32_16x16x32_bf16 v[88:91], a[88:91], a[184:187], v[88:91]
ds_read_b128 a[200:203], v2 offset:6368
v_rcp_f32 v37, v37
v_mfma_f32_16x16x32_bf16 v[92:95], a[100:103], a[184:187], v[92:95]
global_load_dwordx4 a[56:59], v3, s[20:21] offset:-4096
v_mfma_f32_16x16x32_bf16 v[92:95], a[96:99], a[180:183], v[92:95]
v_rcp_f32 v38, v38
v_mfma_f32_16x16x32_bf16 v[92:95], a[92:95], a[176:179], v[92:95]
v_rcp_f32 v39, v39
v_mfma_f32_16x16x32_bf16 v[100:103], a[92:95], a[180:183], v[100:103]
s_waitcnt lgkmcnt(2)
v_fma_f32 v32, v32, v36, -v36
v_fma_f32 v33, v33, v37, -v37
v_mfma_f32_16x16x32_bf16 v[100:103], a[96:99], a[184:187], v[100:103]
global_load_dwordx4 a[60:63], v3, s[20:21] offset:-3072
v_fma_f32 v34, v34, v38, -v38
v_fma_f32 v35, v35, v39, -v39
v_mfma_f32_16x16x32_bf16 v[100:103], a[100:103], a[188:191], v[100:103]
ds_read_b128 a[204:207], v2 offset:7424
v_cvt_pk_bf16_f32 v32, v32, v33
v_mfma_f32_16x16x32_bf16 v[96:99], a[88:91], a[188:191], v[96:99]
ds_read_b128 a[176:179], v2 offset:64
v_cvt_pk_bf16_f32 v33, v34, v35
v_mfma_f32_16x16x32_bf16 v[96:99], a[84:87], a[184:187], v[96:99]
ds_write_b64 v5, v[32:33] offset:16128
v_mfma_f32_16x16x32_bf16 v[96:99], a[80:83], a[180:183], v[96:99]
v_med3_f32 v40, v40, -s22, s22
v_add_u32 v0, 12288, v7
v_mfma_f32_16x16x32_bf16 v[104:107], a[80:83], a[184:187], v[104:107]
buffer_store_dwordx4 a[156:159], v0, s[16:19], 0 offen nt
v_mfma_f32_16x16x32_bf16 v[104:107], a[84:87], a[188:191], v[104:107]
ds_read_b128 a[208:211], v2 offset:8480
v_med3_f32 v41, v41, -s22, s22
v_med3_f32 v42, v42, -s22, s22
v_mfma_f32_16x16x32_bf16 v[104:107], a[88:91], a[192:195], v[104:107]
v_med3_f32 v43, v43, -s22, s22
v_mfma_f32_16x16x32_bf16 v[108:111], a[100:103], a[192:195], v[108:111]
global_load_dwordx4 a[64:67], v3, s[20:21] offset:-2048
v_mfma_f32_16x16x32_bf16 v[108:111], a[96:99], a[188:191], v[108:111]
ds_read_b128 a[180:183], v2 offset:1120
v_exp_f32 v44, v44
v_mfma_f32_16x16x32_bf16 v[108:111], a[92:95], a[184:187], v[108:111]
v_exp_f32 v45, v45
v_mfma_f32_16x16x32_bf16 v[116:119], a[92:95], a[188:191], v[116:119]
v_exp_f32 v46, v46
v_mfma_f32_16x16x32_bf16 v[116:119], a[96:99], a[192:195], v[116:119]
s_waitcnt lgkmcnt(3)
v_exp_f32 v47, v47
v_mfma_f32_16x16x32_bf16 v[116:119], a[100:103], a[196:199], v[116:119]
global_load_dwordx4 a[68:71], v3, s[20:21] offset:-1024
v_mfma_f32_16x16x32_bf16 v[112:115], a[88:91], a[196:199], v[112:115]
ds_read_b128 a[184:187], v2 offset:2176
v_mfma_f32_16x16x32_bf16 v[112:115], a[84:87], a[192:195], v[112:115]
v_exp_f32 v40, v40
v_mfma_f32_16x16x32_bf16 v[112:115], a[80:83], a[188:191], v[112:115]
v_exp_f32 v41, v41
v_mfma_f32_16x16x32_bf16 v[120:123], a[80:83], a[192:195], v[120:123]
v_exp_f32 v42, v42
v_mfma_f32_16x16x32_bf16 v[120:123], a[84:87], a[196:199], v[120:123]
v_exp_f32 v43, v43
v_add_f32 v44, 1.0, v44
v_mfma_f32_16x16x32_bf16 v[120:123], a[88:91], a[200:203], v[120:123]
global_load_dwordx4 a[72:75], v3, s[20:21] offset:0
v_add_u32 v0, 22528, v7
v_mfma_f32_16x16x32_bf16 v[124:127], a[100:103], a[200:203], v[124:127]
ds_read_b128 a[188:191], v2 offset:3232
v_add_f32 v45, 1.0, v45
v_mfma_f32_16x16x32_bf16 v[124:127], a[96:99], a[196:199], v[124:127]
v_add_f32 v46, 1.0, v46
v_add_f32 v47, 1.0, v47
v_mfma_f32_16x16x32_bf16 v[124:127], a[92:95], a[192:195], v[124:127]
buffer_store_dwordx4 a[160:163], v0, s[16:19], 0 offen nt
v_mfma_f32_16x16x32_bf16 v[132:135], a[92:95], a[196:199], v[132:135]
v_fmac_f32 v44, v40, v44
v_fmac_f32 v45, v41, v45
v_mfma_f32_16x16x32_bf16 v[132:135], a[96:99], a[200:203], v[132:135]
v_fmac_f32 v46, v42, v46
v_fmac_f32 v47, v43, v47
v_mfma_f32_16x16x32_bf16 v[132:135], a[100:103], a[204:207], v[132:135]
global_load_dwordx4 a[76:79], v3, s[20:21] offset:1024
v_mfma_f32_16x16x32_bf16 v[128:131], a[88:91], a[204:207], v[128:131]
ds_read_b128 a[192:195], v2 offset:4288
v_rcp_f32 v44, v44
v_mfma_f32_16x16x32_bf16 v[128:131], a[84:87], a[200:203], v[128:131]
v_rcp_f32 v45, v45
v_mfma_f32_16x16x32_bf16 v[128:131], a[80:83], a[196:199], v[128:131]
v_rcp_f32 v46, v46
v_mfma_f32_16x16x32_bf16 v[136:139], a[80:83], a[200:203], v[136:139]
v_rcp_f32 v47, v47
v_mfma_f32_16x16x32_bf16 v[136:139], a[84:87], a[204:207], v[136:139]
s_waitcnt lgkmcnt(1)
v_fma_f32 v40, v40, v44, -v44
v_add_u32 v0, 32768, v9
v_fma_f32 v41, v41, v45, -v45
v_mfma_f32_16x16x32_bf16 v[136:139], a[88:91], a[208:211], v[136:139]
buffer_store_dwordx4 a[164:167], v0, s[16:19], 0 offen nt
v_mfma_f32_16x16x32_bf16 v[140:143], a[100:103], a[208:211], v[140:143]
ds_read_b128 a[196:199], v2 offset:5344
v_fma_f32 v42, v42, v46, -v46
v_mfma_f32_16x16x32_bf16 v[140:143], a[96:99], a[204:207], v[140:143]
v_fma_f32 v43, v43, v47, -v47
v_cvt_pk_bf16_f32 v40, v40, v41
v_mfma_f32_16x16x32_bf16 v[140:143], a[92:95], a[200:203], v[140:143]
s_waitcnt vmcnt(16)
v_cvt_pk_bf16_f32 v41, v42, v43
v_med3_f32 v48, v48, -s22, s22
v_mfma_f32_16x16x32_bf16 v[88:91], a[104:107], a[176:179], v[88:91]
ds_write_b64 v5, v[40:41] offset:18432
v_mfma_f32_16x16x32_bf16 v[88:91], a[108:111], a[180:183], v[88:91]
global_load_dwordx4 a[80:83], v3, s[20:21] offset:2048
v_med3_f32 v49, v49, -s22, s22
v_mfma_f32_16x16x32_bf16 v[88:91], a[112:115], a[184:187], v[88:91]
ds_read_b128 a[200:203], v2 offset:6400
v_med3_f32 v50, v50, -s22, s22
v_mfma_f32_16x16x32_bf16 v[92:95], a[124:127], a[184:187], v[92:95]
v_med3_f32 v51, v51, -s22, s22
v_mfma_f32_16x16x32_bf16 v[92:95], a[120:123], a[180:183], v[92:95]
v_exp_f32 v52, v52
v_mfma_f32_16x16x32_bf16 v[92:95], a[116:119], a[176:179], v[92:95]
v_exp_f32 v53, v53
v_mfma_f32_16x16x32_bf16 v[100:103], a[116:119], a[180:183], v[100:103]
v_exp_f32 v54, v54
v_mfma_f32_16x16x32_bf16 v[100:103], a[120:123], a[184:187], v[100:103]
global_load_dwordx4 a[84:87], v3, s[20:21] offset:3072
v_mfma_f32_16x16x32_bf16 v[100:103], a[124:127], a[188:191], v[100:103]
ds_read_b128 a[204:207], v2 offset:7456
v_exp_f32 v55, v55
v_mfma_f32_16x16x32_bf16 v[96:99], a[112:115], a[188:191], v[96:99]
ds_read_b128 a[176:179], v2 offset:96
v_mfma_f32_16x16x32_bf16 v[96:99], a[108:111], a[184:187], v[96:99]
v_exp_f32 v48, v48
v_mfma_f32_16x16x32_bf16 v[96:99], a[104:107], a[180:183], v[96:99]
v_exp_f32 v49, v49
v_mfma_f32_16x16x32_bf16 v[104:107], a[104:107], a[184:187], v[104:107]
s_waitcnt lgkmcnt(2)
v_exp_f32 v50, v50
v_mfma_f32_16x16x32_bf16 v[104:107], a[108:111], a[188:191], v[104:107]
s_add_u32 s20, s20, 8192
s_addc_u32 s21, s21, 0
v_exp_f32 v51, v51
v_mfma_f32_16x16x32_bf16 v[104:107], a[112:115], a[192:195], v[104:107]
ds_read_b128 a[208:211], v2 offset:8512
v_add_f32 v52, 1.0, v52
v_add_f32 v53, 1.0, v53
v_mfma_f32_16x16x32_bf16 v[108:111], a[124:127], a[192:195], v[108:111]
global_load_dwordx4 a[88:91], v3, s[20:21] offset:-4096
v_add_f32 v54, 1.0, v54
v_mfma_f32_16x16x32_bf16 v[108:111], a[120:123], a[188:191], v[108:111]
ds_read_b128 a[180:183], v2 offset:1152
v_add_f32 v55, 1.0, v55
v_mfma_f32_16x16x32_bf16 v[108:111], a[116:119], a[184:187], v[108:111]
v_fmac_f32 v52, v48, v52
v_fmac_f32 v53, v49, v53
v_mfma_f32_16x16x32_bf16 v[116:119], a[116:119], a[188:191], v[116:119]
v_fmac_f32 v54, v50, v54
v_fmac_f32 v55, v51, v55
v_mfma_f32_16x16x32_bf16 v[116:119], a[120:123], a[192:195], v[116:119]
v_rcp_f32 v52, v52
v_mfma_f32_16x16x32_bf16 v[116:119], a[124:127], a[196:199], v[116:119]
global_load_dwordx4 a[92:95], v3, s[20:21] offset:-3072
v_mfma_f32_16x16x32_bf16 v[112:115], a[112:115], a[196:199], v[112:115]
ds_read_b128 a[184:187], v2 offset:2208
v_rcp_f32 v53, v53
v_mfma_f32_16x16x32_bf16 v[112:115], a[108:111], a[192:195], v[112:115]
v_rcp_f32 v54, v54
v_mfma_f32_16x16x32_bf16 v[112:115], a[104:107], a[188:191], v[112:115]
v_rcp_f32 v55, v55
v_mfma_f32_16x16x32_bf16 v[120:123], a[104:107], a[192:195], v[120:123]
v_fma_f32 v48, v48, v52, -v52
v_fma_f32 v49, v49, v53, -v53
v_mfma_f32_16x16x32_bf16 v[120:123], a[108:111], a[196:199], v[120:123]
v_fma_f32 v50, v50, v54, -v54
v_fma_f32 v51, v51, v55, -v55
v_mfma_f32_16x16x32_bf16 v[120:123], a[112:115], a[200:203], v[120:123]
global_load_dwordx4 a[96:99], v3, s[20:21] offset:-2048
v_cvt_pk_bf16_f32 v48, v48, v49
v_cvt_pk_bf16_f32 v49, v50, v51
v_mfma_f32_16x16x32_bf16 v[124:127], a[124:127], a[200:203], v[124:127]
ds_write_b64 v5, v[48:49] offset:20736
v_mfma_f32_16x16x32_bf16 v[124:127], a[120:123], a[196:199], v[124:127]
ds_read_b128 a[188:191], v2 offset:3264
v_med3_f32 v56, v56, -s22, s22
v_mfma_f32_16x16x32_bf16 v[124:127], a[116:119], a[192:195], v[124:127]
v_med3_f32 v57, v57, -s22, s22
v_med3_f32 v58, v58, -s22, s22
v_mfma_f32_16x16x32_bf16 v[132:135], a[116:119], a[196:199], v[132:135]
v_med3_f32 v59, v59, -s22, s22
v_mfma_f32_16x16x32_bf16 v[132:135], a[120:123], a[200:203], v[132:135]
s_waitcnt lgkmcnt(2)
v_exp_f32 v60, v60
v_mfma_f32_16x16x32_bf16 v[132:135], a[124:127], a[204:207], v[132:135]
global_load_dwordx4 a[100:103], v3, s[20:21] offset:-1024
v_exp_f32 v61, v61
v_mfma_f32_16x16x32_bf16 v[128:131], a[112:115], a[204:207], v[128:131]
ds_read_b128 a[192:195], v2 offset:4320
v_mfma_f32_16x16x32_bf16 v[128:131], a[108:111], a[200:203], v[128:131]
v_exp_f32 v62, v62
v_mfma_f32_16x16x32_bf16 v[128:131], a[104:107], a[196:199], v[128:131]
v_exp_f32 v63, v63
v_mfma_f32_16x16x32_bf16 v[136:139], a[104:107], a[200:203], v[136:139]
v_exp_f32 v56, v56
v_mfma_f32_16x16x32_bf16 v[136:139], a[108:111], a[204:207], v[136:139]
v_exp_f32 v57, v57
v_mfma_f32_16x16x32_bf16 v[136:139], a[112:115], a[208:211], v[136:139]
v_exp_f32 v58, v58
v_mfma_f32_16x16x32_bf16 v[140:143], a[124:127], a[208:211], v[140:143]
ds_read_b128 a[196:199], v2 offset:5376
v_mfma_f32_16x16x32_bf16 v[140:143], a[120:123], a[204:207], v[140:143]
v_exp_f32 v59, v59
v_mfma_f32_16x16x32_bf16 v[140:143], a[116:119], a[200:203], v[140:143]
s_waitcnt vmcnt(19)
v_add_f32 v60, 1.0, v60
v_add_f32 v61, 1.0, v61
v_mfma_f32_16x16x32_bf16 v[88:91], a[128:131], a[176:179], v[88:91]
s_waitcnt vmcnt(16)
v_add_f32 v62, 1.0, v62
v_add_f32 v63, 1.0, v63
v_mfma_f32_16x16x32_bf16 v[88:91], a[132:135], a[180:183], v[88:91]
global_load_dwordx4 a[104:107], v3, s[20:21] offset:0
v_fmac_f32 v60, v56, v60
v_fmac_f32 v61, v57, v61
v_mfma_f32_16x16x32_bf16 v[88:91], a[136:139], a[184:187], v[88:91]
ds_read_b128 a[200:203], v2 offset:6432
v_fmac_f32 v62, v58, v62
v_mfma_f32_16x16x32_bf16 v[92:95], a[148:151], a[184:187], v[92:95]
v_fmac_f32 v63, v59, v63
v_mfma_f32_16x16x32_bf16 v[92:95], a[144:147], a[180:183], v[92:95]
v_rcp_f32 v60, v60
v_mfma_f32_16x16x32_bf16 v[92:95], a[140:143], a[176:179], v[92:95]
v_rcp_f32 v61, v61
v_mfma_f32_16x16x32_bf16 v[100:103], a[140:143], a[180:183], v[100:103]
v_rcp_f32 v62, v62
v_mfma_f32_16x16x32_bf16 v[100:103], a[144:147], a[184:187], v[100:103]
s_waitcnt lgkmcnt(1)
global_load_dwordx4 a[108:111], v3, s[20:21] offset:1024
v_mfma_f32_16x16x32_bf16 v[100:103], a[148:151], a[188:191], v[100:103]
ds_read_b128 a[204:207], v2 offset:7488
v_rcp_f32 v63, v63
v_mfma_f32_16x16x32_bf16 v[96:99], a[136:139], a[188:191], v[96:99]
ds_read_b128 a[176:179], v2 offset:128
v_fma_f32 v56, v56, v60, -v60
v_mfma_f32_16x16x32_bf16 v[96:99], a[132:135], a[184:187], v[96:99]
v_fma_f32 v57, v57, v61, -v61
v_fma_f32 v58, v58, v62, -v62
v_mfma_f32_16x16x32_bf16 v[96:99], a[128:131], a[180:183], v[96:99]
v_fma_f32 v59, v59, v63, -v63
v_cvt_pk_bf16_f32 v56, v56, v57
v_cvt_pk_bf16_f32 v57, v58, v59
v_mfma_f32_16x16x32_bf16 v[104:107], a[128:131], a[184:187], v[104:107]
ds_write_b64 v5, v[56:57] offset:23040
v_mfma_f32_16x16x32_bf16 v[104:107], a[132:135], a[188:191], v[104:107]
ds_read_b128 a[208:211], v2 offset:8544
v_med3_f32 v64, v64, -s22, s22
v_mfma_f32_16x16x32_bf16 v[104:107], a[136:139], a[192:195], v[104:107]
global_load_dwordx4 a[112:115], v3, s[20:21] offset:2048
v_med3_f32 v65, v65, -s22, s22
v_mfma_f32_16x16x32_bf16 v[108:111], a[148:151], a[192:195], v[108:111]
ds_read_b128 a[180:183], v2 offset:1184
v_med3_f32 v66, v66, -s22, s22
v_mfma_f32_16x16x32_bf16 v[108:111], a[144:147], a[188:191], v[108:111]
v_med3_f32 v67, v67, -s22, s22
v_mfma_f32_16x16x32_bf16 v[108:111], a[140:143], a[184:187], v[108:111]
v_exp_f32 v68, v68
v_mfma_f32_16x16x32_bf16 v[116:119], a[140:143], a[188:191], v[116:119]
v_exp_f32 v69, v69
v_mfma_f32_16x16x32_bf16 v[116:119], a[144:147], a[192:195], v[116:119]
v_exp_f32 v70, v70
v_mfma_f32_16x16x32_bf16 v[116:119], a[148:151], a[196:199], v[116:119]
global_load_dwordx4 a[116:119], v3, s[20:21] offset:3072
v_exp_f32 v71, v71
v_mfma_f32_16x16x32_bf16 v[112:115], a[136:139], a[196:199], v[112:115]
ds_read_b128 a[184:187], v2 offset:2240
v_mfma_f32_16x16x32_bf16 v[112:115], a[132:135], a[192:195], v[112:115]
v_exp_f32 v64, v64
v_mfma_f32_16x16x32_bf16 v[112:115], a[128:131], a[188:191], v[112:115]
v_exp_f32 v65, v65
v_mfma_f32_16x16x32_bf16 v[120:123], a[128:131], a[192:195], v[120:123]
v_exp_f32 v66, v66
v_mfma_f32_16x16x32_bf16 v[120:123], a[132:135], a[196:199], v[120:123]
s_waitcnt lgkmcnt(1)
v_exp_f32 v67, v67
v_mfma_f32_16x16x32_bf16 v[120:123], a[136:139], a[200:203], v[120:123]
s_add_u32 s20, s20, 8192
s_addc_u32 s21, s21, 0
v_add_f32 v68, 1.0, v68
v_add_f32 v69, 1.0, v69
v_mfma_f32_16x16x32_bf16 v[124:127], a[148:151], a[200:203], v[124:127]
global_load_dwordx4 a[120:123], v3, s[20:21] offset:-4096
v_add_f32 v70, 1.0, v70
v_mfma_f32_16x16x32_bf16 v[124:127], a[144:147], a[196:199], v[124:127]
ds_read_b128 a[188:191], v2 offset:3296
v_add_f32 v71, 1.0, v71
v_mfma_f32_16x16x32_bf16 v[124:127], a[140:143], a[192:195], v[124:127]
v_fmac_f32 v68, v64, v68
v_fmac_f32 v69, v65, v69
v_mfma_f32_16x16x32_bf16 v[132:135], a[140:143], a[196:199], v[132:135]
v_fmac_f32 v70, v66, v70
v_fmac_f32 v71, v67, v71
v_mfma_f32_16x16x32_bf16 v[132:135], a[144:147], a[200:203], v[132:135]
v_rcp_f32 v68, v68
v_mfma_f32_16x16x32_bf16 v[132:135], a[148:151], a[204:207], v[132:135]
global_load_dwordx4 a[124:127], v3, s[20:21] offset:-3072
v_mfma_f32_16x16x32_bf16 v[128:131], a[136:139], a[204:207], v[128:131]
ds_read_b128 a[192:195], v2 offset:4352
v_rcp_f32 v69, v69
v_mfma_f32_16x16x32_bf16 v[128:131], a[132:135], a[200:203], v[128:131]
v_rcp_f32 v70, v70
v_mfma_f32_16x16x32_bf16 v[128:131], a[128:131], a[196:199], v[128:131]
v_rcp_f32 v71, v71
v_mfma_f32_16x16x32_bf16 v[136:139], a[128:131], a[200:203], v[136:139]
v_fma_f32 v64, v64, v68, -v68
v_fma_f32 v65, v65, v69, -v69
v_mfma_f32_16x16x32_bf16 v[136:139], a[132:135], a[204:207], v[136:139]
v_fma_f32 v66, v66, v70, -v70
v_fma_f32 v67, v67, v71, -v71
v_mfma_f32_16x16x32_bf16 v[136:139], a[136:139], a[208:211], v[136:139]
v_cvt_pk_bf16_f32 v64, v64, v65
v_cvt_pk_bf16_f32 v65, v66, v67
v_mfma_f32_16x16x32_bf16 v[140:143], a[148:151], a[208:211], v[140:143]
ds_write_b64 v5, v[64:65] offset:25344
v_mfma_f32_16x16x32_bf16 v[140:143], a[144:147], a[204:207], v[140:143]
ds_read_b128 a[196:199], v2 offset:5408
v_med3_f32 v72, v72, -s22, s22
v_mfma_f32_16x16x32_bf16 v[140:143], a[140:143], a[200:203], v[140:143]
s_waitcnt vmcnt(17)
v_med3_f32 v73, v73, -s22, s22
v_med3_f32 v74, v74, -s22, s22
v_mfma_f32_16x16x32_bf16 v[88:91], a[56:59], a[176:179], v[88:91]
s_waitcnt lgkmcnt(3) vmcnt(13)
v_med3_f32 v75, v75, -s22, s22
v_mfma_f32_16x16x32_bf16 v[88:91], a[60:63], a[180:183], v[88:91]
global_load_dwordx4 a[128:131], v3, s[20:21] offset:-2048
v_exp_f32 v76, v76
v_mfma_f32_16x16x32_bf16 v[88:91], a[64:67], a[184:187], v[88:91]
ds_read_b128 a[200:203], v2 offset:6464
v_exp_f32 v77, v77
v_mfma_f32_16x16x32_bf16 v[92:95], a[76:79], a[184:187], v[92:95]
ds_read_b128 a[212:215], v2 offset:192
v_mfma_f32_16x16x32_bf16 v[92:95], a[72:75], a[180:183], v[92:95]
v_exp_f32 v78, v78
v_mfma_f32_16x16x32_bf16 v[92:95], a[68:71], a[176:179], v[92:95]
ds_read_b128 a[232:235], v2 offset:224
v_mfma_f32_16x16x32_bf16 v[100:103], a[68:71], a[180:183], v[100:103]
v_exp_f32 v79, v79
v_mfma_f32_16x16x32_bf16 v[100:103], a[72:75], a[184:187], v[100:103]
global_load_dwordx4 a[132:135], v3, s[20:21] offset:-1024
v_exp_f32 v72, v72
v_mfma_f32_16x16x32_bf16 v[100:103], a[76:79], a[188:191], v[100:103]
ds_read_b128 a[204:207], v2 offset:7520
v_mfma_f32_16x16x32_bf16 v[96:99], a[64:67], a[188:191], v[96:99]
ds_read_b128 a[176:179], v2 offset:160
v_exp_f32 v73, v73
v_mfma_f32_16x16x32_bf16 v[96:99], a[60:63], a[184:187], v[96:99]
ds_read_b128 a[216:219], v2 offset:1248
v_mfma_f32_16x16x32_bf16 v[96:99], a[56:59], a[180:183], v[96:99]
ds_read_b128 a[236:239], v2 offset:1280
v_mfma_f32_16x16x32_bf16 v[104:107], a[56:59], a[184:187], v[104:107]
s_waitcnt lgkmcnt(6)
v_exp_f32 v74, v74
v_mfma_f32_16x16x32_bf16 v[104:107], a[60:63], a[188:191], v[104:107]
ds_read_b128 a[208:211], v2 offset:8576
v_exp_f32 v75, v75
v_mfma_f32_16x16x32_bf16 v[104:107], a[64:67], a[192:195], v[104:107]
global_load_dwordx4 a[136:139], v3, s[20:21] offset:0
v_add_f32 v76, 1.0, v76
v_add_f32 v77, 1.0, v77
v_mfma_f32_16x16x32_bf16 v[108:111], a[76:79], a[192:195], v[108:111]
ds_read_b128 a[180:183], v2 offset:1216
v_add_f32 v78, 1.0, v78
v_mfma_f32_16x16x32_bf16 v[108:111], a[72:75], a[188:191], v[108:111]
ds_read_b128 a[220:223], v2 offset:2304
v_add_f32 v79, 1.0, v79
v_mfma_f32_16x16x32_bf16 v[108:111], a[68:71], a[184:187], v[108:111]
ds_read_b128 a[240:243], v2 offset:2336
v_fmac_f32 v76, v72, v76
v_mfma_f32_16x16x32_bf16 v[116:119], a[68:71], a[188:191], v[116:119]
v_fmac_f32 v77, v73, v77
v_fmac_f32 v78, v74, v78
v_mfma_f32_16x16x32_bf16 v[116:119], a[72:75], a[192:195], v[116:119]
v_fmac_f32 v79, v75, v79
v_mfma_f32_16x16x32_bf16 v[116:119], a[76:79], a[196:199], v[116:119]
global_load_dwordx4 a[140:143], v3, s[20:21] offset:1024
v_rcp_f32 v76, v76
v_mfma_f32_16x16x32_bf16 v[112:115], a[64:67], a[196:199], v[112:115]
ds_read_b128 a[184:187], v2 offset:2272
v_mfma_f32_16x16x32_bf16 v[112:115], a[60:63], a[192:195], v[112:115]
ds_read_b128 a[224:227], v2 offset:3360
v_rcp_f32 v77, v77
v_mfma_f32_16x16x32_bf16 v[112:115], a[56:59], a[188:191], v[112:115]
ds_read_b128 a[244:247], v2 offset:3392
v_mfma_f32_16x16x32_bf16 v[120:123], a[56:59], a[192:195], v[120:123]
v_rcp_f32 v78, v78
v_mfma_f32_16x16x32_bf16 v[120:123], a[60:63], a[196:199], v[120:123]
v_rcp_f32 v79, v79
v_mfma_f32_16x16x32_bf16 v[120:123], a[64:67], a[200:203], v[120:123]
global_load_dwordx4 a[144:147], v3, s[20:21] offset:2048
v_fma_f32 v72, v72, v76, -v76
v_fma_f32 v73, v73, v77, -v77
v_fma_f32 v74, v74, v78, -v78
v_fma_f32 v75, v75, v79, -v79
v_cvt_pk_bf16_f32 v72, v72, v73
v_cvt_pk_bf16_f32 v73, v74, v75
ds_write_b64 v5, v[72:73] offset:27648
v_med3_f32 v80, v80, -s22, s22
v_mfma_f32_16x16x32_bf16 v[124:127], a[76:79], a[200:203], v[124:127]
L_stub12:
s_cmp_eq_u32 s37, 1
s_cbranch_scc1 L_wret
ds_read_b128 a[188:191], v2 offset:3328
v_med3_f32 v81, v81, -s22, s22
v_mfma_f32_16x16x32_bf16 v[124:127], a[72:75], a[196:199], v[124:127]
ds_read_b128 a[228:231], v2 offset:4416
v_med3_f32 v82, v82, -s22, s22
v_mfma_f32_16x16x32_bf16 v[124:127], a[68:71], a[192:195], v[124:127]
ds_read_b128 a[248:251], v2 offset:4448
v_med3_f32 v83, v83, -s22, s22
v_mfma_f32_16x16x32_bf16 v[132:135], a[68:71], a[196:199], v[132:135]
v_exp_f32 v84, v84
v_mfma_f32_16x16x32_bf16 v[132:135], a[72:75], a[200:203], v[132:135]
s_waitcnt lgkmcnt(6)
v_exp_f32 v85, v85
v_mfma_f32_16x16x32_bf16 v[132:135], a[76:79], a[204:207], v[132:135]
global_load_dwordx4 a[148:151], v3, s[20:21] offset:3072
v_exp_f32 v86, v86
v_mfma_f32_16x16x32_bf16 v[128:131], a[64:67], a[204:207], v[128:131]
ds_read_b128 a[192:195], v2 offset:4384
v_mfma_f32_16x16x32_bf16 v[128:131], a[60:63], a[200:203], v[128:131]
v_exp_f32 v87, v87
v_mfma_f32_16x16x32_bf16 v[128:131], a[56:59], a[196:199], v[128:131]
v_exp_f32 v80, v80
v_mfma_f32_16x16x32_bf16 v[136:139], a[56:59], a[200:203], v[136:139]
v_exp_f32 v81, v81
v_mfma_f32_16x16x32_bf16 v[136:139], a[60:63], a[204:207], v[136:139]
v_exp_f32 v82, v82
v_mfma_f32_16x16x32_bf16 v[136:139], a[64:67], a[208:211], v[136:139]
v_exp_f32 v83, v83
v_mfma_f32_16x16x32_bf16 v[140:143], a[76:79], a[208:211], v[140:143]
ds_read_b128 a[196:199], v2 offset:5440
v_add_f32 v84, 1.0, v84
v_mfma_f32_16x16x32_bf16 v[140:143], a[72:75], a[204:207], v[140:143]
v_add_f32 v85, 1.0, v85
v_add_f32 v86, 1.0, v86
v_mfma_f32_16x16x32_bf16 v[140:143], a[68:71], a[200:203], v[140:143]
s_waitcnt vmcnt(15)
v_add_f32 v87, 1.0, v87
v_fmac_f32 v84, v80, v84
v_mfma_f32_16x16x32_bf16 v[88:91], a[80:83], a[176:179], v[88:91]
v_fmac_f32 v85, v81, v85
v_fmac_f32 v86, v82, v86
v_mfma_f32_16x16x32_bf16 v[88:91], a[84:87], a[180:183], v[88:91]
ds_read_b128 a[200:203], v2 offset:6496
v_fmac_f32 v87, v83, v87
v_mfma_f32_16x16x32_bf16 v[88:91], a[88:91], a[184:187], v[88:91]
s_waitcnt vmcnt(11)
v_rcp_f32 v84, v84
v_mfma_f32_16x16x32_bf16 v[88:91], a[104:107], a[212:215], v[88:91]
s_waitcnt vmcnt(10)
v_rcp_f32 v85, v85
v_mfma_f32_16x16x32_bf16 v[88:91], a[108:111], a[216:219], v[88:91]
s_waitcnt vmcnt(9)
v_rcp_f32 v86, v86
v_mfma_f32_16x16x32_bf16 v[88:91], a[112:115], a[220:223], v[88:91]
s_waitcnt vmcnt(5)
v_rcp_f32 v87, v87
v_mfma_f32_16x16x32_bf16 v[88:91], a[128:131], a[232:235], v[88:91]
s_waitcnt vmcnt(4)
v_fma_f32 v80, v80, v84, -v84
v_fma_f32 v81, v81, v85, -v85
v_mfma_f32_16x16x32_bf16 v[88:91], a[132:135], a[236:239], v[88:91]
s_waitcnt vmcnt(3)
v_fma_f32 v82, v82, v86, -v86
v_fma_f32 v83, v83, v87, -v87
v_mfma_f32_16x16x32_bf16 v[88:91], a[136:139], a[240:243], v[88:91]
s_waitcnt vmcnt(0)
v_cvt_pk_bf16_f32 v80, v80, v81
v_cvt_pk_bf16_f32 v81, v82, v83
v_mfma_f32_16x16x32_bf16 v[92:95], a[148:151], a[240:243], v[92:95]
ds_write_b64 v5, v[80:81] offset:29952
v_mfma_f32_16x16x32_bf16 v[92:95], a[144:147], a[236:239], v[92:95]
v_mfma_f32_16x16x32_bf16 v[92:95], a[140:143], a[232:235], v[92:95]
v_mfma_f32_16x16x32_bf16 v[92:95], a[124:127], a[220:223], v[92:95]
s_waitcnt lgkmcnt(0)
s_barrier
v_mfma_f32_16x16x32_bf16 v[92:95], a[120:123], a[216:219], v[92:95]
ds_read_b128 a[152:155], v6 offset:16128
v_mfma_f32_16x16x32_bf16 v[92:95], a[116:119], a[212:215], v[92:95]
ds_read_b128 a[156:159], v6 offset:20736
v_mfma_f32_16x16x32_bf16 v[92:95], a[100:103], a[184:187], v[92:95]
ds_read_b128 a[160:163], v6 offset:25344
v_mfma_f32_16x16x32_bf16 v[92:95], a[96:99], a[180:183], v[92:95]
ds_read_b128 a[164:167], v6 offset:29952
v_add_u32 v0, 0, v7
v_mfma_f32_16x16x32_bf16 v[92:95], a[92:95], a[176:179], v[92:95]
s_waitcnt lgkmcnt(3)
buffer_store_dwordx4 a[152:155], v0, s[16:19], 0 offen nt
v_mfma_f32_16x16x32_bf16 v[100:103], a[92:95], a[180:183], v[100:103]
v_mfma_f32_16x16x32_bf16 v[100:103], a[96:99], a[184:187], v[100:103]
ds_read_b128 a[204:207], v2 offset:7552
v_mfma_f32_16x16x32_bf16 v[100:103], a[100:103], a[188:191], v[100:103]
v_add_u32 v0, 10240, v7
v_mfma_f32_16x16x32_bf16 v[100:103], a[116:119], a[216:219], v[100:103]
s_waitcnt lgkmcnt(3)
buffer_store_dwordx4 a[156:159], v0, s[16:19], 0 offen nt
v_mfma_f32_16x16x32_bf16 v[100:103], a[120:123], a[220:223], v[100:103]
v_med3_f32 v88, v88, -s22, s22
v_med3_f32 v89, v89, -s22, s22
v_mfma_f32_16x16x32_bf16 v[100:103], a[124:127], a[224:227], v[100:103]
v_med3_f32 v90, v90, -s22, s22
v_med3_f32 v91, v91, -s22, s22
v_mfma_f32_16x16x32_bf16 v[100:103], a[140:143], a[236:239], v[100:103]
v_exp_f32 v92, v92
v_mfma_f32_16x16x32_bf16 v[100:103], a[144:147], a[240:243], v[100:103]
ds_read_b128 a[212:215], v2 offset:5472
v_exp_f32 v93, v93
v_mfma_f32_16x16x32_bf16 v[100:103], a[148:151], a[244:247], v[100:103]
s_waitcnt lgkmcnt(2)
v_exp_f32 v94, v94
v_add_u32 v0, 20480, v7
v_mfma_f32_16x16x32_bf16 v[96:99], a[136:139], a[244:247], v[96:99]
buffer_store_dwordx4 a[160:163], v0, s[16:19], 0 offen nt
v_mfma_f32_16x16x32_bf16 v[96:99], a[132:135], a[240:243], v[96:99]
v_exp_f32 v95, v95
v_mfma_f32_16x16x32_bf16 v[96:99], a[128:131], a[236:239], v[96:99]
v_exp_f32 v88, v88
v_mfma_f32_16x16x32_bf16 v[96:99], a[112:115], a[224:227], v[96:99]
ds_read_b128 a[232:235], v2 offset:5504
v_exp_f32 v89, v89
v_mfma_f32_16x16x32_bf16 v[96:99], a[108:111], a[220:223], v[96:99]
v_exp_f32 v90, v90
v_mfma_f32_16x16x32_bf16 v[96:99], a[104:107], a[216:219], v[96:99]
v_exp_f32 v91, v91
v_add_u32 v0, 30720, v9
v_mfma_f32_16x16x32_bf16 v[96:99], a[88:91], a[188:191], v[96:99]
buffer_store_dwordx4 a[164:167], v0, s[16:19], 0 offen nt
v_mfma_f32_16x16x32_bf16 v[96:99], a[84:87], a[184:187], v[96:99]
v_add_f32 v92, 1.0, v92
v_add_f32 v93, 1.0, v93
v_accvgpr_read_b32 v0, a253
v_mfma_f32_16x16x32_bf16 v[96:99], a[80:83], a[180:183], v[96:99]
v_add_f32 v94, 1.0, v94
v_add_f32 v95, 1.0, v95
v_fmac_f32 v92, v88, v92
v_mfma_f32_16x16x32_bf16 v[104:107], a[80:83], a[184:187], v[104:107]
v_fmac_f32 v93, v89, v93
v_fmac_f32 v94, v90, v94
v_fmac_f32 v95, v91, v95
v_mfma_f32_16x16x32_bf16 v[104:107], a[84:87], a[188:191], v[104:107]
ds_read_b128 a[208:211], v2 offset:8608
v_rcp_f32 v92, v92
v_mfma_f32_16x16x32_bf16 v[104:107], a[88:91], a[192:195], v[104:107]
v_rcp_f32 v93, v93
v_mfma_f32_16x16x32_bf16 v[104:107], a[104:107], a[220:223], v[104:107]
v_rcp_f32 v94, v94
v_mfma_f32_16x16x32_bf16 v[104:107], a[108:111], a[224:227], v[104:107]
v_rcp_f32 v95, v95
v_fma_f32 v88, v88, v92, -v92
v_mfma_f32_16x16x32_bf16 v[104:107], a[112:115], a[228:231], v[104:107]
v_fma_f32 v89, v89, v93, -v93
v_fma_f32 v90, v90, v94, -v94
v_fma_f32 v91, v91, v95, -v95
v_mfma_f32_16x16x32_bf16 v[104:107], a[128:131], a[240:243], v[104:107]
v_add_u32 v92, 4096, v0
v_cvt_pk_bf16_f32 v88, v88, v89
v_cvt_pk_bf16_f32 v89, v90, v91
v_mfma_f32_16x16x32_bf16 v[104:107], a[132:135], a[244:247], v[104:107]
buffer_store_dwordx2 v[88:89], v92, s[16:19], 0 offen
v_med3_f32 v96, v96, -s22, s22
v_mfma_f32_16x16x32_bf16 v[104:107], a[136:139], a[248:251], v[104:107]
ds_read_b128 a[216:219], v2 offset:6528
v_med3_f32 v97, v97, -s22, s22
v_med3_f32 v98, v98, -s22, s22
v_mfma_f32_16x16x32_bf16 v[108:111], a[148:151], a[248:251], v[108:111]
v_med3_f32 v99, v99, -s22, s22
v_exp_f32 v100, v100
v_mfma_f32_16x16x32_bf16 v[108:111], a[144:147], a[244:247], v[108:111]
v_exp_f32 v101, v101
v_mfma_f32_16x16x32_bf16 v[108:111], a[140:143], a[240:243], v[108:111]
v_exp_f32 v102, v102
v_mfma_f32_16x16x32_bf16 v[108:111], a[124:127], a[228:231], v[108:111]
ds_read_b128 a[236:239], v2 offset:6560
v_exp_f32 v103, v103
v_mfma_f32_16x16x32_bf16 v[108:111], a[120:123], a[224:227], v[108:111]
v_exp_f32 v96, v96
v_mfma_f32_16x16x32_bf16 v[108:111], a[116:119], a[220:223], v[108:111]
v_exp_f32 v97, v97
v_mfma_f32_16x16x32_bf16 v[108:111], a[100:103], a[192:195], v[108:111]
v_exp_f32 v98, v98
v_mfma_f32_16x16x32_bf16 v[108:111], a[96:99], a[188:191], v[108:111]
v_exp_f32 v99, v99
v_add_f32 v100, 1.0, v100
v_mfma_f32_16x16x32_bf16 v[108:111], a[92:95], a[184:187], v[108:111]
v_add_f32 v101, 1.0, v101
v_add_f32 v102, 1.0, v102
v_add_f32 v103, 1.0, v103
v_mfma_f32_16x16x32_bf16 v[116:119], a[92:95], a[188:191], v[116:119]
v_fmac_f32 v100, v96, v100
v_fmac_f32 v101, v97, v101
v_fmac_f32 v102, v98, v102
v_mfma_f32_16x16x32_bf16 v[116:119], a[96:99], a[192:195], v[116:119]
v_fmac_f32 v103, v99, v103
v_rcp_f32 v100, v100
v_mfma_f32_16x16x32_bf16 v[116:119], a[100:103], a[196:199], v[116:119]
v_rcp_f32 v101, v101
v_mfma_f32_16x16x32_bf16 v[116:119], a[116:119], a[224:227], v[116:119]
v_rcp_f32 v102, v102
v_mfma_f32_16x16x32_bf16 v[116:119], a[120:123], a[228:231], v[116:119]
s_waitcnt lgkmcnt(0)
v_rcp_f32 v103, v103
v_fma_f32 v96, v96, v100, -v100
v_mfma_f32_16x16x32_bf16 v[116:119], a[124:127], a[212:215], v[116:119]
v_fma_f32 v97, v97, v101, -v101
v_fma_f32 v98, v98, v102, -v102
v_fma_f32 v99, v99, v103, -v103
v_mfma_f32_16x16x32_bf16 v[116:119], a[140:143], a[244:247], v[116:119]
v_add_u32 v100, 9216, v0
v_cvt_pk_bf16_f32 v96, v96, v97
v_cvt_pk_bf16_f32 v97, v98, v99
v_mfma_f32_16x16x32_bf16 v[116:119], a[144:147], a[248:251], v[116:119]
buffer_store_dwordx2 v[96:97], v100, s[16:19], 0 offen
v_med3_f32 v104, v104, -s22, s22
v_mfma_f32_16x16x32_bf16 v[116:119], a[148:151], a[232:235], v[116:119]
ds_read_b128 a[220:223], v2 offset:7584
v_med3_f32 v105, v105, -s22, s22
v_med3_f32 v106, v106, -s22, s22
v_mfma_f32_16x16x32_bf16 v[112:115], a[136:139], a[232:235], v[112:115]
v_med3_f32 v107, v107, -s22, s22
v_exp_f32 v108, v108
v_mfma_f32_16x16x32_bf16 v[112:115], a[132:135], a[248:251], v[112:115]
v_exp_f32 v109, v109
v_mfma_f32_16x16x32_bf16 v[112:115], a[128:131], a[244:247], v[112:115]
v_exp_f32 v110, v110
v_mfma_f32_16x16x32_bf16 v[112:115], a[112:115], a[212:215], v[112:115]
ds_read_b128 a[240:243], v2 offset:7616
v_exp_f32 v111, v111
v_mfma_f32_16x16x32_bf16 v[112:115], a[108:111], a[228:231], v[112:115]
v_exp_f32 v104, v104
v_mfma_f32_16x16x32_bf16 v[112:115], a[104:107], a[224:227], v[112:115]
v_exp_f32 v105, v105
v_mfma_f32_16x16x32_bf16 v[112:115], a[88:91], a[196:199], v[112:115]
v_exp_f32 v106, v106
v_mfma_f32_16x16x32_bf16 v[112:115], a[84:87], a[192:195], v[112:115]
v_exp_f32 v107, v107
v_add_f32 v108, 1.0, v108
v_mfma_f32_16x16x32_bf16 v[112:115], a[80:83], a[188:191], v[112:115]
v_add_f32 v109, 1.0, v109
v_add_f32 v110, 1.0, v110
v_add_f32 v111, 1.0, v111
v_mfma_f32_16x16x32_bf16 v[120:123], a[80:83], a[192:195], v[120:123]
v_fmac_f32 v108, v104, v108
v_fmac_f32 v109, v105, v109
v_fmac_f32 v110, v106, v110
v_mfma_f32_16x16x32_bf16 v[120:123], a[84:87], a[196:199], v[120:123]
v_fmac_f32 v111, v107, v111
v_rcp_f32 v108, v108
v_mfma_f32_16x16x32_bf16 v[120:123], a[88:91], a[200:203], v[120:123]
v_rcp_f32 v109, v109
v_mfma_f32_16x16x32_bf16 v[120:123], a[104:107], a[228:231], v[120:123]
v_rcp_f32 v110, v110
v_mfma_f32_16x16x32_bf16 v[120:123], a[108:111], a[212:215], v[120:123]
v_rcp_f32 v111, v111
v_fma_f32 v104, v104, v108, -v108
v_mfma_f32_16x16x32_bf16 v[120:123], a[112:115], a[216:219], v[120:123]
v_fma_f32 v105, v105, v109, -v109
v_fma_f32 v106, v106, v110, -v110
v_fma_f32 v107, v107, v111, -v111
v_mfma_f32_16x16x32_bf16 v[120:123], a[128:131], a[248:251], v[120:123]
v_add_u32 v108, 14336, v0
v_cvt_pk_bf16_f32 v104, v104, v105
v_cvt_pk_bf16_f32 v105, v106, v107
v_mfma_f32_16x16x32_bf16 v[120:123], a[132:135], a[232:235], v[120:123]
buffer_store_dwordx2 v[104:105], v108, s[16:19], 0 offen
v_med3_f32 v112, v112, -s22, s22
v_mfma_f32_16x16x32_bf16 v[120:123], a[136:139], a[236:239], v[120:123]
ds_read_b128 a[224:227], v2 offset:8640
v_med3_f32 v113, v113, -s22, s22
v_med3_f32 v114, v114, -s22, s22
v_mfma_f32_16x16x32_bf16 v[124:127], a[148:151], a[236:239], v[124:127]
v_med3_f32 v115, v115, -s22, s22
v_exp_f32 v116, v116
v_mfma_f32_16x16x32_bf16 v[124:127], a[144:147], a[232:235], v[124:127]
v_exp_f32 v117, v117
v_mfma_f32_16x16x32_bf16 v[124:127], a[140:143], a[248:251], v[124:127]
v_exp_f32 v118, v118
v_mfma_f32_16x16x32_bf16 v[124:127], a[124:127], a[216:219], v[124:127]
ds_read_b128 a[244:247], v2 offset:8672
v_exp_f32 v119, v119
v_mfma_f32_16x16x32_bf16 v[124:127], a[120:123], a[212:215], v[124:127]
v_exp_f32 v112, v112
v_mfma_f32_16x16x32_bf16 v[124:127], a[116:119], a[228:231], v[124:127]
v_exp_f32 v113, v113
v_mfma_f32_16x16x32_bf16 v[124:127], a[100:103], a[200:203], v[124:127]
v_exp_f32 v114, v114
v_mfma_f32_16x16x32_bf16 v[124:127], a[96:99], a[196:199], v[124:127]
v_exp_f32 v115, v115
v_add_f32 v116, 1.0, v116
v_mfma_f32_16x16x32_bf16 v[124:127], a[92:95], a[192:195], v[124:127]
v_add_f32 v117, 1.0, v117
v_add_f32 v118, 1.0, v118
v_add_f32 v119, 1.0, v119
v_mfma_f32_16x16x32_bf16 v[132:135], a[92:95], a[196:199], v[132:135]
v_fmac_f32 v116, v112, v116
v_fmac_f32 v117, v113, v117
v_fmac_f32 v118, v114, v118
v_mfma_f32_16x16x32_bf16 v[132:135], a[96:99], a[200:203], v[132:135]
v_fmac_f32 v119, v115, v119
v_rcp_f32 v116, v116
v_mfma_f32_16x16x32_bf16 v[132:135], a[100:103], a[204:207], v[132:135]
v_rcp_f32 v117, v117
v_mfma_f32_16x16x32_bf16 v[132:135], a[116:119], a[212:215], v[132:135]
v_rcp_f32 v118, v118
v_mfma_f32_16x16x32_bf16 v[132:135], a[120:123], a[216:219], v[132:135]
s_waitcnt lgkmcnt(0)
v_rcp_f32 v119, v119
v_fma_f32 v112, v112, v116, -v116
v_mfma_f32_16x16x32_bf16 v[132:135], a[124:127], a[220:223], v[132:135]
v_fma_f32 v113, v113, v117, -v117
v_fma_f32 v114, v114, v118, -v118
v_fma_f32 v115, v115, v119, -v119
v_mfma_f32_16x16x32_bf16 v[132:135], a[140:143], a[232:235], v[132:135]
v_add_u32 v116, 19456, v0
v_cvt_pk_bf16_f32 v112, v112, v113
v_cvt_pk_bf16_f32 v113, v114, v115
v_mfma_f32_16x16x32_bf16 v[132:135], a[144:147], a[236:239], v[132:135]
buffer_store_dwordx2 v[112:113], v116, s[16:19], 0 offen
v_med3_f32 v120, v120, -s22, s22
v_mfma_f32_16x16x32_bf16 v[132:135], a[148:151], a[240:243], v[132:135]
v_med3_f32 v121, v121, -s22, s22
v_med3_f32 v122, v122, -s22, s22
v_med3_f32 v123, v123, -s22, s22
v_mfma_f32_16x16x32_bf16 v[128:131], a[136:139], a[240:243], v[128:131]
v_exp_f32 v124, v124
v_mfma_f32_16x16x32_bf16 v[128:131], a[132:135], a[236:239], v[128:131]
v_exp_f32 v125, v125
v_mfma_f32_16x16x32_bf16 v[128:131], a[128:131], a[232:235], v[128:131]
v_exp_f32 v126, v126
v_mfma_f32_16x16x32_bf16 v[128:131], a[112:115], a[220:223], v[128:131]
v_exp_f32 v127, v127
v_mfma_f32_16x16x32_bf16 v[128:131], a[108:111], a[216:219], v[128:131]
v_exp_f32 v120, v120
v_mfma_f32_16x16x32_bf16 v[128:131], a[104:107], a[212:215], v[128:131]
v_exp_f32 v121, v121
v_mfma_f32_16x16x32_bf16 v[128:131], a[88:91], a[204:207], v[128:131]
v_exp_f32 v122, v122
v_mfma_f32_16x16x32_bf16 v[128:131], a[84:87], a[200:203], v[128:131]
v_exp_f32 v123, v123
v_add_f32 v124, 1.0, v124
v_mfma_f32_16x16x32_bf16 v[128:131], a[80:83], a[196:199], v[128:131]
v_add_f32 v125, 1.0, v125
v_add_f32 v126, 1.0, v126
v_add_f32 v127, 1.0, v127
v_mfma_f32_16x16x32_bf16 v[136:139], a[80:83], a[200:203], v[136:139]
v_fmac_f32 v124, v120, v124
v_fmac_f32 v125, v121, v125
v_fmac_f32 v126, v122, v126
v_mfma_f32_16x16x32_bf16 v[136:139], a[84:87], a[204:207], v[136:139]
v_fmac_f32 v127, v123, v127
v_rcp_f32 v124, v124
v_mfma_f32_16x16x32_bf16 v[136:139], a[88:91], a[208:211], v[136:139]
v_rcp_f32 v125, v125
v_mfma_f32_16x16x32_bf16 v[136:139], a[104:107], a[216:219], v[136:139]
v_rcp_f32 v126, v126
v_mfma_f32_16x16x32_bf16 v[136:139], a[108:111], a[220:223], v[136:139]
v_rcp_f32 v127, v127
v_fma_f32 v120, v120, v124, -v124
v_mfma_f32_16x16x32_bf16 v[136:139], a[112:115], a[224:227], v[136:139]
v_fma_f32 v121, v121, v125, -v125
v_fma_f32 v122, v122, v126, -v126
v_fma_f32 v123, v123, v127, -v127
v_mfma_f32_16x16x32_bf16 v[136:139], a[128:131], a[236:239], v[136:139]
v_add_u32 v124, 24576, v0
v_cvt_pk_bf16_f32 v120, v120, v121
v_cvt_pk_bf16_f32 v121, v122, v123
v_mfma_f32_16x16x32_bf16 v[136:139], a[132:135], a[240:243], v[136:139]
buffer_store_dwordx2 v[120:121], v124, s[16:19], 0 offen
v_med3_f32 v128, v128, -s22, s22
v_mfma_f32_16x16x32_bf16 v[136:139], a[136:139], a[244:247], v[136:139]
v_med3_f32 v129, v129, -s22, s22
v_med3_f32 v130, v130, -s22, s22
v_med3_f32 v131, v131, -s22, s22
v_mfma_f32_16x16x32_bf16 v[140:143], a[148:151], a[244:247], v[140:143]
v_exp_f32 v132, v132
v_mfma_f32_16x16x32_bf16 v[140:143], a[144:147], a[240:243], v[140:143]
v_exp_f32 v133, v133
v_mfma_f32_16x16x32_bf16 v[140:143], a[140:143], a[236:239], v[140:143]
v_exp_f32 v134, v134
v_mfma_f32_16x16x32_bf16 v[140:143], a[124:127], a[224:227], v[140:143]
v_exp_f32 v135, v135
v_mfma_f32_16x16x32_bf16 v[140:143], a[120:123], a[220:223], v[140:143]
v_exp_f32 v128, v128
v_mfma_f32_16x16x32_bf16 v[140:143], a[116:119], a[216:219], v[140:143]
v_exp_f32 v129, v129
v_mfma_f32_16x16x32_bf16 v[140:143], a[100:103], a[208:211], v[140:143]
v_exp_f32 v130, v130
v_mfma_f32_16x16x32_bf16 v[140:143], a[96:99], a[204:207], v[140:143]
v_exp_f32 v131, v131
v_add_f32 v132, 1.0, v132
v_mfma_f32_16x16x32_bf16 v[140:143], a[92:95], a[200:203], v[140:143]
v_add_f32 v133, 1.0, v133
v_add_f32 v134, 1.0, v134
v_add_f32 v135, 1.0, v135
v_fmac_f32 v132, v128, v132
v_fmac_f32 v133, v129, v133
v_fmac_f32 v134, v130, v134
v_fmac_f32 v135, v131, v135
v_rcp_f32 v132, v132
v_rcp_f32 v133, v133
v_rcp_f32 v134, v134
v_rcp_f32 v135, v135
v_fma_f32 v128, v128, v132, -v132
v_fma_f32 v129, v129, v133, -v133
v_fma_f32 v130, v130, v134, -v134
v_fma_f32 v131, v131, v135, -v135
v_add_u32 v132, 29696, v0
v_cvt_pk_bf16_f32 v128, v128, v129
v_cvt_pk_bf16_f32 v129, v130, v131
buffer_store_dwordx2 v[128:129], v132, s[16:19], 0 offen
v_med3_f32 v136, v136, -s22, s22
v_med3_f32 v137, v137, -s22, s22
v_med3_f32 v138, v138, -s22, s22
v_med3_f32 v139, v139, -s22, s22
v_exp_f32 v140, v140
v_exp_f32 v141, v141
v_exp_f32 v142, v142
v_exp_f32 v143, v143
v_exp_f32 v136, v136
v_exp_f32 v137, v137
v_exp_f32 v138, v138
v_exp_f32 v139, v139
v_add_f32 v140, 1.0, v140
v_add_f32 v141, 1.0, v141
v_add_f32 v142, 1.0, v142
v_add_f32 v143, 1.0, v143
v_fmac_f32 v140, v136, v140
v_fmac_f32 v141, v137, v141
v_fmac_f32 v142, v138, v142
v_fmac_f32 v143, v139, v143
v_rcp_f32 v140, v140
v_rcp_f32 v141, v141
v_rcp_f32 v142, v142
v_rcp_f32 v143, v143
v_fma_f32 v136, v136, v140, -v140
v_fma_f32 v137, v137, v141, -v141
v_fma_f32 v138, v138, v142, -v142
v_fma_f32 v139, v139, v143, -v143
v_add_u32 v140, 34816, v0
v_cvt_pk_bf16_f32 v136, v136, v137
v_cvt_pk_bf16_f32 v137, v138, v139
buffer_store_dwordx2 v[136:137], v140, s[16:19], 0 offen
L_end:
s_endpgm
.section .rodata,"a"
.p2align 6
.amdhsa_kernel prep_kernel
  .amdhsa_next_free_vgpr 128
  .amdhsa_next_free_sgpr 100
  .amdhsa_accum_offset 128
  .amdhsa_group_segment_fixed_size 0
  .amdhsa_kernarg_size 40
  .amdhsa_user_sgpr_count 2
  .amdhsa_user_sgpr_kernarg_segment_ptr 1
  .amdhsa_system_sgpr_workgroup_id_x 1
  .amdhsa_float_denorm_mode_32 3
.end_amdhsa_kernel
.section .rodata,"a"
.p2align 6
.amdhsa_kernel standalone__autoregressive_conv_wavernn__speech_kernel
  .amdhsa_next_free_vgpr 512
  .amdhsa_next_free_sgpr 100
  .amdhsa_accum_offset 256
  .amdhsa_group_segment_fixed_size 0
  .amdhsa_kernarg_size 40
  .amdhsa_user_sgpr_count 2
  .amdhsa_user_sgpr_kernarg_segment_ptr 1
  .amdhsa_system_sgpr_workgroup_id_x 1
  .amdhsa_float_denorm_mode_32 3
.end_amdhsa_kernel
```
